```python
import torch

def _softmax(x, axis=-1):
    return torch.softmax(x, dim=axis)
def _gelu(x):
    return torch.nn.functional.gelu(x, approximate="tanh")
def _silu(x):
    return torch.nn.functional.silu(x)
def _sigmoid(x):
    return torch.sigmoid(x)
def _layernorm(x, axis=-1, eps=1e-5):
    m = x.mean(dim=axis, keepdim=True)
    v = x.var(dim=axis, keepdim=True, unbiased=False)
    return (x - m) / torch.sqrt(v + eps)
def _scatter_add(tgt, idx, src, axis=0):
    return tgt.clone().index_add_(axis, idx, src)
def _segment_sum(src, seg, n):
    out = torch.zeros((n,) + src.shape[1:], dtype=src.dtype)
    return out.index_add_(0, seg, src)
def _pad(x, pw):
    flat = tuple(v for pair in reversed(pw) for v in pair)
    return torch.nn.functional.pad(x, flat)

kernel_name = 'sequential_preLN__softmax_full_mha__mixer_token_mlp__prompt'

def setup_inputs():

    _w = (lambda a: (lambda t: t.to(torch.bfloat16) if t.is_floating_point() else t)(torch.as_tensor(a)))
    def _A_setup():
        B, S, D = 1, 2048, 512
        return {
            "x": _w((lambda *s: torch.randn(*s, dtype=torch.bfloat16) * 0.05)(B, S, D)),
            "wqkv": _w((lambda *s: torch.randn(*s, dtype=torch.bfloat16) * 0.05)(D, 3 * D)),
            "wo": _w((lambda *s: torch.randn(*s, dtype=torch.bfloat16) * 0.05)(D, D)),
        }
    _A_in = _A_setup()

    def _B_setup():
        B, S, D, F = 1, 2048, 512, 1792
        return {
            "x": _w((lambda *s: torch.randn(*s, dtype=torch.bfloat16) * 0.05)(B, S, D)),
            "w1": _w((lambda *s: torch.randn(*s, dtype=torch.bfloat16) * 0.8)(S, F) * (S ** -0.5)),
            "b1": _w((lambda *s: torch.randn(*s, dtype=torch.bfloat16) * 12.8)(F) * 0.02),
            "w2": _w((lambda *s: torch.randn(*s, dtype=torch.bfloat16) * 0.2)(F, S) * (F ** -0.5)),
            "b2": _w((lambda *s: torch.randn(*s, dtype=torch.bfloat16) * 3.2)(S) * 0.02),
        }
    _B_in = _B_setup()

    return {
        "A_x": _A_in["x"],
        "A_wqkv": _A_in["wqkv"],
        "A_wo": _A_in["wo"],
        "B_x": _B_in["x"],
        "B_w1": _B_in["w1"],
        "B_b1": _B_in["b1"],
        "B_w2": _B_in["w2"],
        "B_b2": _B_in["b2"],
    }

def reference(A_x, A_wqkv, A_wo, B_x, B_w1, B_b1, B_w2, B_b2):
    def _A_ref(x, wqkv, wo):
        B, S, D = x.shape
        H = 32; Dh = D // H
        qkv = (lambda x, *d: x.permute(*d))((x @ wqkv).reshape(B, S, 3, H, Dh), 2, 0, 3, 1, 4)
        q, k, v = qkv[0], qkv[1], qkv[2]
        scale = Dh ** -0.5
        scores = torch.einsum("bhqd,bhkd->bhqk", q, k) * scale
        p = _softmax(scores, axis=-1)
        o = torch.einsum("bhqk,bhkd->bhqd", p, v)
        return (lambda x, *d: x.permute(*d))(o, 0, 2, 1, 3).reshape(B, S, D) @ wo

    def _B_ref(x, w1, b1, w2, b2):
        B, S, D = x.shape
        h = _layernorm(x, axis=-1)
        u = torch.einsum("bsd,sf->bdf", h, w1) + b1
        u = _gelu(u)
        y = torch.einsum("bdf,fs->bds", u, w2) + b2
        return (lambda x, *d: x.permute(*d))(y, 0, 2, 1)

    x = A_x
    h = x + _A_ref(_layernorm(x, axis=-1), A_wqkv, A_wo)
    h2 = h + _B_ref(_layernorm(h, axis=-1), B_w1, B_b1, B_w2, B_b2)
    return h2
```

```asm
; @launch grid=(256,1,1) block=(256,1,1) lds=163840
.amdgcn_target "amdgcn-amd-amdhsa--gfx950"
.text
.globl sequential_preLN__softmax_full_mha__mixer_token_mlp__prompt_kernel
.p2align 12
.p2align 8
.type sequential_preLN__softmax_full_mha__mixer_token_mlp__prompt_kernel,@function
sequential_preLN__softmax_full_mha__mixer_token_mlp__prompt_kernel:
    s_load_dwordx2 s[4:5], s[0:1], 0
    s_load_dwordx2 s[8:9], s[0:1], 8
    s_load_dwordx2 s[12:13], s[0:1], 80
    s_cmp_ge_u32 s2, 256
    s_cbranch_scc1 L_end
    s_getpc_b64 s[60:61]
L_pc_1:
    s_add_u32 s60, s60, L_pf_base-L_pc_1
    s_addc_u32 s61, s61, 0
    s_lshr_b32 s62, s2, 3
    s_lshl_b32 s62, s62, 4
    v_lshrrev_b32 v250, 4, v0
    v_add_lshl_u32 v250, v250, s62, 7
    v_min_u32 v250, L_code_end-L_pf_base-4, v250
    global_load_dword v251, v250, s[60:61]
L_pf_base:
    v_lshrrev_b32 v2, 6, v0
    s_and_b32 s41, s2, 7
    v_readfirstlane_b32 s40, v2
    s_lshr_b32 s42, s2, 3
    s_lshr_b32 s50, s41, 1
    s_and_b32 s46, s42, 7
    s_lshl3_add_u32 s50, s50, s46
    s_and_b32 s46, s41, 1
    s_lshr_b32 s47, s42, 3
    s_lshl2_add_u32 s51, s46, s47
    s_add_u32 s46, s50, s51
    s_lshl_b32 s46, s46, 2
    s_lshl_b32 s47, s50, 0
    s_cmp_eq_u32 s51, 3
    s_cselect_b32 s46, s47, s46
    s_add_u32 s46, s46, s41
    s_and_b32 s46, s46, 7
    s_lshl_b32 s54, s46, 7
    s_lshl_b32 s56, s40, 11
    s_lshl2_add_u32 s46, s50, s40
    s_lshl_b32 s46, s46, 14
    v_bfe_u32 v6, v0, 3, 3
    v_lshl_add_u32 v6, v6, 10, s46
    v_bfe_u32 v5, v0, 4, 2
    v_and_b32 v7, 7, v0
    v_xor_b32 v5, v5, v7
    v_lshl_add_u32 v3, v5, 4, v6
    v_xor_b32 v4, 64, v3
    v_add_u32 v4, 7168, v4
    s_mov_b32 s6, 2097152
    s_mov_b32 s7, 0x00020000
    s_add_u32 m0, s56, 0
    s_mul_i32 s96, s54, 1536
    s_waitcnt lgkmcnt(0)
    buffer_load_dwordx4 v3, s[4:7], s54 offen offset:0 lds
    buffer_load_dwordx4 v4, s[4:7], s54 offen offset:1024 lds
    s_mul_i32 s46, s40, 49152
    s_lshl_b32 s47, s51, 7
    s_add_u32 s46, s46, s47
    v_bfe_u32 v6, v0, 2, 3
    v_mul_u32_u24 v6, 3072, v6
    v_bfe_u32 v7, v0, 5, 1
    v_lshl_add_u32 v6, v7, 6, v6
    v_and_b32 v7, 3, v0
    v_lshlrev_b32 v7, 4, v7
    v_add3_u32 v5, v6, v7, s46
    v_add_u32 v18, 23552, v5
    v_add_u32 v19, 1024, v5
    v_add_u32 v23, 24576, v5
    s_mov_b32 s10, 1572864
    s_mov_b32 s11, 0x00020000
    s_add_u32 m0, s56, 8192
    s_add_u32 s54, s54, 128
    buffer_load_dwordx4 v5, s[8:11], s96 offen offset:0 lds
    buffer_load_dwordx4 v18, s[8:11], s96 offen offset:1024 lds
    s_add_u32 m0, s56, 16384
    s_and_b32 s54, s54, 1023
    buffer_load_dwordx4 v19, s[8:11], s96 offen offset:0 lds
    buffer_load_dwordx4 v23, s[8:11], s96 offen offset:1024 lds
    s_add_u32 s62, s12, 14942208
    s_addc_u32 s63, s13, 0
    s_load_dwordx2 s[44:45], s[62:63], 0
    s_load_dwordx2 s[16:17], s[0:1], 16
    s_load_dwordx2 s[20:21], s[0:1], 32
    s_load_dwordx2 s[24:25], s[0:1], 48
    s_load_dwordx2 s[28:29], s[0:1], 40
    s_load_dwordx2 s[32:33], s[0:1], 56
    s_load_dwordx2 s[36:37], s[0:1], 64
    s_add_u32 m0, s56, 24576
    s_mul_i32 s95, s54, 1536
    buffer_load_dwordx4 v3, s[4:7], s54 offen offset:0 lds
    buffer_load_dwordx4 v4, s[4:7], s54 offen offset:1024 lds
    s_add_u32 m0, s56, 32768
    s_add_u32 s54, s54, 128
    buffer_load_dwordx4 v5, s[8:11], s95 offen offset:0 lds
    buffer_load_dwordx4 v18, s[8:11], s95 offen offset:1024 lds
    s_add_u32 m0, s56, 40960
    s_and_b32 s54, s54, 1023
    buffer_load_dwordx4 v19, s[8:11], s95 offen offset:0 lds
    buffer_load_dwordx4 v23, s[8:11], s95 offen offset:1024 lds
    s_mov_b32 s14, 16777216
    s_mov_b32 s15, 0x00020000
    v_mov_b32 v238, 0
    s_lshl2_add_u32 s57, s2, s40
    s_lshl_b32 s57, s57, 7
    s_add_u32 s57, s57, 15204352
    s_mov_b64 exec, 1
    buffer_atomic_or v238, off, s[12:15], s57 sc1
    s_mov_b64 exec, -1
    s_add_u32 m0, s56, 49152
    s_mul_i32 s94, s54, 1536
    buffer_load_dwordx4 v3, s[4:7], s54 offen offset:0 lds
    buffer_load_dwordx4 v4, s[4:7], s54 offen offset:1024 lds
    s_add_u32 m0, s56, 57344
    s_add_u32 s54, s54, 128
    buffer_load_dwordx4 v5, s[8:11], s94 offen offset:0 lds
    buffer_load_dwordx4 v18, s[8:11], s94 offen offset:1024 lds
    s_add_u32 m0, s56, 65536
    s_and_b32 s54, s54, 1023
    buffer_load_dwordx4 v19, s[8:11], s94 offen offset:0 lds
    buffer_load_dwordx4 v23, s[8:11], s94 offen offset:1024 lds
    s_mov_b32 s14, 16777216
    s_mov_b32 s15, 0x00020000
    s_mov_b32 s18, 524288
    s_mov_b32 s19, 0x00020000
    s_mov_b32 s22, 7340032
    s_mov_b32 s23, 0x00020000
    s_mov_b32 s26, 7340032
    s_mov_b32 s27, 0x00020000
    s_mov_b32 s30, 3584
    s_mov_b32 s31, 0x00020000
    s_mov_b32 s34, 4096
    s_mov_b32 s35, 0x00020000
    s_mov_b32 s38, 2097152
    s_mov_b32 s39, 0x00020000
    v_and_b32 v1, 63, v0
    v_lshlrev_b32 v2, 4, v1
    s_and_b32 s52, s40, 1
    s_lshr_b32 s53, s40, 1
    s_xor_b32 s48, s52, s53
    s_lshl_b32 s46, s52, 12
    s_lshl_b32 s47, s48, 5
    v_and_b32 v20, 31, v1
    v_lshrrev_b32 v21, 5, v1
    v_bfe_u32 v22, v1, 1, 3
    v_xor_b32 v22, v22, v21
    v_lshlrev_b32 v22, 4, v22
    v_xor_b32 v22, s47, v22
    v_lshl_add_u32 v22, v20, 7, v22
    v_add_u32 v6, s46, v22
    v_xor_b32 v7, 32, v6
    v_xor_b32 v8, 64, v6
    v_xor_b32 v9, 96, v6
    v_add_u32 v10, 0x10000, v6
    v_add_u32 v11, 0x10000, v7
    v_add_u32 v12, 0x10000, v8
    v_add_u32 v13, 0x10000, v9
    s_lshl2_add_u32 s46, s48, s53
    s_lshl_b32 s46, s46, 9
    v_lshlrev_b32 v24, 10, v21
    v_bfe_u32 v22, v1, 2, 2
    v_lshl_add_u32 v24, v22, 6, v24
    v_bfe_u32 v22, v1, 4, 1
    v_lshl_add_u32 v24, v22, 5, v24
    v_and_b32 v22, 3, v1
    v_lshl_add_u32 v24, v22, 3, v24
    v_add_u32 v14, s46, v24
    v_xor_b32 v15, 2048, v14
    v_add_u32 v16, 0x10000, v14
    v_add_u32 v17, 0x10000, v15
    s_add_u32 s46, s56, 155648
    v_lshl_add_u32 v213, v1, 2, s46
    v_lshl_add_u32 v214, v20, 2, s46
    v_xor_b32 v215, 4096, v214
    v_xor_b32 v216, 2048, v213
    v_lshl_add_u32 v217, v21, 4, s46
    v_and_b32 v218, 0x33, v1
    v_bfe_u32 v22, v1, 2, 1
    v_lshl_add_u32 v218, v22, 3, v218
    v_bfe_u32 v22, v1, 3, 1
    v_lshl_add_u32 v218, v22, 2, v218
    v_lshlrev_b32 v218, 4, v218
    v_and_b32 v219, 15, v1
    v_lshlrev_b32 v219, 4, v219
    v_lshl_add_u32 v219, v21, 8, v219
    v_bfe_u32 v24, v1, 4, 1
    v_lshl_add_u32 v219, v24, 16, v219
    s_lshl1_add_u32 s46, s51, s53
    s_lshl1_add_u32 s47, s50, s52
    s_lshl_b32 s59, s46, 7
    s_add_u32 s59, s59, s47
    s_lshl_b32 s59, s59, 10
    s_and_b32 s48, s50, 3
    s_lshl2_add_u32 s48, s51, s48
    s_lshl_b32 s48, s48, 7
    s_lshr_b32 s46, s50, 2
    s_lshl3_add_u32 s48, s46, s48
    s_add_u32 s48, s48, 15204352
    v_xor_b32 v22, v22, v21
    v_and_b32 v24, 6, v1
    v_or_b32 v22, v22, v24
    v_cmp_eq_u32 vcc, 0, v22
    v_cmp_eq_u32 s[62:63], 4, v22
    v_mov_b32 v22, 0x3f803f80
    v_cndmask_b32 v208, 0, v22, vcc
    v_cndmask_b32 v209, 0, v22, vcc
    v_cndmask_b32 v210, 0, v22, s[62:63]
    v_cndmask_b32 v211, 0, v22, s[62:63]
    v_and_b32 v22, 1, v1
    v_mul_u32_u24 v22, 0xaaaa, v22
    v_add_u32 v212, 0x4444, v22
    v_mov_b32 v20, 0
    v_mov_b32 v21, 0
    s_mov_b32 s58, 0xffff0000
    v_mul_u32_u24 v254, 4096, v1
    v_lshlrev_b32 v255, 3, v1
    s_waitcnt lgkmcnt(0)
    s_add_u32 s44, s44, 0x9e3779b9
    s_add_u32 s45, s45, 0x7f4a7c15
    s_lshl_b32 s46, s2, 10
    s_add_u32 s46, s46, 14680064
    v_lshl_add_u32 v236, v0, 2, s46
    v_mov_b32 v237, -1
    v_mov_b32 v238, 0
    s_lshl2_add_u32 s57, s2, s40
    s_lshl_b32 s57, s57, 7
    s_add_u32 s57, s57, 15204352
    v_mov_b32 v220, 0
    v_mov_b32 v221, 0
    v_mov_b32 v222, 0
    v_mov_b32 v223, 0
    v_mov_b32 v224, 0
    v_mov_b32 v225, 0
    v_mov_b32 v226, 0
    v_mov_b32 v227, 0
    v_mov_b32 v228, 0
    v_mov_b32 v229, 0
    v_mov_b32 v230, 0
    v_mov_b32 v231, 0
    s_waitcnt vmcnt(13)
    s_barrier
    ds_read_b128 v[96:99], v6 offset:0
    ds_read_b64_tr_b16 v[28:29], v14 offset:16384
    ds_read_b64_tr_b16 v[30:31], v14 offset:16640
    ds_read_b64_tr_b16 v[24:25], v14 offset:8192
    ds_read_b64_tr_b16 v[26:27], v14 offset:8448
    ds_read_b128 a[0:3], v7 offset:0
    ds_read_b64_tr_b16 v[36:37], v15 offset:16384
    ds_read_b64_tr_b16 v[38:39], v15 offset:16640
    ds_read_b64_tr_b16 v[32:33], v15 offset:8192
    ds_read_b64_tr_b16 v[34:35], v15 offset:8448
    s_waitcnt lgkmcnt(7)
    v_mfma_f32_32x32x16_bf16 v[64:79], v[28:31], v[96:99], 0
    s_add_u32 m0, s56, 73728
    ds_read_b128 v[100:103], v8 offset:0
    ds_read_b64_tr_b16 v[44:45], v14 offset:20480
    ds_read_b64_tr_b16 v[46:47], v14 offset:20736
    v_lshlrev_b32 v192, 16, v96
    v_and_b32 v193, s58, v96
    v_lshlrev_b32 v194, 16, v97
    s_mul_i32 s93, s54, 1536
    s_waitcnt lgkmcnt(8)
    v_mfma_f32_32x32x16_bf16 v[48:63], v[24:27], v[96:99], 0
    ds_read_b64_tr_b16 v[40:41], v14 offset:12288
    ds_read_b64_tr_b16 v[42:43], v14 offset:12544
    buffer_load_dwordx4 v3, s[4:7], s54 offen offset:0 lds
    buffer_load_dwordx4 v4, s[4:7], s54 offen offset:1024 lds
    v_and_b32 v195, s58, v97
    v_lshlrev_b32 v196, 16, v98
    v_and_b32 v197, s58, v98
    v_lshlrev_b32 v198, 16, v99
    v_and_b32 v199, s58, v99
    v_smfmac_f32_16x16x64_bf16 v[224:227], v[208:211], v[24:31], v212
    s_waitcnt lgkmcnt(5)
    v_mfma_f32_32x32x16_bf16 v[64:79], v[36:39], a[0:3], v[64:79]
    s_add_u32 m0, s56, 81920
    ds_read_b128 a[4:7], v9 offset:0
    ds_read_b64_tr_b16 v[28:29], v15 offset:20480
    ds_read_b64_tr_b16 v[30:31], v15 offset:20736
    v_fmac_f32 v20, v192, v192
    v_fmac_f32 v21, v193, v193
    v_fmac_f32 v20, v194, v194
    s_add_u32 s54, s54, 128
    v_mfma_f32_32x32x16_bf16 v[48:63], v[32:35], a[0:3], v[48:63]
    s_waitcnt lgkmcnt(3)
    ds_read_b64_tr_b16 v[24:25], v15 offset:12288
    ds_read_b64_tr_b16 v[26:27], v15 offset:12544
    buffer_load_dwordx4 v5, s[8:11], s93 offen offset:0 lds
    buffer_load_dwordx4 v18, s[8:11], s93 offen offset:1024 lds
    v_fmac_f32 v21, v195, v195
    v_fmac_f32 v20, v196, v196
    v_fmac_f32 v21, v197, v197
    v_fmac_f32 v20, v198, v198
    v_fmac_f32 v21, v199, v199
    v_mfma_f32_32x32x16_bf16 v[64:79], v[44:47], v[100:103], v[64:79]
    s_waitcnt vmcnt(11)
    s_barrier
    s_add_u32 m0, s56, 90112
    ds_read_b128 v[104:107], v6 offset:24576
    ds_read_b64_tr_b16 v[36:37], v14 offset:40960
    ds_read_b64_tr_b16 v[38:39], v14 offset:41216
    v_lshlrev_b32 v192, 16, v100
    v_and_b32 v193, s58, v100
    v_lshlrev_b32 v194, 16, v101
    s_and_b32 s54, s54, 1023
    v_mfma_f32_32x32x16_bf16 v[48:63], v[40:43], v[100:103], v[48:63]
    ds_read_b64_tr_b16 v[32:33], v14 offset:32768
    ds_read_b64_tr_b16 v[34:35], v14 offset:33024
    buffer_load_dwordx4 v19, s[8:11], s93 offen offset:0 lds
    buffer_load_dwordx4 v23, s[8:11], s93 offen offset:1024 lds
    v_and_b32 v195, s58, v101
    v_lshlrev_b32 v196, 16, v102
    v_and_b32 v197, s58, v102
    v_lshlrev_b32 v198, 16, v103
    v_and_b32 v199, s58, v103
    v_smfmac_f32_16x16x64_bf16 v[224:227], v[208:211], v[40:47], v212
    v_smfmac_f32_16x16x64_bf16 v[220:223], v[208:211], v[96:103], v212
    s_waitcnt lgkmcnt(5)
    v_mfma_f32_32x32x16_bf16 v[64:79], v[28:31], a[4:7], v[64:79]
    s_add_u32 m0, s56, 98304
    ds_read_b128 a[8:11], v7 offset:24576
    ds_read_b64_tr_b16 v[44:45], v15 offset:40960
    ds_read_b64_tr_b16 v[46:47], v15 offset:41216
    v_fmac_f32 v20, v192, v192
    v_fmac_f32 v21, v193, v193
    v_fmac_f32 v20, v194, v194
    s_mul_i32 s92, s54, 1536
    v_mfma_f32_32x32x16_bf16 v[48:63], v[24:27], a[4:7], v[48:63]
    s_waitcnt lgkmcnt(3)
    ds_read_b64_tr_b16 v[40:41], v15 offset:32768
    ds_read_b64_tr_b16 v[42:43], v15 offset:33024
    buffer_load_dwordx4 v3, s[4:7], s54 offen offset:0 lds
    buffer_load_dwordx4 v4, s[4:7], s54 offen offset:1024 lds
    v_fmac_f32 v21, v195, v195
    v_fmac_f32 v20, v196, v196
    v_fmac_f32 v21, v197, v197
    v_fmac_f32 v20, v198, v198
    v_fmac_f32 v21, v199, v199
    v_mfma_f32_32x32x16_bf16 v[64:79], v[36:39], v[104:107], v[64:79]
    s_add_u32 m0, s56, 106496
    ds_read_b128 v[108:111], v8 offset:24576
    ds_read_b64_tr_b16 v[28:29], v14 offset:45056
    ds_read_b64_tr_b16 v[30:31], v14 offset:45312
    v_lshlrev_b32 v192, 16, v104
    v_and_b32 v193, s58, v104
    v_lshlrev_b32 v194, 16, v105
    s_add_u32 s54, s54, 128
    v_mfma_f32_32x32x16_bf16 v[48:63], v[32:35], v[104:107], v[48:63]
    ds_read_b64_tr_b16 v[24:25], v14 offset:36864
    ds_read_b64_tr_b16 v[26:27], v14 offset:37120
    buffer_load_dwordx4 v5, s[8:11], s92 offen offset:0 lds
    buffer_load_dwordx4 v18, s[8:11], s92 offen offset:1024 lds
    v_and_b32 v195, s58, v105
    v_lshlrev_b32 v196, 16, v106
    v_and_b32 v197, s58, v106
    v_lshlrev_b32 v198, 16, v107
    v_and_b32 v199, s58, v107
    v_smfmac_f32_16x16x64_bf16 v[224:227], v[208:211], v[32:39], v212
    s_waitcnt lgkmcnt(5)
    v_mfma_f32_32x32x16_bf16 v[64:79], v[44:47], a[8:11], v[64:79]
    s_add_u32 m0, s56, 114688
    ds_read_b128 a[12:15], v9 offset:24576
    ds_read_b64_tr_b16 v[36:37], v15 offset:45056
    ds_read_b64_tr_b16 v[38:39], v15 offset:45312
    v_fmac_f32 v20, v192, v192
    v_fmac_f32 v21, v193, v193
    v_fmac_f32 v20, v194, v194
    s_and_b32 s54, s54, 1023
    v_mfma_f32_32x32x16_bf16 v[48:63], v[40:43], a[8:11], v[48:63]
    s_waitcnt lgkmcnt(3)
    ds_read_b64_tr_b16 v[32:33], v15 offset:36864
    ds_read_b64_tr_b16 v[34:35], v15 offset:37120
    buffer_load_dwordx4 v19, s[8:11], s92 offen offset:0 lds
    buffer_load_dwordx4 v23, s[8:11], s92 offen offset:1024 lds
    v_fmac_f32 v21, v195, v195
    v_fmac_f32 v20, v196, v196
    v_fmac_f32 v21, v197, v197
    v_fmac_f32 v20, v198, v198
    v_fmac_f32 v21, v199, v199
    v_mfma_f32_32x32x16_bf16 v[64:79], v[28:31], v[108:111], v[64:79]
    s_waitcnt vmcnt(12)
    s_barrier
    s_add_u32 m0, s56, 122880
    ds_read_b128 v[112:115], v6 offset:49152
    ds_read_b64_tr_b16 v[44:45], v16 offset:0
    ds_read_b64_tr_b16 v[46:47], v16 offset:256
    v_lshlrev_b32 v192, 16, v108
    v_and_b32 v193, s58, v108
    v_lshlrev_b32 v194, 16, v109
    s_mul_i32 s3, s54, 1536
    v_mfma_f32_32x32x16_bf16 v[48:63], v[24:27], v[108:111], v[48:63]
    ds_read_b64_tr_b16 v[40:41], v14 offset:57344
    ds_read_b64_tr_b16 v[42:43], v14 offset:57600
    buffer_load_dwordx4 v3, s[4:7], s54 offen offset:0 lds
    buffer_load_dwordx4 v4, s[4:7], s54 offen offset:1024 lds
    v_and_b32 v195, s58, v109
    v_lshlrev_b32 v196, 16, v110
    v_and_b32 v197, s58, v110
    v_lshlrev_b32 v198, 16, v111
    v_and_b32 v199, s58, v111
    v_smfmac_f32_16x16x64_bf16 v[224:227], v[208:211], v[24:31], v212
    v_smfmac_f32_16x16x64_bf16 v[220:223], v[208:211], v[104:111], v212
    s_waitcnt lgkmcnt(5)
    v_mfma_f32_32x32x16_bf16 v[64:79], v[36:39], a[12:15], v[64:79]
    s_add_u32 m0, s56, 0
    ds_read_b128 a[16:19], v7 offset:49152
    ds_read_b64_tr_b16 v[28:29], v17 offset:0
    ds_read_b64_tr_b16 v[30:31], v17 offset:256
    v_fmac_f32 v20, v192, v192
    v_fmac_f32 v21, v193, v193
    v_fmac_f32 v20, v194, v194
    s_add_u32 s54, s54, 128
    v_mfma_f32_32x32x16_bf16 v[48:63], v[32:35], a[12:15], v[48:63]
    s_waitcnt lgkmcnt(3)
    ds_read_b64_tr_b16 v[24:25], v15 offset:57344
    ds_read_b64_tr_b16 v[26:27], v15 offset:57600
    buffer_load_dwordx4 v5, s[8:11], s3 offen offset:0 lds
    buffer_load_dwordx4 v18, s[8:11], s3 offen offset:1024 lds
    v_fmac_f32 v21, v195, v195
    v_fmac_f32 v20, v196, v196
    v_fmac_f32 v21, v197, v197
    v_fmac_f32 v20, v198, v198
    v_fmac_f32 v21, v199, v199
    v_mfma_f32_32x32x16_bf16 v[64:79], v[44:47], v[112:115], v[64:79]
    s_add_u32 m0, s56, 8192
    ds_read_b128 v[116:119], v8 offset:49152
    ds_read_b64_tr_b16 v[36:37], v16 offset:4096
    ds_read_b64_tr_b16 v[38:39], v16 offset:4352
    v_lshlrev_b32 v192, 16, v112
    v_and_b32 v193, s58, v112
    v_lshlrev_b32 v194, 16, v113
    s_and_b32 s54, s54, 1023
    v_mfma_f32_32x32x16_bf16 v[48:63], v[40:43], v[112:115], v[48:63]
    ds_read_b64_tr_b16 v[32:33], v14 offset:61440
    ds_read_b64_tr_b16 v[34:35], v14 offset:61696
    buffer_load_dwordx4 v19, s[8:11], s3 offen offset:0 lds
    buffer_load_dwordx4 v23, s[8:11], s3 offen offset:1024 lds
    v_and_b32 v195, s58, v113
    v_lshlrev_b32 v196, 16, v114
    v_and_b32 v197, s58, v114
    v_lshlrev_b32 v198, 16, v115
    v_and_b32 v199, s58, v115
    v_smfmac_f32_16x16x64_bf16 v[224:227], v[208:211], v[40:47], v212
    s_waitcnt lgkmcnt(5)
    v_mfma_f32_32x32x16_bf16 v[64:79], v[28:31], a[16:19], v[64:79]
    ds_read_b128 a[20:23], v9 offset:49152
    ds_read_b64_tr_b16 v[44:45], v17 offset:4096
    ds_read_b64_tr_b16 v[46:47], v17 offset:4352
    v_fmac_f32 v20, v192, v192
    v_fmac_f32 v21, v193, v193
    v_fmac_f32 v20, v194, v194
    v_mfma_f32_32x32x16_bf16 v[48:63], v[24:27], a[16:19], v[48:63]
    s_waitcnt lgkmcnt(3)
    ds_read_b64_tr_b16 v[40:41], v15 offset:61440
    ds_read_b64_tr_b16 v[42:43], v15 offset:61696
    v_fmac_f32 v21, v195, v195
    v_fmac_f32 v20, v196, v196
    v_fmac_f32 v21, v197, v197
    v_fmac_f32 v20, v198, v198
    v_fmac_f32 v21, v199, v199
    v_mfma_f32_32x32x16_bf16 v[64:79], v[36:39], v[116:119], v[64:79]
    s_waitcnt vmcnt(12)
    s_barrier
    s_add_u32 m0, s56, 16384
    ds_read_b128 v[120:123], v10 offset:8192
    ds_read_b64_tr_b16 v[28:29], v16 offset:24576
    ds_read_b64_tr_b16 v[30:31], v16 offset:24832
    v_lshlrev_b32 v192, 16, v116
    v_and_b32 v193, s58, v116
    v_lshlrev_b32 v194, 16, v117
    s_mul_i32 s1, s54, 1536
    v_mfma_f32_32x32x16_bf16 v[48:63], v[32:35], v[116:119], v[48:63]
    ds_read_b64_tr_b16 v[24:25], v16 offset:16384
    ds_read_b64_tr_b16 v[26:27], v16 offset:16640
    buffer_load_dwordx4 v3, s[4:7], s54 offen offset:0 lds
    buffer_load_dwordx4 v4, s[4:7], s54 offen offset:1024 lds
    v_and_b32 v195, s58, v117
    v_lshlrev_b32 v196, 16, v118
    v_and_b32 v197, s58, v118
    v_lshlrev_b32 v198, 16, v119
    v_and_b32 v199, s58, v119
    v_smfmac_f32_16x16x64_bf16 v[224:227], v[208:211], v[32:39], v212
    v_smfmac_f32_16x16x64_bf16 v[220:223], v[208:211], v[112:119], v212
    s_waitcnt lgkmcnt(5)
    v_mfma_f32_32x32x16_bf16 v[64:79], v[44:47], a[20:23], v[64:79]
    s_add_u32 m0, s56, 24576
    ds_read_b128 a[24:27], v11 offset:8192
    ds_read_b64_tr_b16 v[36:37], v17 offset:24576
    ds_read_b64_tr_b16 v[38:39], v17 offset:24832
    v_fmac_f32 v20, v192, v192
    v_fmac_f32 v21, v193, v193
    v_fmac_f32 v20, v194, v194
    s_add_u32 s54, s54, 128
    v_mfma_f32_32x32x16_bf16 v[48:63], v[40:43], a[20:23], v[48:63]
    s_waitcnt lgkmcnt(3)
    ds_read_b64_tr_b16 v[32:33], v17 offset:16384
    ds_read_b64_tr_b16 v[34:35], v17 offset:16640
    buffer_load_dwordx4 v5, s[8:11], s1 offen offset:0 lds
    buffer_load_dwordx4 v18, s[8:11], s1 offen offset:1024 lds
    v_fmac_f32 v21, v195, v195
    v_fmac_f32 v20, v196, v196
    v_fmac_f32 v21, v197, v197
    v_fmac_f32 v20, v198, v198
    v_fmac_f32 v21, v199, v199
    v_mfma_f32_32x32x16_bf16 v[64:79], v[28:31], v[120:123], v[64:79]
    s_add_u32 m0, s56, 32768
    ds_read_b128 v[124:127], v12 offset:8192
    ds_read_b64_tr_b16 v[44:45], v16 offset:28672
    ds_read_b64_tr_b16 v[46:47], v16 offset:28928
    v_lshlrev_b32 v192, 16, v120
    v_and_b32 v193, s58, v120
    v_lshlrev_b32 v194, 16, v121
    s_and_b32 s54, s54, 1023
    v_mfma_f32_32x32x16_bf16 v[48:63], v[24:27], v[120:123], v[48:63]
    ds_read_b64_tr_b16 v[40:41], v16 offset:20480
    ds_read_b64_tr_b16 v[42:43], v16 offset:20736
    buffer_load_dwordx4 v19, s[8:11], s1 offen offset:0 lds
    buffer_load_dwordx4 v23, s[8:11], s1 offen offset:1024 lds
    v_and_b32 v195, s58, v121
    v_lshlrev_b32 v196, 16, v122
    v_and_b32 v197, s58, v122
    v_lshlrev_b32 v198, 16, v123
    v_and_b32 v199, s58, v123
    v_smfmac_f32_16x16x64_bf16 v[224:227], v[208:211], v[24:31], v212
    s_waitcnt lgkmcnt(5)
    v_mfma_f32_32x32x16_bf16 v[64:79], v[36:39], a[24:27], v[64:79]
    ds_read_b128 a[28:31], v13 offset:8192
    ds_read_b64_tr_b16 v[28:29], v17 offset:28672
    ds_read_b64_tr_b16 v[30:31], v17 offset:28928
    v_fmac_f32 v20, v192, v192
    v_fmac_f32 v21, v193, v193
    v_fmac_f32 v20, v194, v194
    v_mfma_f32_32x32x16_bf16 v[48:63], v[32:35], a[24:27], v[48:63]
    s_waitcnt lgkmcnt(3)
    ds_read_b64_tr_b16 v[24:25], v17 offset:20480
    ds_read_b64_tr_b16 v[26:27], v17 offset:20736
    v_fmac_f32 v21, v195, v195
    v_fmac_f32 v20, v196, v196
    v_fmac_f32 v21, v197, v197
    v_fmac_f32 v20, v198, v198
    v_fmac_f32 v21, v199, v199
    v_mfma_f32_32x32x16_bf16 v[64:79], v[44:47], v[124:127], v[64:79]
    s_waitcnt vmcnt(12)
L_pad_0:
    s_cbranch_execz L_pad_4
    s_barrier
    s_add_u32 m0, s56, 40960
    ds_read_b128 v[128:131], v10 offset:32768
    ds_read_b64_tr_b16 v[36:37], v16 offset:49152
    ds_read_b64_tr_b16 v[38:39], v16 offset:49408
    v_lshlrev_b32 v192, 16, v124
    v_and_b32 v193, s58, v124
    v_lshlrev_b32 v194, 16, v125
    s_mul_i32 s0, s54, 1536
    v_mfma_f32_32x32x16_bf16 v[48:63], v[40:43], v[124:127], v[48:63]
    ds_read_b64_tr_b16 v[32:33], v16 offset:40960
    ds_read_b64_tr_b16 v[34:35], v16 offset:41216
    buffer_load_dwordx4 v3, s[4:7], s54 offen offset:0 lds
    buffer_load_dwordx4 v4, s[4:7], s54 offen offset:1024 lds
    v_and_b32 v195, s58, v125
    v_lshlrev_b32 v196, 16, v126
    v_and_b32 v197, s58, v126
    v_lshlrev_b32 v198, 16, v127
    v_and_b32 v199, s58, v127
    v_smfmac_f32_16x16x64_bf16 v[224:227], v[208:211], v[40:47], v212
    v_smfmac_f32_16x16x64_bf16 v[220:223], v[208:211], v[120:127], v212
    s_waitcnt lgkmcnt(5)
    v_mfma_f32_32x32x16_bf16 v[64:79], v[28:31], a[28:31], v[64:79]
    s_add_u32 m0, s56, 49152
    ds_read_b128 a[32:35], v11 offset:32768
    ds_read_b64_tr_b16 v[44:45], v17 offset:49152
    ds_read_b64_tr_b16 v[46:47], v17 offset:49408
    v_fmac_f32 v20, v192, v192
    v_fmac_f32 v21, v193, v193
    v_fmac_f32 v20, v194, v194
    s_add_u32 s54, s54, 128
    v_mfma_f32_32x32x16_bf16 v[48:63], v[24:27], a[28:31], v[48:63]
    s_waitcnt lgkmcnt(3)
    ds_read_b64_tr_b16 v[40:41], v17 offset:40960
    ds_read_b64_tr_b16 v[42:43], v17 offset:41216
    buffer_load_dwordx4 v5, s[8:11], s0 offen offset:0 lds
    buffer_load_dwordx4 v18, s[8:11], s0 offen offset:1024 lds
    v_fmac_f32 v21, v195, v195
    v_fmac_f32 v20, v196, v196
    v_fmac_f32 v21, v197, v197
    v_fmac_f32 v20, v198, v198
    v_fmac_f32 v21, v199, v199
    v_mfma_f32_32x32x16_bf16 v[64:79], v[36:39], v[128:131], v[64:79]
    s_add_u32 m0, s56, 57344
    ds_read_b128 v[132:135], v12 offset:32768
    ds_read_b64_tr_b16 v[28:29], v16 offset:53248
    ds_read_b64_tr_b16 v[30:31], v16 offset:53504
    v_lshlrev_b32 v192, 16, v128
    v_and_b32 v193, s58, v128
    v_lshlrev_b32 v194, 16, v129
    s_and_b32 s54, s54, 1023
    v_mfma_f32_32x32x16_bf16 v[48:63], v[32:35], v[128:131], v[48:63]
    ds_read_b64_tr_b16 v[24:25], v16 offset:45056
    ds_read_b64_tr_b16 v[26:27], v16 offset:45312
    buffer_load_dwordx4 v19, s[8:11], s0 offen offset:0 lds
    buffer_load_dwordx4 v23, s[8:11], s0 offen offset:1024 lds
    v_and_b32 v195, s58, v129
    v_lshlrev_b32 v196, 16, v130
    v_and_b32 v197, s58, v130
    v_lshlrev_b32 v198, 16, v131
    v_and_b32 v199, s58, v131
    v_smfmac_f32_16x16x64_bf16 v[224:227], v[208:211], v[32:39], v212
    s_waitcnt lgkmcnt(5)
    v_mfma_f32_32x32x16_bf16 v[64:79], v[44:47], a[32:35], v[64:79]
    ds_read_b128 a[36:39], v13 offset:32768
    ds_read_b64_tr_b16 v[36:37], v17 offset:53248
    ds_read_b64_tr_b16 v[38:39], v17 offset:53504
    v_fmac_f32 v20, v192, v192
    v_fmac_f32 v21, v193, v193
    v_fmac_f32 v20, v194, v194
    v_mfma_f32_32x32x16_bf16 v[48:63], v[40:43], a[32:35], v[48:63]
    s_waitcnt lgkmcnt(3)
    ds_read_b64_tr_b16 v[32:33], v17 offset:45056
    ds_read_b64_tr_b16 v[34:35], v17 offset:45312
    v_fmac_f32 v21, v195, v195
    v_fmac_f32 v20, v196, v196
    v_fmac_f32 v21, v197, v197
    v_fmac_f32 v20, v198, v198
    v_fmac_f32 v21, v199, v199
    v_mfma_f32_32x32x16_bf16 v[64:79], v[28:31], v[132:135], v[64:79]
    s_waitcnt vmcnt(12)
    s_barrier
    s_add_u32 m0, s56, 65536
    ds_read_b128 v[136:139], v10 offset:57344
    ds_read_b64_tr_b16 v[44:45], v14 offset:8192
    ds_read_b64_tr_b16 v[46:47], v14 offset:8448
    v_lshlrev_b32 v192, 16, v132
    v_and_b32 v193, s58, v132
    v_lshlrev_b32 v194, 16, v133
    v_add_u32 v5, 2048, v5
    v_add_u32 v18, 2048, v18
    v_mfma_f32_32x32x16_bf16 v[48:63], v[24:27], v[132:135], v[48:63]
    ds_read_b64_tr_b16 v[40:41], v14 offset:0
    ds_read_b64_tr_b16 v[42:43], v14 offset:256
    buffer_load_dwordx4 v5, s[8:11], s96 offen offset:0 lds
    buffer_load_dwordx4 v18, s[8:11], s96 offen offset:1024 lds
    v_and_b32 v195, s58, v133
    v_lshlrev_b32 v196, 16, v134
    v_and_b32 v197, s58, v134
    v_lshlrev_b32 v198, 16, v135
    v_and_b32 v199, s58, v135
    v_smfmac_f32_16x16x64_bf16 v[224:227], v[208:211], v[24:31], v212
    v_smfmac_f32_16x16x64_bf16 v[220:223], v[208:211], v[128:135], v212
    s_waitcnt lgkmcnt(5)
    v_mfma_f32_32x32x16_bf16 v[64:79], v[36:39], a[36:39], v[64:79]
    s_add_u32 m0, s56, 73728
    ds_read_b128 a[40:43], v11 offset:57344
    ds_read_b64_tr_b16 v[28:29], v15 offset:8192
    ds_read_b64_tr_b16 v[30:31], v15 offset:8448
    v_fmac_f32 v20, v192, v192
    v_fmac_f32 v21, v193, v193
    v_fmac_f32 v20, v194, v194
    v_mfma_f32_32x32x16_bf16 v[48:63], v[32:35], a[36:39], v[48:63]
    s_waitcnt lgkmcnt(3)
    ds_read_b64_tr_b16 v[24:25], v15 offset:0
    ds_read_b64_tr_b16 v[26:27], v15 offset:256
    buffer_load_dwordx4 v5, s[8:11], s95 offen offset:0 lds
    buffer_load_dwordx4 v18, s[8:11], s95 offen offset:1024 lds
    v_fmac_f32 v21, v195, v195
    v_fmac_f32 v20, v196, v196
    v_fmac_f32 v21, v197, v197
    v_fmac_f32 v20, v198, v198
    v_fmac_f32 v21, v199, v199
    v_mfma_f32_32x32x16_bf16 v[64:79], v[44:47], v[136:139], v[64:79]
    s_add_u32 m0, s56, 81920
    ds_read_b128 v[140:143], v12 offset:57344
    ds_read_b64_tr_b16 v[36:37], v14 offset:12288
    ds_read_b64_tr_b16 v[38:39], v14 offset:12544
    v_lshlrev_b32 v192, 16, v136
    v_and_b32 v193, s58, v136
    v_lshlrev_b32 v194, 16, v137
    v_mfma_f32_32x32x16_bf16 v[48:63], v[40:43], v[136:139], v[48:63]
    ds_read_b64_tr_b16 v[32:33], v14 offset:4096
    ds_read_b64_tr_b16 v[34:35], v14 offset:4352
    buffer_load_dwordx4 v5, s[8:11], s94 offen offset:0 lds
    buffer_load_dwordx4 v18, s[8:11], s94 offen offset:1024 lds
    v_and_b32 v195, s58, v137
    v_lshlrev_b32 v196, 16, v138
    v_and_b32 v197, s58, v138
    v_lshlrev_b32 v198, 16, v139
    v_and_b32 v199, s58, v139
    v_smfmac_f32_16x16x64_bf16 v[224:227], v[208:211], v[40:47], v212
    s_waitcnt lgkmcnt(5)
    v_mfma_f32_32x32x16_bf16 v[64:79], v[28:31], a[40:43], v[64:79]
    ds_read_b128 a[44:47], v13 offset:57344
    ds_read_b64_tr_b16 v[44:45], v15 offset:12288
    ds_read_b64_tr_b16 v[46:47], v15 offset:12544
    v_fmac_f32 v20, v192, v192
    v_fmac_f32 v21, v193, v193
    v_fmac_f32 v20, v194, v194
    v_mfma_f32_32x32x16_bf16 v[48:63], v[24:27], a[40:43], v[48:63]
    s_waitcnt lgkmcnt(3)
    ds_read_b64_tr_b16 v[40:41], v15 offset:4096
    ds_read_b64_tr_b16 v[42:43], v15 offset:4352
    v_fmac_f32 v21, v195, v195
    v_fmac_f32 v20, v196, v196
    v_fmac_f32 v21, v197, v197
    v_fmac_f32 v20, v198, v198
    v_fmac_f32 v21, v199, v199
    v_mfma_f32_32x32x16_bf16 v[64:79], v[36:39], v[140:143], v[64:79]
    s_waitcnt vmcnt(6) lgkmcnt(0)
    s_barrier
    s_add_u32 m0, s56, 90112
    ds_read_b128 v[144:147], v6 offset:16384
    ds_read_b64_tr_b16 v[28:29], v14 offset:32768
    ds_read_b64_tr_b16 v[30:31], v14 offset:33024
    v_lshlrev_b32 v192, 16, v140
    v_and_b32 v193, s58, v140
    v_lshlrev_b32 v194, 16, v141
    v_mfma_f32_32x32x16_bf16 v[48:63], v[32:35], v[140:143], v[48:63]
    ds_read_b64_tr_b16 v[24:25], v14 offset:24576
    ds_read_b64_tr_b16 v[26:27], v14 offset:24832
    buffer_load_dwordx4 v5, s[8:11], s93 offen offset:0 lds
    buffer_load_dwordx4 v18, s[8:11], s93 offen offset:1024 lds
    v_and_b32 v195, s58, v141
    v_lshlrev_b32 v196, 16, v142
    v_and_b32 v197, s58, v142
    v_lshlrev_b32 v198, 16, v143
    v_and_b32 v199, s58, v143
    v_smfmac_f32_16x16x64_bf16 v[224:227], v[208:211], v[32:39], v212
    v_smfmac_f32_16x16x64_bf16 v[220:223], v[208:211], v[136:143], v212
    v_mfma_f32_32x32x16_bf16 v[64:79], v[44:47], a[44:47], v[64:79]
    s_add_u32 m0, s56, 98304
    ds_read_b128 a[48:51], v7 offset:16384
    ds_read_b64_tr_b16 v[36:37], v15 offset:32768
    ds_read_b64_tr_b16 v[38:39], v15 offset:33024
    v_fmac_f32 v20, v192, v192
    v_fmac_f32 v21, v193, v193
    v_fmac_f32 v20, v194, v194
    v_mfma_f32_32x32x16_bf16 v[48:63], v[40:43], a[44:47], v[48:63]
    s_waitcnt lgkmcnt(3)
    ds_read_b64_tr_b16 v[32:33], v15 offset:24576
    ds_read_b64_tr_b16 v[34:35], v15 offset:24832
    buffer_load_dwordx4 v5, s[8:11], s92 offen offset:0 lds
    buffer_load_dwordx4 v18, s[8:11], s92 offen offset:1024 lds
    v_fmac_f32 v21, v195, v195
    v_fmac_f32 v20, v196, v196
    v_fmac_f32 v21, v197, v197
    v_fmac_f32 v20, v198, v198
    v_fmac_f32 v21, v199, v199
    v_mfma_f32_32x32x16_bf16 v[64:79], v[28:31], v[144:147], v[64:79]
    s_add_u32 m0, s56, 106496
    ds_read_b128 v[148:151], v8 offset:16384
    ds_read_b64_tr_b16 v[44:45], v14 offset:36864
    ds_read_b64_tr_b16 v[46:47], v14 offset:37120
    v_lshlrev_b32 v192, 16, v144
    v_and_b32 v193, s58, v144
    v_lshlrev_b32 v194, 16, v145
    v_mfma_f32_32x32x16_bf16 v[48:63], v[24:27], v[144:147], v[48:63]
    ds_read_b64_tr_b16 v[40:41], v14 offset:28672
    ds_read_b64_tr_b16 v[42:43], v14 offset:28928
    buffer_load_dwordx4 v5, s[8:11], s3 offen offset:0 lds
    buffer_load_dwordx4 v18, s[8:11], s3 offen offset:1024 lds
    v_and_b32 v195, s58, v145
    v_lshlrev_b32 v196, 16, v146
    v_and_b32 v197, s58, v146
    v_lshlrev_b32 v198, 16, v147
    v_and_b32 v199, s58, v147
    v_smfmac_f32_16x16x64_bf16 v[224:227], v[208:211], v[24:31], v212
    s_waitcnt lgkmcnt(5)
    v_mfma_f32_32x32x16_bf16 v[64:79], v[36:39], a[48:51], v[64:79]
    s_add_u32 m0, s56, 114688
    ds_read_b128 a[52:55], v9 offset:16384
    ds_read_b64_tr_b16 v[28:29], v15 offset:36864
    ds_read_b64_tr_b16 v[30:31], v15 offset:37120
    v_fmac_f32 v20, v192, v192
    v_fmac_f32 v21, v193, v193
    v_fmac_f32 v20, v194, v194
    v_mfma_f32_32x32x16_bf16 v[48:63], v[32:35], a[48:51], v[48:63]
    s_waitcnt lgkmcnt(3)
    ds_read_b64_tr_b16 v[24:25], v15 offset:28672
    ds_read_b64_tr_b16 v[26:27], v15 offset:28928
    buffer_load_dwordx4 v5, s[8:11], s1 offen offset:0 lds
    buffer_load_dwordx4 v18, s[8:11], s1 offen offset:1024 lds
    v_fmac_f32 v21, v195, v195
    v_fmac_f32 v20, v196, v196
    v_fmac_f32 v21, v197, v197
    v_fmac_f32 v20, v198, v198
    v_fmac_f32 v21, v199, v199
    v_mfma_f32_32x32x16_bf16 v[64:79], v[44:47], v[148:151], v[64:79]
    s_add_u32 m0, s56, 122880
    ds_read_b128 v[152:155], v6 offset:40960
    ds_read_b64_tr_b16 v[36:37], v14 offset:57344
    ds_read_b64_tr_b16 v[38:39], v14 offset:57600
    v_lshlrev_b32 v192, 16, v148
    v_and_b32 v193, s58, v148
    v_lshlrev_b32 v194, 16, v149
    v_mfma_f32_32x32x16_bf16 v[48:63], v[40:43], v[148:151], v[48:63]
    ds_read_b64_tr_b16 v[32:33], v14 offset:49152
    ds_read_b64_tr_b16 v[34:35], v14 offset:49408
    buffer_load_dwordx4 v5, s[8:11], s0 offen offset:0 lds
    buffer_load_dwordx4 v18, s[8:11], s0 offen offset:1024 lds
    v_and_b32 v195, s58, v149
    v_lshlrev_b32 v196, 16, v150
    v_and_b32 v197, s58, v150
    v_lshlrev_b32 v198, 16, v151
    v_and_b32 v199, s58, v151
    v_smfmac_f32_16x16x64_bf16 v[224:227], v[208:211], v[40:47], v212
    v_smfmac_f32_16x16x64_bf16 v[220:223], v[208:211], v[144:151], v212
    s_waitcnt lgkmcnt(5)
    v_mfma_f32_32x32x16_bf16 v[64:79], v[28:31], a[52:55], v[64:79]
    ds_read_b128 v[156:159], v8 offset:40960
    ds_read_b64_tr_b16 v[44:45], v14 offset:61440
    ds_read_b64_tr_b16 v[46:47], v14 offset:61696
    v_fmac_f32 v20, v192, v192
    v_fmac_f32 v21, v193, v193
    v_fmac_f32 v20, v194, v194
    v_mfma_f32_32x32x16_bf16 v[48:63], v[24:27], a[52:55], v[48:63]
    s_waitcnt lgkmcnt(3)
    ds_read_b64_tr_b16 v[40:41], v14 offset:53248
    ds_read_b64_tr_b16 v[42:43], v14 offset:53504
    buffer_store_dword v237, v236, s[12:15], 0 offen sc1
    v_fmac_f32 v21, v195, v195
    v_fmac_f32 v20, v196, v196
    v_fmac_f32 v21, v197, v197
    v_fmac_f32 v20, v198, v198
    v_fmac_f32 v21, v199, v199
    v_mfma_f32_32x32x16_bf16 v[64:79], v[36:39], v[152:155], v[64:79]
    ds_read_b128 a[56:59], v7 offset:40960
    ds_read_b64_tr_b16 v[28:29], v15 offset:57344
    ds_read_b64_tr_b16 v[30:31], v15 offset:57600
    v_lshlrev_b32 v192, 16, v152
    v_and_b32 v193, s58, v152
    v_lshlrev_b32 v194, 16, v153
    v_mfma_f32_32x32x16_bf16 v[48:63], v[32:35], v[152:155], v[48:63]
    ds_read_b64_tr_b16 v[24:25], v15 offset:49152
    ds_read_b64_tr_b16 v[26:27], v15 offset:49408
    v_and_b32 v195, s58, v153
    v_lshlrev_b32 v196, 16, v154
    v_and_b32 v197, s58, v154
    v_lshlrev_b32 v198, 16, v155
    v_and_b32 v199, s58, v155
    v_smfmac_f32_16x16x64_bf16 v[224:227], v[208:211], v[32:39], v212
    s_waitcnt lgkmcnt(5)
    v_mfma_f32_32x32x16_bf16 v[64:79], v[44:47], v[156:159], v[64:79]
    ds_read_b128 a[60:63], v9 offset:40960
    ds_read_b64_tr_b16 v[36:37], v15 offset:61440
    ds_read_b64_tr_b16 v[38:39], v15 offset:61696
    v_fmac_f32 v20, v192, v192
    v_fmac_f32 v21, v193, v193
    v_fmac_f32 v20, v194, v194
    v_mfma_f32_32x32x16_bf16 v[48:63], v[40:43], v[156:159], v[48:63]
    ds_read_b64_tr_b16 v[32:33], v15 offset:53248
    ds_read_b64_tr_b16 v[34:35], v15 offset:53504
    v_fmac_f32 v21, v195, v195
    v_fmac_f32 v20, v196, v196
    v_fmac_f32 v21, v197, v197
    v_fmac_f32 v20, v198, v198
    v_fmac_f32 v21, v199, v199
    v_lshlrev_b32 v200, 16, v156
    v_and_b32 v201, s58, v156
    v_lshlrev_b32 v202, 16, v157
    v_and_b32 v203, s58, v157
    v_lshlrev_b32 v204, 16, v158
    v_and_b32 v205, s58, v158
    v_lshlrev_b32 v206, 16, v159
    v_and_b32 v207, s58, v159
    v_smfmac_f32_16x16x64_bf16 v[224:227], v[208:211], v[40:47], v212
    v_smfmac_f32_16x16x64_bf16 v[220:223], v[208:211], v[152:159], v212
    s_waitcnt lgkmcnt(5)
    v_mfma_f32_32x32x16_bf16 v[64:79], v[28:31], a[56:59], v[64:79]
    s_waitcnt vmcnt(13)
    s_barrier
    ds_read_b64_tr_b16 v[160:161], v16 offset:0
    ds_read_b64_tr_b16 v[162:163], v16 offset:256
    ds_read_b64_tr_b16 v[164:165], v17 offset:0
    v_fmac_f32 v20, v200, v200
    v_fmac_f32 v21, v201, v201
    v_fmac_f32 v20, v202, v202
    v_mfma_f32_32x32x16_bf16 v[48:63], v[24:27], a[56:59], v[48:63]
    s_waitcnt lgkmcnt(3)
    ds_read_b64_tr_b16 v[166:167], v17 offset:256
    ds_read_b64_tr_b16 v[168:169], v16 offset:4096
    ds_read_b64_tr_b16 v[170:171], v16 offset:4352
    v_fmac_f32 v21, v203, v203
    v_fmac_f32 v20, v204, v204
    v_fmac_f32 v21, v205, v205
    v_fmac_f32 v20, v206, v206
    v_fmac_f32 v21, v207, v207
    v_mfma_f32_32x32x16_bf16 v[64:79], v[36:39], a[60:63], v[64:79]
    ds_read_b64_tr_b16 v[172:173], v17 offset:4096
    ds_read_b64_tr_b16 v[174:175], v17 offset:4352
    ds_read_b64_tr_b16 v[176:177], v16 offset:8192
    v_add_f32 v220, v220, v221
    v_add_f32 v20, v20, v21
    v_add_f32 v224, v224, v225
    v_mfma_f32_32x32x16_bf16 v[48:63], v[32:35], a[60:63], v[48:63]
    s_waitcnt lgkmcnt(7)
    ds_read_b64_tr_b16 v[178:179], v16 offset:8448
    ds_read_b64_tr_b16 v[180:181], v17 offset:8192
    ds_read_b64_tr_b16 v[182:183], v17 offset:8448
    ds_write_b32 v213, v220
    ds_write_b32 v213, v20 offset:256
    ds_write_b32 v213, v224 offset:512
    v_mfma_f32_32x32x16_bf16 v[80:95], v[96:99], v[160:163], 0
    s_waitcnt lgkmcnt(9)
    ds_read_b64_tr_b16 v[184:185], v16 offset:12288
    ds_read_b64_tr_b16 v[186:187], v16 offset:12544
    v_mfma_f32_32x32x16_bf16 v[80:95], a[0:3], v[164:167], v[80:95]
    s_waitcnt lgkmcnt(9)
    ds_read_b64_tr_b16 v[188:189], v17 offset:12288
    ds_read_b64_tr_b16 v[190:191], v17 offset:12544
    v_smfmac_f32_16x16x64_bf16 v[228:231], v[208:211], v[160:167], v212
    v_mfma_f32_32x32x16_bf16 v[80:95], v[100:103], v[168:171], v[80:95]
    s_waitcnt lgkmcnt(9)
    s_waitcnt vmcnt(1) lgkmcnt(4)
    s_barrier
    ds_read_b64_tr_b16 v[160:161], v16 offset:16384
    ds_read_b64_tr_b16 v[162:163], v16 offset:16640
    ds_read_b32 v24, v216 offset:512
    ds_read2_b32 v[26:27], v214 offset0:0 offset1:32
    ds_read2_b32 v[28:29], v215 offset0:0 offset1:32
    ds_read2_b32 v[30:31], v214 offset0:64 offset1:96
    v_mfma_f32_32x32x16_bf16 v[80:95], a[4:7], v[172:175], v[80:95]
    ds_read_b64_tr_b16 v[164:165], v17 offset:16384
    ds_read_b64_tr_b16 v[166:167], v17 offset:16640
    ds_read2_b32 v[32:33], v215 offset0:64 offset1:96
    v_smfmac_f32_16x16x64_bf16 v[228:231], v[208:211], v[168:175], v212
    s_waitcnt lgkmcnt(6)
    v_add_f32 v224, v224, v24
    v_mfma_f32_32x32x16_bf16 v[80:95], v[104:107], v[176:179], v[80:95]
    ds_read_b64_tr_b16 v[168:169], v16 offset:20480
    ds_read_b64_tr_b16 v[170:171], v16 offset:20736
    ds_write_b32 v213, v224 offset:768
    ds_read_b128 v[192:195], v217 offset:896
    ds_read_b128 v[196:199], v217 offset:928
    ds_read_b128 v[200:203], v217 offset:960
    v_mfma_f32_32x32x16_bf16 v[80:95], a[8:11], v[180:183], v[80:95]
    ds_read_b64_tr_b16 v[172:173], v17 offset:20480
    ds_read_b64_tr_b16 v[174:175], v17 offset:20736
    ds_read_b128 v[204:207], v217 offset:992
    s_waitcnt lgkmcnt(14)
    v_add_f32 v26, v26, v27
    s_waitcnt lgkmcnt(13)
    v_add_f32 v28, v28, v29
    s_waitcnt lgkmcnt(12)
    v_add_f32 v30, v30, v31
    v_smfmac_f32_16x16x64_bf16 v[228:231], v[208:211], v[176:183], v212
    s_waitcnt lgkmcnt(9)
    v_add_f32 v32, v32, v33
    v_mfma_f32_32x32x16_bf16 v[80:95], v[108:111], v[184:187], v[80:95]
    ds_read_b64_tr_b16 v[176:177], v16 offset:24576
    ds_read_b64_tr_b16 v[178:179], v16 offset:24832
    v_add_f32 v26, v26, v28
    v_add_f32 v20, v30, v32
    v_mul_f32 v22, 0xbb000000, v26
    v_mul_f32 v20, 0x3b000000, v20
    v_mfma_f32_32x32x16_bf16 v[80:95], a[12:15], v[188:191], v[80:95]
    ds_read_b64_tr_b16 v[180:181], v17 offset:24576
    ds_read_b64_tr_b16 v[182:183], v17 offset:24832
    v_fma_f32 v20, -v22, v22, v20
    v_max_f32 v20, 0, v20
    v_add_f32 v20, 0x3727c5ac, v20
    v_rsq_f32 v232, v20
    v_smfmac_f32_16x16x64_bf16 v[228:231], v[208:211], v[184:191], v212
    ds_write_b32 v214, v22 offset:1024
    v_mfma_f32_32x32x16_bf16 v[80:95], v[112:115], v[160:163], v[80:95]
    s_waitcnt lgkmcnt(12)
    ds_read_b64_tr_b16 v[184:185], v16 offset:28672
    ds_read_b64_tr_b16 v[186:187], v16 offset:28928
    ds_write_b32 v214, v232 offset:1152
    v_mul_f32 v233, 0x3eb8aa3b, v232
    s_waitcnt lgkmcnt(13)
    v_fmac_f32 v64, v192, v22
    v_fmac_f32 v65, v193, v22
    v_mfma_f32_32x32x16_bf16 v[80:95], a[16:19], v[164:167], v[80:95]
    s_waitcnt lgkmcnt(9)
    ds_read_b64_tr_b16 v[188:189], v17 offset:28672
    ds_read_b64_tr_b16 v[190:191], v17 offset:28928
    v_fmac_f32 v66, v194, v22
    v_fmac_f32 v67, v195, v22
    v_fmac_f32 v68, v196, v22
    v_fmac_f32 v69, v197, v22
    v_smfmac_f32_16x16x64_bf16 v[228:231], v[208:211], v[160:167], v212
    v_fmac_f32 v70, v198, v22
    v_mfma_f32_32x32x16_bf16 v[80:95], v[116:119], v[168:171], v[80:95]
    s_waitcnt lgkmcnt(8)
    ds_read_b64_tr_b16 v[160:161], v16 offset:32768
    ds_read_b64_tr_b16 v[162:163], v16 offset:33024
    v_fmac_f32 v71, v199, v22
    ds_read_b128 v[192:195], v217 offset:768
    ds_read_b128 v[196:199], v217 offset:800
    v_mul_f32 v64, v64, v232
    v_mfma_f32_32x32x16_bf16 v[80:95], a[20:23], v[172:175], v[80:95]
    s_waitcnt lgkmcnt(10)
    ds_read_b64_tr_b16 v[164:165], v17 offset:32768
    ds_read_b64_tr_b16 v[166:167], v17 offset:33024
    v_mul_f32 v65, v65, v232
    v_mul_f32 v66, v66, v232
    v_mul_f32 v67, v67, v232
    v_mul_f32 v68, v68, v232
    v_smfmac_f32_16x16x64_bf16 v[228:231], v[208:211], v[168:175], v212
    v_mul_f32 v69, v69, v232
    v_mfma_f32_32x32x16_bf16 v[80:95], v[120:123], v[176:179], v[80:95]
    s_waitcnt lgkmcnt(9)
    ds_read_b64_tr_b16 v[168:169], v16 offset:36864
    ds_read_b64_tr_b16 v[170:171], v16 offset:37120
    v_mul_f32 v70, v70, v232
    v_mul_f32 v71, v71, v232
    v_cvt_pk_bf16_f32 v240, v64, v65
    v_cvt_pk_bf16_f32 v241, v66, v67
    v_mfma_f32_32x32x16_bf16 v[80:95], a[24:27], v[180:183], v[80:95]
    s_waitcnt lgkmcnt(8)
    ds_read_b64_tr_b16 v[172:173], v17 offset:36864
    ds_read_b64_tr_b16 v[174:175], v17 offset:37120
    v_cvt_pk_bf16_f32 v242, v68, v69
    v_cvt_pk_bf16_f32 v243, v70, v71
    s_add_u32 s47, s59, 2097152
    buffer_store_dwordx4 v[240:243], v218, s[12:15], s47 offen sc1
    v_smfmac_f32_16x16x64_bf16 v[228:231], v[208:211], v[176:183], v212
    v_fmac_f32 v72, v200, v22
    v_mfma_f32_32x32x16_bf16 v[80:95], v[124:127], v[184:187], v[80:95]
    s_waitcnt lgkmcnt(8)
    ds_read_b64_tr_b16 v[176:177], v16 offset:40960
    ds_read_b64_tr_b16 v[178:179], v16 offset:41216
    v_fmac_f32 v73, v201, v22
    v_fmac_f32 v74, v202, v22
    v_fmac_f32 v75, v203, v22
    v_fmac_f32 v76, v204, v22
    v_mfma_f32_32x32x16_bf16 v[80:95], a[28:31], v[188:191], v[80:95]
    s_waitcnt lgkmcnt(6)
    ds_read_b64_tr_b16 v[180:181], v17 offset:40960
    ds_read_b64_tr_b16 v[182:183], v17 offset:41216
    v_fmac_f32 v77, v205, v22
    v_fmac_f32 v78, v206, v22
    v_fmac_f32 v79, v207, v22
    ds_read_b128 v[200:203], v217 offset:832
    v_smfmac_f32_16x16x64_bf16 v[228:231], v[208:211], v[184:191], v212
    ds_read_b128 v[204:207], v217 offset:864
    v_mfma_f32_32x32x16_bf16 v[80:95], v[128:131], v[160:163], v[80:95]
    s_waitcnt lgkmcnt(8)
    ds_read_b64_tr_b16 v[184:185], v16 offset:45056
    ds_read_b64_tr_b16 v[186:187], v16 offset:45312
    v_mul_f32 v72, v72, v232
    v_mul_f32 v73, v73, v232
    v_mul_f32 v74, v74, v232
    v_mul_f32 v75, v75, v232
    v_mfma_f32_32x32x16_bf16 v[80:95], a[32:35], v[164:167], v[80:95]
    s_waitcnt lgkmcnt(8)
    ds_read_b64_tr_b16 v[188:189], v17 offset:45056
    ds_read_b64_tr_b16 v[190:191], v17 offset:45312
    v_mul_f32 v76, v76, v232
    v_mul_f32 v77, v77, v232
    v_mul_f32 v78, v78, v232
    v_mul_f32 v79, v79, v232
    v_smfmac_f32_16x16x64_bf16 v[228:231], v[208:211], v[160:167], v212
    v_cvt_pk_bf16_f32 v244, v72, v73
    v_mfma_f32_32x32x16_bf16 v[80:95], v[132:135], v[168:171], v[80:95]
    s_waitcnt lgkmcnt(8)
    ds_read_b64_tr_b16 v[160:161], v16 offset:49152
    ds_read_b64_tr_b16 v[162:163], v16 offset:49408
    v_cvt_pk_bf16_f32 v245, v74, v75
    v_cvt_pk_bf16_f32 v246, v76, v77
    v_cvt_pk_bf16_f32 v247, v78, v79
    s_add_u32 s47, s59, 2162688
    v_mfma_f32_32x32x16_bf16 v[80:95], a[36:39], v[172:175], v[80:95]
    s_waitcnt lgkmcnt(8)
    ds_read_b64_tr_b16 v[164:165], v17 offset:49152
    ds_read_b64_tr_b16 v[166:167], v17 offset:49408
    buffer_store_dwordx4 v[244:247], v218, s[12:15], s47 offen sc1
    v_fmac_f32 v48, v192, v22
    v_fmac_f32 v49, v193, v22
    v_fmac_f32 v50, v194, v22
    v_smfmac_f32_16x16x64_bf16 v[228:231], v[208:211], v[168:175], v212
    v_fmac_f32 v51, v195, v22
    v_mfma_f32_32x32x16_bf16 v[80:95], v[136:139], v[176:179], v[80:95]
    s_waitcnt lgkmcnt(6)
    ds_read_b64_tr_b16 v[168:169], v16 offset:53248
    ds_read_b64_tr_b16 v[170:171], v16 offset:53504
    v_fmac_f32 v52, v196, v22
    v_fmac_f32 v53, v197, v22
    v_fmac_f32 v54, v198, v22
    v_fmac_f32 v55, v199, v22
    v_mfma_f32_32x32x16_bf16 v[80:95], a[40:43], v[180:183], v[80:95]
    s_waitcnt lgkmcnt(6)
    ds_read_b64_tr_b16 v[172:173], v17 offset:53248
    ds_read_b64_tr_b16 v[174:175], v17 offset:53504
    v_mul_f32 v48, v48, v233
    v_mul_f32 v49, v49, v233
    v_mul_f32 v50, v50, v233
    v_mul_f32 v51, v51, v233
    v_smfmac_f32_16x16x64_bf16 v[228:231], v[208:211], v[176:183], v212
    v_mul_f32 v52, v52, v233
    v_mfma_f32_32x32x16_bf16 v[80:95], v[140:143], v[184:187], v[80:95]
    s_waitcnt lgkmcnt(6)
    ds_read_b64_tr_b16 v[176:177], v16 offset:57344
    ds_read_b64_tr_b16 v[178:179], v16 offset:57600
    v_mul_f32 v53, v53, v233
    v_mul_f32 v54, v54, v233
    v_mul_f32 v55, v55, v233
    v_cvt_pk_bf16_f32 v240, v48, v49
    v_mfma_f32_32x32x16_bf16 v[80:95], a[44:47], v[188:191], v[80:95]
    s_waitcnt lgkmcnt(6)
    ds_read_b64_tr_b16 v[180:181], v16 offset:61440
    ds_read_b64_tr_b16 v[182:183], v16 offset:61696
    v_cvt_pk_bf16_f32 v241, v50, v51
    v_cvt_pk_bf16_f32 v242, v52, v53
    v_cvt_pk_bf16_f32 v243, v54, v55
    s_add_u32 s47, s59, 0
    v_smfmac_f32_16x16x64_bf16 v[228:231], v[208:211], v[184:191], v212
    buffer_store_dwordx4 v[240:243], v2, s[12:15], s47 offen sc1
    v_mfma_f32_32x32x16_bf16 v[80:95], v[144:147], v[160:163], v[80:95]
    s_waitcnt lgkmcnt(6)
    ds_read_b64_tr_b16 v[184:185], v17 offset:57344
    ds_read_b64_tr_b16 v[186:187], v17 offset:57600
    v_fmac_f32 v56, v200, v22
    v_fmac_f32 v57, v201, v22
    v_fmac_f32 v58, v202, v22
    v_fmac_f32 v59, v203, v22
    v_mfma_f32_32x32x16_bf16 v[80:95], a[48:51], v[164:167], v[80:95]
    s_waitcnt lgkmcnt(6)
    ds_read_b64_tr_b16 v[188:189], v17 offset:61440
    ds_read_b64_tr_b16 v[190:191], v17 offset:61696
    v_fmac_f32 v60, v204, v22
    v_fmac_f32 v61, v205, v22
    v_fmac_f32 v62, v206, v22
    v_fmac_f32 v63, v207, v22
    v_smfmac_f32_16x16x64_bf16 v[228:231], v[208:211], v[160:167], v212
    v_mul_f32 v56, v56, v233
    v_mfma_f32_32x32x16_bf16 v[80:95], v[148:151], v[168:171], v[80:95]
    s_waitcnt lgkmcnt(6)
    v_mul_f32 v57, v57, v233
    v_mul_f32 v58, v58, v233
    v_mul_f32 v59, v59, v233
    v_mul_f32 v60, v60, v233
    v_mul_f32 v61, v61, v233
    v_mul_f32 v62, v62, v233
    v_mfma_f32_32x32x16_bf16 v[80:95], a[52:55], v[172:175], v[80:95]
    s_waitcnt lgkmcnt(4)
    v_mul_f32 v63, v63, v233
    v_cvt_pk_bf16_f32 v244, v56, v57
    v_cvt_pk_bf16_f32 v245, v58, v59
    v_cvt_pk_bf16_f32 v246, v60, v61
    v_cvt_pk_bf16_f32 v247, v62, v63
    s_add_u32 s47, s59, 65536
    v_smfmac_f32_16x16x64_bf16 v[228:231], v[208:211], v[168:175], v212
    buffer_store_dwordx4 v[244:247], v2, s[12:15], s47 offen sc1
    v_mfma_f32_32x32x16_bf16 v[80:95], v[152:155], v[176:179], v[80:95]
    s_waitcnt lgkmcnt(2)
    ds_read_b128 v[64:67], v217 offset:1024
    ds_read_b128 v[24:27], v217 offset:1152
    ds_read_b128 v[68:71], v217 offset:1056
    ds_read_b128 v[28:31], v217 offset:1184
    ds_read_b128 v[72:75], v217 offset:1088
    ds_read_b128 v[32:35], v217 offset:1216
    v_mfma_f32_32x32x16_bf16 v[80:95], v[156:159], v[180:183], v[80:95]
    s_waitcnt lgkmcnt(6)
    ds_read_b128 v[76:79], v217 offset:1120
    ds_read_b128 v[36:39], v217 offset:1248
    v_smfmac_f32_16x16x64_bf16 v[228:231], v[208:211], v[176:183], v212
    v_smfmac_f32_16x16x64_bf16 v[228:231], v[208:211], v[184:191], v212
    v_mfma_f32_32x32x16_bf16 v[80:95], a[56:59], v[184:187], v[80:95]
    v_mfma_f32_32x32x16_bf16 v[80:95], a[60:63], v[188:191], v[80:95]
    s_nop 5
    v_add_f32 v228, v228, v229
    v_mov_b32 v230, v228
    s_add_u32 s47, s59, 4194304
    s_nop 0
    v_permlane32_swap_b32 v230, v228
    v_add_f32 v228, v228, v230
    s_waitcnt lgkmcnt(7)
    v_pk_fma_f32 v[80:81], v[64:65], v[228:229], v[80:81] op_sel_hi:[1,0,1]
    v_pk_fma_f32 v[82:83], v[66:67], v[228:229], v[82:83] op_sel_hi:[1,0,1]
    s_waitcnt lgkmcnt(5)
    v_pk_fma_f32 v[84:85], v[68:69], v[228:229], v[84:85] op_sel_hi:[1,0,1]
    v_pk_fma_f32 v[86:87], v[70:71], v[228:229], v[86:87] op_sel_hi:[1,0,1]
    v_pk_mul_f32 v[80:81], v[80:81], v[24:25]
    v_pk_mul_f32 v[82:83], v[82:83], v[26:27]
    s_waitcnt lgkmcnt(4)
    v_pk_mul_f32 v[84:85], v[84:85], v[28:29]
    v_pk_mul_f32 v[86:87], v[86:87], v[30:31]
    v_cvt_pk_bf16_f32 v96, v80, v81
    v_cvt_pk_bf16_f32 v97, v82, v83
    v_cvt_pk_bf16_f32 v98, v84, v85
    v_cvt_pk_bf16_f32 v99, v86, v87
    buffer_store_dwordx4 v[96:99], v219, s[12:15], s47 offen offset:0 sc1
    s_waitcnt lgkmcnt(3)
    v_pk_fma_f32 v[88:89], v[72:73], v[228:229], v[88:89] op_sel_hi:[1,0,1]
    v_pk_fma_f32 v[90:91], v[74:75], v[228:229], v[90:91] op_sel_hi:[1,0,1]
    s_waitcnt lgkmcnt(1)
    v_pk_fma_f32 v[92:93], v[76:77], v[228:229], v[92:93] op_sel_hi:[1,0,1]
    v_pk_fma_f32 v[94:95], v[78:79], v[228:229], v[94:95] op_sel_hi:[1,0,1]
    v_pk_mul_f32 v[88:89], v[88:89], v[32:33]
    v_pk_mul_f32 v[90:91], v[90:91], v[34:35]
    s_waitcnt lgkmcnt(0)
    v_pk_mul_f32 v[92:93], v[92:93], v[36:37]
    v_pk_mul_f32 v[94:95], v[94:95], v[38:39]
    v_cvt_pk_bf16_f32 v100, v88, v89
    v_cvt_pk_bf16_f32 v101, v90, v91
    v_cvt_pk_bf16_f32 v102, v92, v93
    v_cvt_pk_bf16_f32 v103, v94, v95
    buffer_store_dwordx4 v[100:103], v219, s[12:15], s47 offen offset:512 sc1
    s_and_b32 s46, s41, 1
    s_and_b32 s47, s42, 3
    s_lshl2_add_u32 s43, s46, s47
    s_lshl_b32 s58, s40, 12
    s_add_u32 s58, s58, 90112
    s_lshl3_add_u32 s57, 0, s40
    s_lshl_b32 s57, s57, 15
    s_lshl_b32 s46, s43, 7
L_pad_1:
    s_cbranch_execz L_pad_5
    s_add_u32 s57, s57, s46
    v_bfe_u32 v140, v1, 2, 3
    v_lshlrev_b32 v140, 10, v140
    v_lshrrev_b32 v20, 5, v1
    v_lshl_add_u32 v140, v20, 6, v140
    v_and_b32 v20, 3, v1
    v_lshl_add_u32 v140, v20, 4, v140
    v_add_u32 v141, 7168, v140
    v_add_u32 v142, 14336, v140
    v_add_u32 v143, 21504, v140
    s_lshl_b32 s50, s41, 2
    s_and_b32 s46, s42, 3
    s_add_u32 s50, s50, s46
    s_lshr_b32 s51, s42, 2
    s_lshl_b32 s51, s51, 2
    s_add_u32 s51, s51, s40
    s_lshl_b32 s52, s50, 16
    s_lshl_b32 s61, s51, 11
    s_add_u32 s61, s61, s52
    s_lshl_b32 s53, s40, 11
    s_add_u32 s52, s52, s53
    s_add_u32 s52, s52, 2097152
    s_lshr_b32 s46, s40, 1
    s_mul_i32 s46, s46, 96
    s_add_u32 s54, s53, s46
    v_add_u32 v153, 2097152, v2
    v_and_b32 v20, 1, v1
    v_cmp_eq_u32 vcc, 0, v20
    v_mov_b32 v21, 0x3f803f80
    s_nop 0
    v_cndmask_b32 v24, 0, v21, vcc
    v_bfe_u32 v21, v1, 1, 2
    v_mul_u32_u24 v21, 4192, v21
    v_lshl_add_u32 v21, v20, 4, v21
    v_and_b32 v20, 8, v1
    v_lshl_add_u32 v21, v20, 3, v21
    v_mov_b32 v25, v24
    v_mov_b32 v26, v24
    v_mov_b32 v27, v24
    ds_write_b128 v21, v[24:27] offset:20480
    s_mul_i32 s56, s40, 12288
    s_add_u32 s56, s56, 33280
    v_and_b32 v20, 15, v1
    v_lshlrev_b32 v20, 4, v20
    v_lshrrev_b32 v21, 5, v1
    v_lshl_add_u32 v20, v21, 8, v20
    s_and_b32 s46, s40, 1
    v_lshl_add_u32 v200, s46, 12, v2
    s_mul_i32 s46, s46, 4192
    s_add_u32 s46, s46, 16384
    v_add_u32 v20, s46, v20
    s_add_u32 s46, s46, 4096
    v_and_b32 v21, 11, v1
    v_min_u32 v21, 1, v21
    v_lshlrev_b32 v21, 4, v21
    v_add_u32 v21, s46, v21
    v_add_u32 v22, 4, v1
    v_and_b32 v22, 8, v22
    v_lshl_add_u32 v21, v22, 3, v21
    v_and_b32 v22, 16, v1
    v_cmp_eq_u32 vcc, 0, v22
    v_mov_b32 v3, 0xdddd
    s_mov_b32 s55, 0
    v_cndmask_b32 v12, v21, v20, vcc
    v_add_u32 v20, 512, v20
    v_cndmask_b32 v13, v21, v20, vcc
    v_add_u32 v20, 512, v20
    v_cndmask_b32 v14, v21, v20, vcc
    v_add_u32 v20, 512, v20
    v_cndmask_b32 v15, v21, v20, vcc
    v_add_u32 v20, 512, v20
    v_cndmask_b32 v16, v21, v20, vcc
    v_add_u32 v20, 512, v20
    v_cndmask_b32 v17, v21, v20, vcc
    v_add_u32 v20, 512, v20
    v_cndmask_b32 v18, v21, v20, vcc
    v_add_u32 v20, 512, v20
    v_cndmask_b32 v19, v21, v20, vcc
    v_pk_mov_b32 v[44:45], 0, 0
    v_pk_mov_b32 v[160:161], 0, 0
    v_pk_mov_b32 v[46:47], 0, 0
    v_pk_mov_b32 v[162:163], 0, 0
    v_pk_mov_b32 v[48:49], 0, 0
    v_pk_mov_b32 v[164:165], 0, 0
    v_pk_mov_b32 v[50:51], 0, 0
    v_pk_mov_b32 v[166:167], 0, 0
    v_pk_mov_b32 v[52:53], 0, 0
    v_pk_mov_b32 v[168:169], 0, 0
    v_pk_mov_b32 v[54:55], 0, 0
    v_pk_mov_b32 v[170:171], 0, 0
    v_pk_mov_b32 v[56:57], 0, 0
    v_pk_mov_b32 v[172:173], 0, 0
    v_pk_mov_b32 v[58:59], 0, 0
    v_pk_mov_b32 v[174:175], 0, 0
    v_pk_mov_b32 v[60:61], 0, 0
    v_pk_mov_b32 v[176:177], 0, 0
    v_pk_mov_b32 v[62:63], 0, 0
    v_pk_mov_b32 v[178:179], 0, 0
    v_pk_mov_b32 v[64:65], 0, 0
    v_pk_mov_b32 v[180:181], 0, 0
    v_pk_mov_b32 v[66:67], 0, 0
    v_pk_mov_b32 v[182:183], 0, 0
    v_pk_mov_b32 v[68:69], 0, 0
    v_pk_mov_b32 v[184:185], 0, 0
    v_pk_mov_b32 v[70:71], 0, 0
    v_pk_mov_b32 v[186:187], 0, 0
    v_pk_mov_b32 v[72:73], 0, 0
    v_pk_mov_b32 v[188:189], 0, 0
    v_pk_mov_b32 v[74:75], 0, 0
    v_pk_mov_b32 v[190:191], 0, 0
    v_add_u32 v201, s56, v2
    s_xor_b32 s46, s40, 1
    s_mul_i32 s46, s46, 12288
    s_add_u32 s46, s46, 33280
    v_add_u32 v202, s46, v2
    v_mov_b32 v22, s44
    v_mov_b32 v23, s45
    s_cmp_lg_u32 s40, 0
    s_waitcnt vmcnt(0)
    s_barrier
    s_cbranch_scc1 L_nosig_2
    s_mov_b64 exec, 15
    buffer_atomic_swap_x2 v[22:23], v254, s[12:15], s48 offen sc1
    s_mov_b64 exec, -1
L_nosig_2:
    s_and_b32 s59, s42, 3
    s_lshl3_add_u32 s59, s59, s41
    s_lshl2_add_u32 s59, s59, s40
    s_lshl_b32 s59, s59, 7
    s_add_u32 s59, s59, 15204352
    s_mov_b64 exec, 255
    v_mov_b32 v146, 0
    v_mov_b32 v147, 0
    buffer_atomic_or_x2 v[146:147], v255, s[12:15], s59 offen sc0 sc1
    s_mov_b64 exec, -1
    s_mov_b64 exec, 0
    s_cmp_eq_u32 s40, 1
    s_cbranch_scc1 L_pad_1
    s_cmp_eq_u32 s40, 2
    s_cbranch_scc1 L_pad_2
    s_cmp_eq_u32 s40, 3
    s_cbranch_scc1 L_pad_3
    s_branch L_pad_0
L_pad_ret:
    s_mov_b64 exec, -1
    s_mov_b64 exec, 255
    s_waitcnt vmcnt(0)
    v_cmp_ne_u64 vcc, s[44:45], v[146:147]
    s_mov_b32 s49, 0
    s_cbranch_vccz L_seen_5
L_poll_3:
    v_mov_b32 v146, 0
    v_mov_b32 v147, 0
    buffer_atomic_or_x2 v[146:147], v255, s[12:15], s59 offen sc0 sc1
    s_add_u32 s49, s49, 1
    s_waitcnt vmcnt(0)
    v_cmp_ne_u64 vcc, s[44:45], v[146:147]
    s_nop 0
    s_cbranch_vccz L_seen_5
    s_cmp_lt_u32 s49, 131072
    s_cbranch_scc1 L_poll_3
L_seen_5:
    s_mov_b64 exec, -1
    s_add_u32 m0, s53, 0
    s_nop 0
    buffer_load_dwordx4 v2, s[12:15], s52 offen offset:0 sc1 lds
    buffer_load_dwordx4 v2, s[12:15], s52 offen offset:1024 sc1 lds
    s_add_u32 m0, s54, 16384
    s_nop 0
    buffer_load_dwordx4 v153, s[12:15], s52 offen offset:0 sc1 lds
    buffer_load_dwordx4 v153, s[12:15], s52 offen offset:1024 sc1 lds
    s_mov_b32 m0, s56
    s_nop 0
    buffer_load_dwordx4 v2, s[12:15], s61 offen sc1 lds
    buffer_load_dwordx4 v2, s[12:15], s61 offen offset:1024 sc1 lds
    s_add_u32 m0, s53, 8192
    s_add_u32 s52, s52, 8192
    buffer_load_dwordx4 v2, s[12:15], s52 offen offset:0 sc1 lds
    buffer_load_dwordx4 v2, s[12:15], s52 offen offset:1024 sc1 lds
    s_add_u32 m0, s54, 24768
    s_nop 0
    buffer_load_dwordx4 v153, s[12:15], s52 offen offset:0 sc1 lds
    buffer_load_dwordx4 v153, s[12:15], s52 offen offset:1024 sc1 lds
    s_and_b32 s47, s42, 3
    s_lshr_b32 s46, s42, 2
    s_lshl1_add_u32 s99, s47, s46
    s_add_u32 s98, s99, s41
    s_and_b32 s98, s98, 7
    s_sub_u32 s47, s99, 7
    s_cselect_b32 s99, s99, s47
    s_lshr_b32 s47, s41, 1
    s_lshl3_add_u32 s97, s47, s46
    s_mul_i32 s96, s47, 7
    s_min_u32 s46, s46, 6
    s_add_u32 s96, s96, s46
    s_and_b32 s98, s41, 6
    s_and_b32 s99, s41, 6
    s_mul_i32 s94, s40, 1835008
    s_lshl_b32 s46, s96, 7
    s_add_u32 s94, s94, s46
    s_add_u32 s95, s94, 1835008
    s_mul_i32 s93, s98, 229376
    s_add_u32 s93, s93, s94
    v_bfe_u32 v148, v1, 2, 3
    v_mul_u32_u24 v148, 3584, v148
    v_lshrrev_b32 v150, 5, v1
    v_lshrrev_b32 v149, 7, v0
    v_xor_b32 v149, v149, v150
    v_lshl_add_u32 v148, v149, 6, v148
    v_lshlrev_b32 v150, 10, v150
    v_and_b32 v149, 3, v1
    v_lshl_add_u32 v148, v149, 4, v148
    v_lshl_add_u32 v150, v149, 3, v150
    v_bfe_u32 v149, v1, 2, 2
    v_lshl_add_u32 v150, v149, 6, v150
    v_and_b32 v149, 16, v1
    v_mad_u32_u24 v150, v149, 18, v150
    v_lshlrev_b32 v149, 1, v149
    v_xor_b32 v148, v148, v149
    v_add_u32 v149, 27648, v148
    v_add_u32 v150, s56, v150
    v_xor_b32 v156, 32, v150
    s_mul_i32 s101, s40, 1835008
    s_lshl_b32 s46, s97, 7
    s_add_u32 s101, s101, s46
    s_add_u32 s3, s101, 1835008
    s_mul_i32 s100, s99, 262144
    s_add_u32 s100, s100, s101
    s_lshl_b32 s92, s40, 11
    s_add_u32 s92, s92, 49152
    v_bfe_u32 v250, v1, 2, 3
    v_mul_u32_u24 v250, 4096, v250
    v_lshrrev_b32 v252, 5, v1
    v_lshrrev_b32 v251, 7, v0
    v_xor_b32 v251, v251, v252
    v_lshl_add_u32 v250, v251, 6, v250
    v_lshlrev_b32 v252, 10, v252
    v_and_b32 v251, 3, v1
    v_lshl_add_u32 v250, v251, 4, v250
    v_lshl_add_u32 v252, v251, 3, v252
    v_bfe_u32 v251, v1, 2, 2
    v_lshl_add_u32 v252, v251, 6, v252
    v_and_b32 v251, 16, v1
    v_mad_u32_u24 v252, v251, 18, v252
    v_lshlrev_b32 v251, 1, v251
    v_xor_b32 v250, v250, v251
    v_add_u32 v251, 31744, v250
    v_add_u32 v252, s92, v252
    v_add_u32 v253, 57344, v252
    v_xor_b32 v244, 32, v252
    v_xor_b32 v245, 32, v253
    s_lshl_b32 s46, s43, 7
    s_lshl2_add_u32 s48, s97, s40
    s_lshl_b32 s48, s48, 14
    s_add_u32 s48, s48, s46
    v_lshrrev_b32 v20, 3, v1
    v_lshl_add_u32 v20, v20, 10, s48
    v_lshrrev_b32 v21, 4, v1
    v_and_b32 v22, 7, v1
    v_xor_b32 v21, v21, v22
    v_lshl_add_u32 v151, v21, 4, v20
    v_xor_b32 v21, 4, v21
    v_lshl_add_u32 v152, v21, 4, v20
    v_add_u32 v152, 7168, v152
    s_and_b32 s62, s40, 1
    s_lshr_b32 s63, s40, 1
    s_lshl1_add_u32 s47, s97, s63
    s_lshl_b32 s9, s43, 6
    s_add_u32 s9, s9, s47
    s_lshl1_add_u32 s9, s9, s62
    s_lshl_b32 s9, s9, 11
    s_add_u32 s9, s9, 10485760
    s_lshl1_add_u32 s47, s96, s63
    s_mul_i32 s10, s43, 56
    s_add_u32 s10, s10, s47
    s_lshl1_add_u32 s10, s10, s62
    s_lshl_b32 s10, s10, 11
    s_add_u32 s10, s10, 12582912
    s_cmp_ge_u32 s42, 28
    s_cselect_b32 s10, 16777216, s10
    s_lshl_b32 s8, s51, 6
    s_add_u32 s8, s8, s50
    s_lshl_b32 s8, s8, 10
    s_add_u32 s8, s8, 6291456
    s_mov_b32 s11, 131072
    v_mov_b32 v236, -1
    v_mov_b32 v237, -1
    v_mov_b32 v238, -1
    v_mov_b32 v239, -1
    s_lshr_b32 s63, s40, 1
    s_lshl1_add_u32 s47, s96, s63
    s_lshl_b32 s47, s47, 6
    v_lshrrev_b32 v20, 4, v1
    v_lshl_add_u32 v154, v20, 3, s47
    s_lshl1_add_u32 s47, s97, s63
    s_lshl_b32 s47, s47, 6
    v_and_b32 v20, 31, v1
    v_lshl_add_u32 v155, v20, 1, s47
    s_lshl2_add_u32 s60, s42, s40
    s_mul_i32 s60, s60, 57344
    s_lshr_b32 s46, s41, 1
    s_lshl_b32 s46, s46, 10
    s_add_u32 s60, s60, s46
    v_lshrrev_b32 v20, 5, v1
    v_bfe_u32 v21, v1, 2, 3
    v_lshlrev_b32 v144, 12, v20
    v_lshl_add_u32 v144, v21, 7, v144
    s_lshl_b32 s59, s40, 8
    s_add_u32 s59, s59, s42
    s_mul_i32 s59, s59, 7168
    s_lshr_b32 s46, s41, 1
    s_mul_i32 s46, s46, 896
    s_add_u32 s59, s59, s46
    v_mul_u32_u24 v157, 3584, v20
    v_min_u32 v21, 6, v21
    v_lshl_add_u32 v157, v21, 7, v157
    s_lshl2_add_u32 s46, s42, s40
    s_lshl_b32 s46, s46, 12
    s_and_b32 s47, s41, 1
    s_lshl_b32 s47, s47, 9
    s_add_u32 s46, s46, s47
    v_lshrrev_b32 v20, 4, v1
    v_lshl_add_u32 v20, v20, 10, s46
    v_bfe_u32 v21, v1, 2, 2
    v_lshl_add_u32 v158, v21, 7, v20
    s_waitcnt vmcnt(4) lgkmcnt(0)
    s_barrier
    ds_read_b128 v[20:23], v200 offset:0
    ds_read_b128 v[204:207], v202 offset:0
    ds_read_b128 v[208:211], v202 offset:1024
    ds_read_b128 v[4:7], v201 offset:0
    ds_read_b128 v[8:11], v201 offset:1024
    ds_read_b128 v[28:31], v12 offset:0
    ds_read_b128 v[36:39], v13 offset:0
    s_waitcnt lgkmcnt(5)
    v_mfma_f32_32x32x16_bf16 v[76:91], v[20:23], v[204:207], 0
    s_nop 11
    v_exp_f32 v76, v76
    s_waitcnt lgkmcnt(4)
    v_mfma_f32_32x32x16_bf16 v[92:107], v[20:23], v[208:211], 0
    s_waitcnt lgkmcnt(0)
    v_exp_f32 v77, v77
    v_exp_f32 v78, v78
    v_exp_f32 v79, v79
    v_exp_f32 v80, v80
    v_exp_f32 v81, v81
    v_exp_f32 v82, v82
    v_exp_f32 v83, v83
    v_exp_f32 v84, v84
    v_exp_f32 v85, v85
    v_exp_f32 v86, v86
    v_smfmac_f32_32x32x32_bf16 v[160:175], v[28:31], v[76:83], v3
    buffer_load_dword v145, v157, s[20:23], s59 offen
    v_exp_f32 v87, v87
    v_exp_f32 v88, v88
    v_exp_f32 v89, v89
    v_exp_f32 v90, v90
    v_exp_f32 v91, v91
    v_exp_f32 v92, v92
    v_mfma_f32_32x32x16_bf16 v[108:123], v[20:23], v[4:7], 0
    v_exp_f32 v93, v93
    v_exp_f32 v94, v94
    v_exp_f32 v95, v95
    v_exp_f32 v96, v96
    v_exp_f32 v97, v97
    v_smfmac_f32_32x32x32_bf16 v[160:175], v[36:39], v[84:91], v3
    v_exp_f32 v98, v98
    v_exp_f32 v99, v99
    v_exp_f32 v100, v100
    v_exp_f32 v101, v101
    v_exp_f32 v102, v102
    v_smfmac_f32_32x32x32_bf16 v[176:191], v[28:31], v[92:99], v3
    v_exp_f32 v103, v103
    v_exp_f32 v104, v104
    v_exp_f32 v105, v105
    v_exp_f32 v106, v106
    v_exp_f32 v107, v107
    v_exp_f32 v108, v108
    v_mfma_f32_32x32x16_bf16 v[124:139], v[20:23], v[8:11], 0
    ds_read_b128 v[24:27], v200 offset:1024
    v_exp_f32 v109, v109
    v_exp_f32 v110, v110
    v_exp_f32 v111, v111
    v_exp_f32 v112, v112
    v_exp_f32 v113, v113
    v_smfmac_f32_32x32x32_bf16 v[176:191], v[36:39], v[100:107], v3
    v_exp_f32 v114, v114
    v_exp_f32 v115, v115
    v_exp_f32 v116, v116
    v_exp_f32 v117, v117
    v_exp_f32 v118, v118
    v_smfmac_f32_32x32x32_bf16 v[44:59], v[28:31], v[108:115], v3
    s_waitcnt lgkmcnt(0)
    v_exp_f32 v119, v119
    v_exp_f32 v120, v120
    v_exp_f32 v121, v121
    v_exp_f32 v122, v122
    v_exp_f32 v123, v123
    v_exp_f32 v124, v124
    v_mfma_f32_32x32x16_bf16 v[76:91], v[24:27], v[204:207], 0
    ds_read_b128 v[32:35], v14 offset:0
    v_exp_f32 v125, v125
    v_exp_f32 v126, v126
    v_exp_f32 v127, v127
    v_exp_f32 v128, v128
    v_exp_f32 v129, v129
    v_smfmac_f32_32x32x32_bf16 v[44:59], v[36:39], v[116:123], v3
    s_add_u32 s59, s59, 229376
    ds_read_b128 v[40:43], v15 offset:0
    v_exp_f32 v130, v130
    v_exp_f32 v131, v131
    v_exp_f32 v132, v132
    v_exp_f32 v133, v133
    v_exp_f32 v134, v134
    v_smfmac_f32_32x32x32_bf16 v[60:75], v[28:31], v[124:131], v3
    buffer_load_dword v145, v157, s[20:23], s59 offen
    v_exp_f32 v135, v135
    v_exp_f32 v136, v136
    v_exp_f32 v137, v137
    v_exp_f32 v138, v138
    v_exp_f32 v139, v139
    v_exp_f32 v76, v76
    v_mfma_f32_32x32x16_bf16 v[92:107], v[24:27], v[208:211], 0
    s_waitcnt lgkmcnt(0)
    v_exp_f32 v77, v77
    v_exp_f32 v78, v78
    v_exp_f32 v79, v79
    v_exp_f32 v80, v80
    v_exp_f32 v81, v81
    v_smfmac_f32_32x32x32_bf16 v[60:75], v[36:39], v[132:139], v3
    v_exp_f32 v82, v82
    v_exp_f32 v83, v83
    v_exp_f32 v84, v84
    v_exp_f32 v85, v85
    v_exp_f32 v86, v86
    v_smfmac_f32_32x32x32_bf16 v[160:175], v[32:35], v[76:83], v3
    v_exp_f32 v87, v87
    v_exp_f32 v88, v88
    v_exp_f32 v89, v89
    v_exp_f32 v90, v90
    v_exp_f32 v91, v91
    v_exp_f32 v92, v92
    v_mfma_f32_32x32x16_bf16 v[108:123], v[24:27], v[4:7], 0
    v_exp_f32 v93, v93
    v_exp_f32 v94, v94
    v_exp_f32 v95, v95
    v_exp_f32 v96, v96
    v_exp_f32 v97, v97
    v_smfmac_f32_32x32x32_bf16 v[160:175], v[40:43], v[84:91], v3
    v_exp_f32 v98, v98
    v_exp_f32 v99, v99
    v_exp_f32 v100, v100
    v_exp_f32 v101, v101
    v_exp_f32 v102, v102
    v_smfmac_f32_32x32x32_bf16 v[176:191], v[32:35], v[92:99], v3
    v_exp_f32 v103, v103
    v_exp_f32 v104, v104
    v_exp_f32 v105, v105
    v_exp_f32 v106, v106
    v_exp_f32 v107, v107
    v_exp_f32 v108, v108
    v_mfma_f32_32x32x16_bf16 v[124:139], v[24:27], v[8:11], 0
    ds_read_b128 v[20:23], v200 offset:2048
    v_exp_f32 v109, v109
    v_exp_f32 v110, v110
    v_exp_f32 v111, v111
    v_exp_f32 v112, v112
    v_exp_f32 v113, v113
    v_smfmac_f32_32x32x32_bf16 v[176:191], v[40:43], v[100:107], v3
    s_add_u32 s59, s59, 229376
    v_exp_f32 v114, v114
    v_exp_f32 v115, v115
    v_exp_f32 v116, v116
    v_exp_f32 v117, v117
    v_exp_f32 v118, v118
    v_smfmac_f32_32x32x32_bf16 v[44:59], v[32:35], v[108:115], v3
    s_waitcnt lgkmcnt(0)
    buffer_load_dword v145, v157, s[20:23], s59 offen
    v_exp_f32 v119, v119
    v_exp_f32 v120, v120
    v_exp_f32 v121, v121
    v_exp_f32 v122, v122
    v_exp_f32 v123, v123
    v_exp_f32 v124, v124
    v_mfma_f32_32x32x16_bf16 v[76:91], v[20:23], v[204:207], 0
    ds_read_b128 v[28:31], v16 offset:0
    v_exp_f32 v125, v125
    v_exp_f32 v126, v126
    v_exp_f32 v127, v127
    v_exp_f32 v128, v128
    v_exp_f32 v129, v129
    v_smfmac_f32_32x32x32_bf16 v[44:59], v[40:43], v[116:123], v3
    ds_read_b128 v[36:39], v17 offset:0
    v_exp_f32 v130, v130
    v_exp_f32 v131, v131
    v_exp_f32 v132, v132
    v_exp_f32 v133, v133
    v_exp_f32 v134, v134
    v_smfmac_f32_32x32x32_bf16 v[60:75], v[32:35], v[124:131], v3
    v_exp_f32 v135, v135
    v_exp_f32 v136, v136
    v_exp_f32 v137, v137
    v_exp_f32 v138, v138
    v_exp_f32 v139, v139
    v_exp_f32 v76, v76
    v_mfma_f32_32x32x16_bf16 v[92:107], v[20:23], v[208:211], 0
    s_waitcnt lgkmcnt(0)
    v_exp_f32 v77, v77
    v_exp_f32 v78, v78
    v_exp_f32 v79, v79
    v_exp_f32 v80, v80
    v_exp_f32 v81, v81
    v_smfmac_f32_32x32x32_bf16 v[60:75], v[40:43], v[132:139], v3
    v_exp_f32 v82, v82
    v_exp_f32 v83, v83
    v_exp_f32 v84, v84
    v_exp_f32 v85, v85
    v_exp_f32 v86, v86
    v_smfmac_f32_32x32x32_bf16 v[160:175], v[28:31], v[76:83], v3
    v_exp_f32 v87, v87
    v_exp_f32 v88, v88
    v_exp_f32 v89, v89
    v_exp_f32 v90, v90
    v_exp_f32 v91, v91
    v_exp_f32 v92, v92
    v_mfma_f32_32x32x16_bf16 v[108:123], v[20:23], v[4:7], 0
    v_exp_f32 v93, v93
    v_exp_f32 v94, v94
    v_exp_f32 v95, v95
    v_exp_f32 v96, v96
    v_exp_f32 v97, v97
    v_smfmac_f32_32x32x32_bf16 v[160:175], v[36:39], v[84:91], v3
    s_add_u32 s59, s59, 229376
    v_exp_f32 v98, v98
    v_exp_f32 v99, v99
    v_exp_f32 v100, v100
    v_exp_f32 v101, v101
    v_exp_f32 v102, v102
    v_smfmac_f32_32x32x32_bf16 v[176:191], v[28:31], v[92:99], v3
    buffer_load_dword v145, v157, s[20:23], s59 offen
    v_exp_f32 v103, v103
    v_exp_f32 v104, v104
    v_exp_f32 v105, v105
    v_exp_f32 v106, v106
    v_exp_f32 v107, v107
    v_exp_f32 v108, v108
    v_mfma_f32_32x32x16_bf16 v[124:139], v[20:23], v[8:11], 0
    ds_read_b128 v[24:27], v200 offset:3072
    v_exp_f32 v109, v109
    v_exp_f32 v110, v110
    v_exp_f32 v111, v111
    v_exp_f32 v112, v112
    v_exp_f32 v113, v113
    v_smfmac_f32_32x32x32_bf16 v[176:191], v[36:39], v[100:107], v3
    v_exp_f32 v114, v114
    v_exp_f32 v115, v115
    v_exp_f32 v116, v116
    v_exp_f32 v117, v117
    v_exp_f32 v118, v118
    v_smfmac_f32_32x32x32_bf16 v[44:59], v[28:31], v[108:115], v3
    s_waitcnt lgkmcnt(0)
    v_exp_f32 v119, v119
    v_exp_f32 v120, v120
    v_exp_f32 v121, v121
    v_exp_f32 v122, v122
    v_exp_f32 v123, v123
    v_exp_f32 v124, v124
    v_mfma_f32_32x32x16_bf16 v[76:91], v[24:27], v[204:207], 0
    ds_read_b128 v[32:35], v18 offset:0
    v_exp_f32 v125, v125
    v_exp_f32 v126, v126
    v_exp_f32 v127, v127
    v_exp_f32 v128, v128
    v_exp_f32 v129, v129
    v_smfmac_f32_32x32x32_bf16 v[44:59], v[36:39], v[116:123], v3
    ds_read_b128 v[40:43], v19 offset:0
    v_exp_f32 v130, v130
    v_exp_f32 v131, v131
    v_exp_f32 v132, v132
    v_exp_f32 v133, v133
    v_exp_f32 v134, v134
    v_smfmac_f32_32x32x32_bf16 v[60:75], v[28:31], v[124:131], v3
    v_exp_f32 v135, v135
    v_exp_f32 v136, v136
    v_exp_f32 v137, v137
    v_exp_f32 v138, v138
    v_exp_f32 v139, v139
    v_exp_f32 v76, v76
    v_mfma_f32_32x32x16_bf16 v[92:107], v[24:27], v[208:211], 0
    s_waitcnt lgkmcnt(0)
    v_exp_f32 v77, v77
    v_exp_f32 v78, v78
    v_exp_f32 v79, v79
    v_exp_f32 v80, v80
    v_exp_f32 v81, v81
    v_smfmac_f32_32x32x32_bf16 v[60:75], v[36:39], v[132:139], v3
    s_add_u32 s59, s59, 229376
    v_exp_f32 v82, v82
    v_exp_f32 v83, v83
    v_exp_f32 v84, v84
    v_exp_f32 v85, v85
    v_exp_f32 v86, v86
    v_smfmac_f32_32x32x32_bf16 v[160:175], v[32:35], v[76:83], v3
    buffer_load_dword v145, v157, s[20:23], s59 offen
    v_exp_f32 v87, v87
    v_exp_f32 v88, v88
    v_exp_f32 v89, v89
    v_exp_f32 v90, v90
    v_exp_f32 v91, v91
    v_exp_f32 v92, v92
    v_mfma_f32_32x32x16_bf16 v[108:123], v[24:27], v[4:7], 0
    v_exp_f32 v93, v93
    v_exp_f32 v94, v94
    v_exp_f32 v95, v95
    v_exp_f32 v96, v96
    v_exp_f32 v97, v97
    v_smfmac_f32_32x32x32_bf16 v[160:175], v[40:43], v[84:91], v3
    v_exp_f32 v98, v98
    v_exp_f32 v99, v99
    v_exp_f32 v100, v100
    v_exp_f32 v101, v101
    v_exp_f32 v102, v102
    v_smfmac_f32_32x32x32_bf16 v[176:191], v[32:35], v[92:99], v3
    v_exp_f32 v103, v103
    v_exp_f32 v104, v104
    v_exp_f32 v105, v105
    v_exp_f32 v106, v106
    v_exp_f32 v107, v107
    v_exp_f32 v108, v108
    v_mfma_f32_32x32x16_bf16 v[124:139], v[24:27], v[8:11], 0
    s_waitcnt vmcnt(5)
    s_barrier
    ds_read_b128 v[20:23], v200 offset:8192
    v_exp_f32 v109, v109
    v_exp_f32 v110, v110
    v_exp_f32 v111, v111
    v_exp_f32 v112, v112
    v_exp_f32 v113, v113
    v_smfmac_f32_32x32x32_bf16 v[176:191], v[40:43], v[100:107], v3
    s_add_u32 m0, s53, 0
    s_add_u32 s52, s52, 8192
    v_exp_f32 v114, v114
    v_exp_f32 v115, v115
    v_exp_f32 v116, v116
    v_exp_f32 v117, v117
    v_exp_f32 v118, v118
    v_smfmac_f32_32x32x32_bf16 v[44:59], v[32:35], v[108:115], v3
    s_waitcnt lgkmcnt(0)
    buffer_load_dwordx4 v2, s[12:15], s52 offen offset:0 sc1 lds
    buffer_load_dwordx4 v2, s[12:15], s52 offen offset:1024 sc1 lds
    v_exp_f32 v119, v119
    v_exp_f32 v120, v120
    v_exp_f32 v121, v121
    v_exp_f32 v122, v122
    v_exp_f32 v123, v123
    v_exp_f32 v124, v124
    v_mfma_f32_32x32x16_bf16 v[76:91], v[20:23], v[204:207], 0
    ds_read_b128 v[28:31], v12 offset:8384
    v_exp_f32 v125, v125
    v_exp_f32 v126, v126
    v_exp_f32 v127, v127
    v_exp_f32 v128, v128
    v_exp_f32 v129, v129
    v_smfmac_f32_32x32x32_bf16 v[44:59], v[40:43], v[116:123], v3
    s_add_u32 m0, s54, 16384
    ds_read_b128 v[36:39], v13 offset:8384
    v_exp_f32 v130, v130
    v_exp_f32 v131, v131
    v_exp_f32 v132, v132
    v_exp_f32 v133, v133
    v_exp_f32 v134, v134
    v_smfmac_f32_32x32x32_bf16 v[60:75], v[32:35], v[124:131], v3
    buffer_load_dwordx4 v153, s[12:15], s52 offen offset:0 sc1 lds
    buffer_load_dwordx4 v153, s[12:15], s52 offen offset:1024 sc1 lds
    v_exp_f32 v135, v135
    v_exp_f32 v136, v136
    v_exp_f32 v137, v137
    v_exp_f32 v138, v138
    v_exp_f32 v139, v139
    v_exp_f32 v76, v76
    v_mfma_f32_32x32x16_bf16 v[92:107], v[20:23], v[208:211], 0
    s_waitcnt lgkmcnt(0)
    v_exp_f32 v77, v77
    v_exp_f32 v78, v78
    v_exp_f32 v79, v79
    v_exp_f32 v80, v80
    v_exp_f32 v81, v81
    v_smfmac_f32_32x32x32_bf16 v[60:75], v[40:43], v[132:139], v3
    v_exp_f32 v82, v82
    v_exp_f32 v83, v83
    v_exp_f32 v84, v84
    v_exp_f32 v85, v85
    v_exp_f32 v86, v86
    v_smfmac_f32_32x32x32_bf16 v[160:175], v[28:31], v[76:83], v3
    buffer_load_dwordx2 v[240:241], v154, s[28:31], 0 offen offset:0
    buffer_load_dwordx2 v[242:243], v154, s[28:31], 0 offen offset:32
    v_exp_f32 v87, v87
    v_exp_f32 v88, v88
    v_exp_f32 v89, v89
    v_exp_f32 v90, v90
    v_exp_f32 v91, v91
    v_exp_f32 v92, v92
    v_mfma_f32_32x32x16_bf16 v[108:123], v[20:23], v[4:7], 0
    v_exp_f32 v93, v93
    v_exp_f32 v94, v94
    v_exp_f32 v95, v95
    v_exp_f32 v96, v96
    v_exp_f32 v97, v97
    v_smfmac_f32_32x32x32_bf16 v[160:175], v[36:39], v[84:91], v3
    s_add_u32 s59, s59, 229376
    v_exp_f32 v98, v98
    v_exp_f32 v99, v99
    v_exp_f32 v100, v100
    v_exp_f32 v101, v101
    v_exp_f32 v102, v102
    v_smfmac_f32_32x32x32_bf16 v[176:191], v[28:31], v[92:99], v3
    buffer_load_dword v145, v157, s[20:23], s59 offen
    v_exp_f32 v103, v103
    v_exp_f32 v104, v104
    v_exp_f32 v105, v105
    v_exp_f32 v106, v106
    v_exp_f32 v107, v107
    v_exp_f32 v108, v108
    v_mfma_f32_32x32x16_bf16 v[124:139], v[20:23], v[8:11], 0
    ds_read_b128 v[24:27], v200 offset:9216
    v_exp_f32 v109, v109
    v_exp_f32 v110, v110
    v_exp_f32 v111, v111
    v_exp_f32 v112, v112
    v_exp_f32 v113, v113
    v_smfmac_f32_32x32x32_bf16 v[176:191], v[36:39], v[100:107], v3
    s_add_u32 s59, s59, 229376
    v_exp_f32 v114, v114
    v_exp_f32 v115, v115
    v_exp_f32 v116, v116
    v_exp_f32 v117, v117
    v_exp_f32 v118, v118
    v_smfmac_f32_32x32x32_bf16 v[44:59], v[28:31], v[108:115], v3
    s_waitcnt lgkmcnt(0)
    buffer_load_dword v145, v157, s[20:23], s59 offen
    v_exp_f32 v119, v119
    v_exp_f32 v120, v120
    v_exp_f32 v121, v121
    v_exp_f32 v122, v122
    v_exp_f32 v123, v123
    v_exp_f32 v124, v124
    v_mfma_f32_32x32x16_bf16 v[76:91], v[24:27], v[204:207], 0
    ds_read_b128 v[32:35], v14 offset:8384
    v_exp_f32 v125, v125
    v_exp_f32 v126, v126
    v_exp_f32 v127, v127
    v_exp_f32 v128, v128
    v_exp_f32 v129, v129
    v_smfmac_f32_32x32x32_bf16 v[44:59], v[36:39], v[116:123], v3
    ds_read_b128 v[40:43], v15 offset:8384
    v_exp_f32 v130, v130
    v_exp_f32 v131, v131
    v_exp_f32 v132, v132
    v_exp_f32 v133, v133
    v_exp_f32 v134, v134
    v_smfmac_f32_32x32x32_bf16 v[60:75], v[28:31], v[124:131], v3
    v_exp_f32 v135, v135
    v_exp_f32 v136, v136
    v_exp_f32 v137, v137
    v_exp_f32 v138, v138
    v_exp_f32 v139, v139
    v_exp_f32 v76, v76
    v_mfma_f32_32x32x16_bf16 v[92:107], v[24:27], v[208:211], 0
    s_waitcnt lgkmcnt(0)
    v_exp_f32 v77, v77
    v_exp_f32 v78, v78
    v_exp_f32 v79, v79
    v_exp_f32 v80, v80
    v_exp_f32 v81, v81
    v_smfmac_f32_32x32x32_bf16 v[60:75], v[36:39], v[132:139], v3
    v_exp_f32 v82, v82
    v_exp_f32 v83, v83
    v_exp_f32 v84, v84
    v_exp_f32 v85, v85
    v_exp_f32 v86, v86
    v_smfmac_f32_32x32x32_bf16 v[160:175], v[32:35], v[76:83], v3
    v_exp_f32 v87, v87
    v_exp_f32 v88, v88
    v_exp_f32 v89, v89
    v_exp_f32 v90, v90
    v_exp_f32 v91, v91
    v_exp_f32 v92, v92
    v_mfma_f32_32x32x16_bf16 v[108:123], v[24:27], v[4:7], 0
L_pad_2:
    s_cbranch_execz L_pad_6
    v_exp_f32 v93, v93
    v_exp_f32 v94, v94
    v_exp_f32 v95, v95
    v_exp_f32 v96, v96
    v_exp_f32 v97, v97
    v_smfmac_f32_32x32x32_bf16 v[160:175], v[40:43], v[84:91], v3
    s_add_u32 s59, s59, 229376
    v_exp_f32 v98, v98
    v_exp_f32 v99, v99
    v_exp_f32 v100, v100
    v_exp_f32 v101, v101
    v_exp_f32 v102, v102
    v_smfmac_f32_32x32x32_bf16 v[176:191], v[32:35], v[92:99], v3
    buffer_load_dword v145, v157, s[20:23], s59 offen
    v_exp_f32 v103, v103
    v_exp_f32 v104, v104
    v_exp_f32 v105, v105
    v_exp_f32 v106, v106
    v_exp_f32 v107, v107
    v_exp_f32 v108, v108
    v_mfma_f32_32x32x16_bf16 v[124:139], v[24:27], v[8:11], 0
    ds_read_b128 v[20:23], v200 offset:10240
    v_exp_f32 v109, v109
    v_exp_f32 v110, v110
    v_exp_f32 v111, v111
    v_exp_f32 v112, v112
    v_exp_f32 v113, v113
    v_smfmac_f32_32x32x32_bf16 v[176:191], v[40:43], v[100:107], v3
    v_exp_f32 v114, v114
    v_exp_f32 v115, v115
    v_exp_f32 v116, v116
    v_exp_f32 v117, v117
    v_exp_f32 v118, v118
    v_smfmac_f32_32x32x32_bf16 v[44:59], v[32:35], v[108:115], v3
    s_waitcnt lgkmcnt(0)
    v_exp_f32 v119, v119
    v_exp_f32 v120, v120
    v_exp_f32 v121, v121
    v_exp_f32 v122, v122
    v_exp_f32 v123, v123
    v_exp_f32 v124, v124
    v_mfma_f32_32x32x16_bf16 v[76:91], v[20:23], v[204:207], 0
    ds_read_b128 v[28:31], v16 offset:8384
    v_exp_f32 v125, v125
    v_exp_f32 v126, v126
    v_exp_f32 v127, v127
    v_exp_f32 v128, v128
    v_exp_f32 v129, v129
    v_smfmac_f32_32x32x32_bf16 v[44:59], v[40:43], v[116:123], v3
    ds_read_b128 v[36:39], v17 offset:8384
    v_exp_f32 v130, v130
    v_exp_f32 v131, v131
    v_exp_f32 v132, v132
    v_exp_f32 v133, v133
    v_exp_f32 v134, v134
    v_smfmac_f32_32x32x32_bf16 v[60:75], v[32:35], v[124:131], v3
    v_exp_f32 v135, v135
    v_exp_f32 v136, v136
    v_exp_f32 v137, v137
    v_exp_f32 v138, v138
    v_exp_f32 v139, v139
    v_exp_f32 v76, v76
    v_mfma_f32_32x32x16_bf16 v[92:107], v[20:23], v[208:211], 0
    s_waitcnt lgkmcnt(0)
    v_exp_f32 v77, v77
    v_exp_f32 v78, v78
    v_exp_f32 v79, v79
    v_exp_f32 v80, v80
    v_exp_f32 v81, v81
    v_smfmac_f32_32x32x32_bf16 v[60:75], v[40:43], v[132:139], v3
    s_lshl_b32 s46, s40, 11
    s_add_u32 m0, s46, 155648
    v_exp_f32 v82, v82
    v_exp_f32 v83, v83
    v_exp_f32 v84, v84
    v_exp_f32 v85, v85
    v_exp_f32 v86, v86
    v_smfmac_f32_32x32x32_bf16 v[160:175], v[28:31], v[76:83], v3
    buffer_load_dwordx4 v151, s[4:7], 0 offen lds
    buffer_load_dwordx4 v152, s[4:7], 0 offen offset:1024 lds
    v_exp_f32 v87, v87
    v_exp_f32 v88, v88
    v_exp_f32 v89, v89
    v_exp_f32 v90, v90
    v_exp_f32 v91, v91
    v_exp_f32 v92, v92
    v_mfma_f32_32x32x16_bf16 v[108:123], v[20:23], v[4:7], 0
    v_exp_f32 v93, v93
    v_exp_f32 v94, v94
    v_exp_f32 v95, v95
    v_exp_f32 v96, v96
    v_exp_f32 v97, v97
    v_smfmac_f32_32x32x32_bf16 v[160:175], v[36:39], v[84:91], v3
    v_exp_f32 v98, v98
    v_exp_f32 v99, v99
    v_exp_f32 v100, v100
    v_exp_f32 v101, v101
    v_exp_f32 v102, v102
    v_smfmac_f32_32x32x32_bf16 v[176:191], v[28:31], v[92:99], v3
    buffer_load_dword v145, v158, s[16:19], 0 offen
    v_exp_f32 v103, v103
    v_exp_f32 v104, v104
    v_exp_f32 v105, v105
    v_exp_f32 v106, v106
    v_exp_f32 v107, v107
    v_exp_f32 v108, v108
    v_mfma_f32_32x32x16_bf16 v[124:139], v[20:23], v[8:11], 0
    ds_read_b128 v[24:27], v200 offset:11264
    v_exp_f32 v109, v109
    v_exp_f32 v110, v110
    v_exp_f32 v111, v111
    v_exp_f32 v112, v112
    v_exp_f32 v113, v113
    v_smfmac_f32_32x32x32_bf16 v[176:191], v[36:39], v[100:107], v3
    s_add_u32 m0, s56, 0
    v_exp_f32 v114, v114
    v_exp_f32 v115, v115
    v_exp_f32 v116, v116
    v_exp_f32 v117, v117
    v_exp_f32 v118, v118
    v_smfmac_f32_32x32x32_bf16 v[44:59], v[28:31], v[108:115], v3
    s_waitcnt lgkmcnt(0)
    buffer_load_dwordx4 v148, s[20:23], s93 offen lds
    buffer_load_dwordx4 v149, s[20:23], s93 offen offset:1024 lds
    v_exp_f32 v119, v119
    v_exp_f32 v120, v120
    v_exp_f32 v121, v121
    v_exp_f32 v122, v122
    v_exp_f32 v123, v123
    v_exp_f32 v124, v124
    v_mfma_f32_32x32x16_bf16 v[76:91], v[24:27], v[204:207], 0
    ds_read_b128 v[32:35], v18 offset:8384
    v_exp_f32 v125, v125
    v_exp_f32 v126, v126
    v_exp_f32 v127, v127
    v_exp_f32 v128, v128
    v_exp_f32 v129, v129
    v_smfmac_f32_32x32x32_bf16 v[44:59], v[36:39], v[116:123], v3
    ds_read_b128 v[40:43], v19 offset:8384
    v_exp_f32 v130, v130
    v_exp_f32 v131, v131
    v_exp_f32 v132, v132
    v_exp_f32 v133, v133
    v_exp_f32 v134, v134
    v_smfmac_f32_32x32x32_bf16 v[60:75], v[28:31], v[124:131], v3
    v_exp_f32 v135, v135
    v_exp_f32 v136, v136
    v_exp_f32 v137, v137
    v_exp_f32 v138, v138
    v_exp_f32 v139, v139
    v_exp_f32 v76, v76
    v_mfma_f32_32x32x16_bf16 v[92:107], v[24:27], v[208:211], 0
    s_waitcnt lgkmcnt(0)
    v_exp_f32 v77, v77
    v_exp_f32 v78, v78
    v_exp_f32 v79, v79
    v_exp_f32 v80, v80
    v_exp_f32 v81, v81
    v_smfmac_f32_32x32x32_bf16 v[60:75], v[36:39], v[132:139], v3
    v_exp_f32 v82, v82
    v_exp_f32 v83, v83
    v_exp_f32 v84, v84
    v_exp_f32 v85, v85
    v_exp_f32 v86, v86
    v_smfmac_f32_32x32x32_bf16 v[160:175], v[32:35], v[76:83], v3
    buffer_load_ushort v248, v155, s[32:35], 0 offen
    v_exp_f32 v87, v87
    v_exp_f32 v88, v88
    v_exp_f32 v89, v89
    v_exp_f32 v90, v90
    v_exp_f32 v91, v91
    v_exp_f32 v92, v92
    v_mfma_f32_32x32x16_bf16 v[108:123], v[24:27], v[4:7], 0
    v_exp_f32 v93, v93
    v_exp_f32 v94, v94
    v_exp_f32 v95, v95
    v_exp_f32 v96, v96
    v_exp_f32 v97, v97
    v_smfmac_f32_32x32x32_bf16 v[160:175], v[40:43], v[84:91], v3
    s_add_u32 m0, s56, 2048
    s_add_u32 s93, s93, 57344
    v_exp_f32 v98, v98
    v_exp_f32 v99, v99
    v_exp_f32 v100, v100
    v_exp_f32 v101, v101
    v_exp_f32 v102, v102
    v_smfmac_f32_32x32x32_bf16 v[176:191], v[32:35], v[92:99], v3
    buffer_load_dwordx4 v148, s[20:23], s93 offen lds
    buffer_load_dwordx4 v149, s[20:23], s93 offen offset:1024 lds
    v_exp_f32 v103, v103
    v_exp_f32 v104, v104
    v_exp_f32 v105, v105
    v_exp_f32 v106, v106
    v_exp_f32 v107, v107
    v_exp_f32 v108, v108
    v_mfma_f32_32x32x16_bf16 v[124:139], v[24:27], v[8:11], 0
    s_waitcnt vmcnt(13)
    s_barrier
    ds_read_b128 v[20:23], v200 offset:0
    v_exp_f32 v109, v109
    v_exp_f32 v110, v110
    v_exp_f32 v111, v111
    v_exp_f32 v112, v112
    v_exp_f32 v113, v113
    v_smfmac_f32_32x32x32_bf16 v[176:191], v[40:43], v[100:107], v3
    s_add_u32 m0, s53, 8192
    s_add_u32 s52, s52, 8192
    v_exp_f32 v114, v114
    v_exp_f32 v115, v115
    v_exp_f32 v116, v116
    v_exp_f32 v117, v117
    v_exp_f32 v118, v118
    v_smfmac_f32_32x32x32_bf16 v[44:59], v[32:35], v[108:115], v3
    s_waitcnt lgkmcnt(0)
    buffer_load_dwordx4 v2, s[12:15], s52 offen offset:0 sc1 lds
    buffer_load_dwordx4 v2, s[12:15], s52 offen offset:1024 sc1 lds
    v_exp_f32 v119, v119
    v_exp_f32 v120, v120
    v_exp_f32 v121, v121
    v_exp_f32 v122, v122
    v_exp_f32 v123, v123
    v_exp_f32 v124, v124
    v_mfma_f32_32x32x16_bf16 v[76:91], v[20:23], v[204:207], 0
    ds_read_b128 v[28:31], v12 offset:0
    v_exp_f32 v125, v125
    v_exp_f32 v126, v126
    v_exp_f32 v127, v127
    v_exp_f32 v128, v128
    v_exp_f32 v129, v129
    v_smfmac_f32_32x32x32_bf16 v[44:59], v[40:43], v[116:123], v3
    s_add_u32 m0, s54, 24768
    ds_read_b128 v[36:39], v13 offset:0
    v_exp_f32 v130, v130
    v_exp_f32 v131, v131
    v_exp_f32 v132, v132
    v_exp_f32 v133, v133
    v_exp_f32 v134, v134
    v_smfmac_f32_32x32x32_bf16 v[60:75], v[32:35], v[124:131], v3
    buffer_load_dwordx4 v153, s[12:15], s52 offen offset:0 sc1 lds
    buffer_load_dwordx4 v153, s[12:15], s52 offen offset:1024 sc1 lds
    v_exp_f32 v135, v135
    v_exp_f32 v136, v136
    v_exp_f32 v137, v137
    v_exp_f32 v138, v138
    v_exp_f32 v139, v139
    v_exp_f32 v76, v76
    v_mfma_f32_32x32x16_bf16 v[92:107], v[20:23], v[208:211], 0
    s_waitcnt lgkmcnt(0)
    v_exp_f32 v77, v77
    v_exp_f32 v78, v78
    v_exp_f32 v79, v79
    v_exp_f32 v80, v80
    v_exp_f32 v81, v81
    v_smfmac_f32_32x32x32_bf16 v[60:75], v[40:43], v[132:139], v3
    s_add_u32 m0, s58, 0
    v_exp_f32 v82, v82
    v_exp_f32 v83, v83
    v_exp_f32 v84, v84
    v_exp_f32 v85, v85
    v_exp_f32 v86, v86
    v_smfmac_f32_32x32x32_bf16 v[160:175], v[28:31], v[76:83], v3
    buffer_load_dwordx4 v140, s[16:19], s57 offen offset:0 lds
    buffer_load_dwordx4 v141, s[16:19], s57 offen offset:1024 lds
    v_exp_f32 v87, v87
    v_exp_f32 v88, v88
    v_exp_f32 v89, v89
    v_exp_f32 v90, v90
    v_exp_f32 v91, v91
    v_exp_f32 v92, v92
    v_mfma_f32_32x32x16_bf16 v[108:123], v[20:23], v[4:7], 0
    v_exp_f32 v93, v93
    v_exp_f32 v94, v94
    v_exp_f32 v95, v95
    v_exp_f32 v96, v96
    v_exp_f32 v97, v97
    v_smfmac_f32_32x32x32_bf16 v[160:175], v[36:39], v[84:91], v3
    s_add_u32 m0, s56, 4096
    s_add_u32 s93, s93, 57344
    v_exp_f32 v98, v98
    v_exp_f32 v99, v99
    v_exp_f32 v100, v100
    v_exp_f32 v101, v101
    v_exp_f32 v102, v102
    v_smfmac_f32_32x32x32_bf16 v[176:191], v[28:31], v[92:99], v3
    buffer_load_dwordx4 v148, s[20:23], s93 offen lds
    buffer_load_dwordx4 v149, s[20:23], s93 offen offset:1024 lds
    v_exp_f32 v103, v103
    v_exp_f32 v104, v104
    v_exp_f32 v105, v105
    v_exp_f32 v106, v106
    v_exp_f32 v107, v107
    v_exp_f32 v108, v108
    v_mfma_f32_32x32x16_bf16 v[124:139], v[20:23], v[8:11], 0
    ds_read_b128 v[24:27], v200 offset:1024
    v_exp_f32 v109, v109
    v_exp_f32 v110, v110
    v_exp_f32 v111, v111
    v_exp_f32 v112, v112
    v_exp_f32 v113, v113
    v_smfmac_f32_32x32x32_bf16 v[176:191], v[36:39], v[100:107], v3
    v_exp_f32 v114, v114
    v_exp_f32 v115, v115
    v_exp_f32 v116, v116
    v_exp_f32 v117, v117
    v_exp_f32 v118, v118
    v_smfmac_f32_32x32x32_bf16 v[44:59], v[28:31], v[108:115], v3
    s_waitcnt lgkmcnt(0)
    v_exp_f32 v119, v119
    v_exp_f32 v120, v120
    v_exp_f32 v121, v121
    v_exp_f32 v122, v122
    v_exp_f32 v123, v123
    v_exp_f32 v124, v124
    v_mfma_f32_32x32x16_bf16 v[76:91], v[24:27], v[204:207], 0
    ds_read_b128 v[32:35], v14 offset:0
    v_exp_f32 v125, v125
    v_exp_f32 v126, v126
    v_exp_f32 v127, v127
    v_exp_f32 v128, v128
    v_exp_f32 v129, v129
    v_smfmac_f32_32x32x32_bf16 v[44:59], v[36:39], v[116:123], v3
    s_add_u32 m0, s56, 6144
    s_add_u32 s93, s93, 57344
    ds_read_b128 v[40:43], v15 offset:0
    v_exp_f32 v130, v130
    v_exp_f32 v131, v131
    v_exp_f32 v132, v132
    v_exp_f32 v133, v133
    v_exp_f32 v134, v134
    v_smfmac_f32_32x32x32_bf16 v[60:75], v[28:31], v[124:131], v3
    buffer_load_dwordx4 v148, s[20:23], s93 offen lds
    buffer_load_dwordx4 v149, s[20:23], s93 offen offset:1024 lds
    v_exp_f32 v135, v135
    v_exp_f32 v136, v136
    v_exp_f32 v137, v137
    v_exp_f32 v138, v138
    v_exp_f32 v139, v139
    v_exp_f32 v76, v76
    v_mfma_f32_32x32x16_bf16 v[92:107], v[24:27], v[208:211], 0
    s_waitcnt lgkmcnt(0)
    v_exp_f32 v77, v77
    v_exp_f32 v78, v78
    v_exp_f32 v79, v79
    v_exp_f32 v80, v80
    v_exp_f32 v81, v81
    v_smfmac_f32_32x32x32_bf16 v[60:75], v[36:39], v[132:139], v3
    s_add_u32 s93, s93, 57344
    s_cmp_eq_u32 s93, s95
    v_exp_f32 v82, v82
    v_exp_f32 v83, v83
    v_exp_f32 v84, v84
    v_exp_f32 v85, v85
    v_exp_f32 v86, v86
    v_smfmac_f32_32x32x32_bf16 v[160:175], v[32:35], v[76:83], v3
    v_exp_f32 v87, v87
    v_exp_f32 v88, v88
    v_exp_f32 v89, v89
    v_exp_f32 v90, v90
    v_exp_f32 v91, v91
    v_exp_f32 v92, v92
    v_mfma_f32_32x32x16_bf16 v[108:123], v[24:27], v[4:7], 0
    v_exp_f32 v93, v93
    v_exp_f32 v94, v94
    v_exp_f32 v95, v95
    v_exp_f32 v96, v96
    v_exp_f32 v97, v97
    v_smfmac_f32_32x32x32_bf16 v[160:175], v[40:43], v[84:91], v3
    s_cselect_b32 s93, s94, s93
    s_add_u32 m0, s56, 8192
    v_exp_f32 v98, v98
    v_exp_f32 v99, v99
    v_exp_f32 v100, v100
    v_exp_f32 v101, v101
    v_exp_f32 v102, v102
    v_smfmac_f32_32x32x32_bf16 v[176:191], v[32:35], v[92:99], v3
    buffer_load_dwordx4 v148, s[20:23], s93 offen lds
    buffer_load_dwordx4 v149, s[20:23], s93 offen offset:1024 lds
    v_exp_f32 v103, v103
    v_exp_f32 v104, v104
    v_exp_f32 v105, v105
    v_exp_f32 v106, v106
    v_exp_f32 v107, v107
    v_exp_f32 v108, v108
    v_mfma_f32_32x32x16_bf16 v[124:139], v[24:27], v[8:11], 0
    ds_read_b128 v[20:23], v200 offset:2048
    v_exp_f32 v109, v109
    v_exp_f32 v110, v110
    v_exp_f32 v111, v111
    v_exp_f32 v112, v112
    v_exp_f32 v113, v113
    v_smfmac_f32_32x32x32_bf16 v[176:191], v[40:43], v[100:107], v3
    v_exp_f32 v114, v114
    v_exp_f32 v115, v115
    v_exp_f32 v116, v116
    v_exp_f32 v117, v117
    v_exp_f32 v118, v118
    v_smfmac_f32_32x32x32_bf16 v[44:59], v[32:35], v[108:115], v3
    s_waitcnt lgkmcnt(0)
    v_exp_f32 v119, v119
    v_exp_f32 v120, v120
    v_exp_f32 v121, v121
    v_exp_f32 v122, v122
    v_exp_f32 v123, v123
    v_exp_f32 v124, v124
    v_mfma_f32_32x32x16_bf16 v[76:91], v[20:23], v[204:207], 0
    ds_read_b128 v[28:31], v16 offset:0
    v_exp_f32 v125, v125
    v_exp_f32 v126, v126
    v_exp_f32 v127, v127
    v_exp_f32 v128, v128
    v_exp_f32 v129, v129
    v_smfmac_f32_32x32x32_bf16 v[44:59], v[40:43], v[116:123], v3
    s_add_u32 m0, s56, 10240
    s_add_u32 s93, s93, 57344
    ds_read_b128 v[36:39], v17 offset:0
    v_exp_f32 v130, v130
    v_exp_f32 v131, v131
    v_exp_f32 v132, v132
    v_exp_f32 v133, v133
    v_exp_f32 v134, v134
    v_smfmac_f32_32x32x32_bf16 v[60:75], v[32:35], v[124:131], v3
    s_waitcnt vmcnt(15)
    buffer_load_dwordx4 v148, s[20:23], s93 offen lds
    buffer_load_dwordx4 v149, s[20:23], s93 offen offset:1024 lds
    ds_read_b64_tr_b16 a[0:1], v150 offset:0
    ds_read_b64_tr_b16 a[4:5], v156 offset:0
    v_exp_f32 v135, v135
    v_exp_f32 v136, v136
    v_exp_f32 v137, v137
    v_exp_f32 v138, v138
    v_exp_f32 v139, v139
    v_exp_f32 v76, v76
    v_mfma_f32_32x32x16_bf16 v[92:107], v[20:23], v[208:211], 0
    s_waitcnt lgkmcnt(2)
    v_exp_f32 v77, v77
    v_exp_f32 v78, v78
    v_exp_f32 v79, v79
    v_exp_f32 v80, v80
    v_exp_f32 v81, v81
    v_smfmac_f32_32x32x32_bf16 v[60:75], v[40:43], v[132:139], v3
    s_add_u32 m0, s58, 0
    v_exp_f32 v82, v82
    v_exp_f32 v83, v83
    v_exp_f32 v84, v84
    v_exp_f32 v85, v85
    v_exp_f32 v86, v86
    v_smfmac_f32_32x32x32_bf16 v[160:175], v[28:31], v[76:83], v3
    buffer_load_dwordx4 v142, s[16:19], s57 offen offset:2048 lds
    buffer_load_dwordx4 v143, s[16:19], s57 offen offset:3072 lds
    ds_read_b64_tr_b16 a[8:9], v150 offset:512
    ds_read_b64_tr_b16 a[12:13], v156 offset:512
    v_exp_f32 v87, v87
    v_exp_f32 v88, v88
    v_exp_f32 v89, v89
    v_exp_f32 v90, v90
    v_exp_f32 v91, v91
    v_exp_f32 v92, v92
    v_mfma_f32_32x32x16_bf16 v[108:123], v[20:23], v[4:7], 0
    v_exp_f32 v93, v93
    v_exp_f32 v94, v94
    v_exp_f32 v95, v95
    v_exp_f32 v96, v96
    v_exp_f32 v97, v97
    v_smfmac_f32_32x32x32_bf16 v[160:175], v[36:39], v[84:91], v3
    s_add_u32 m0, s56, 0
    s_add_u32 s93, s93, 57344
    v_exp_f32 v98, v98
    v_exp_f32 v99, v99
    v_exp_f32 v100, v100
    v_exp_f32 v101, v101
    v_exp_f32 v102, v102
    v_smfmac_f32_32x32x32_bf16 v[176:191], v[28:31], v[92:99], v3
    s_waitcnt vmcnt(16) lgkmcnt(0)
    buffer_load_dwordx4 v148, s[20:23], s93 offen lds
    buffer_load_dwordx4 v149, s[20:23], s93 offen offset:1024 lds
    ds_read_b64_tr_b16 a[2:3], v150 offset:2048
    ds_read_b64_tr_b16 a[6:7], v156 offset:2048
    v_exp_f32 v103, v103
    v_exp_f32 v104, v104
    v_exp_f32 v105, v105
    v_exp_f32 v106, v106
    v_exp_f32 v107, v107
    v_exp_f32 v108, v108
    v_mfma_f32_32x32x16_bf16 v[124:139], v[20:23], v[8:11], 0
    ds_read_b128 v[24:27], v200 offset:3072
    v_exp_f32 v109, v109
    v_exp_f32 v110, v110
    v_exp_f32 v111, v111
    v_exp_f32 v112, v112
    v_exp_f32 v113, v113
    v_smfmac_f32_32x32x32_bf16 v[176:191], v[36:39], v[100:107], v3
    v_exp_f32 v114, v114
    v_exp_f32 v115, v115
    v_exp_f32 v116, v116
    v_exp_f32 v117, v117
    v_exp_f32 v118, v118
    v_smfmac_f32_32x32x32_bf16 v[44:59], v[28:31], v[108:115], v3
    s_waitcnt lgkmcnt(0)
    ds_read_b64_tr_b16 a[10:11], v150 offset:2560
    ds_read_b64_tr_b16 a[14:15], v156 offset:2560
    v_exp_f32 v119, v119
    v_exp_f32 v120, v120
    v_exp_f32 v121, v121
    v_exp_f32 v122, v122
    v_exp_f32 v123, v123
    v_exp_f32 v124, v124
    v_mfma_f32_32x32x16_bf16 v[76:91], v[24:27], v[204:207], 0
    ds_read_b128 v[32:35], v18 offset:0
    v_exp_f32 v125, v125
    v_exp_f32 v126, v126
    v_exp_f32 v127, v127
    v_exp_f32 v128, v128
    v_exp_f32 v129, v129
    v_smfmac_f32_32x32x32_bf16 v[44:59], v[36:39], v[116:123], v3
    s_add_u32 m0, s56, 2048
    s_add_u32 s93, s93, 57344
    ds_read_b128 v[40:43], v19 offset:0
    v_exp_f32 v130, v130
    v_exp_f32 v131, v131
    v_exp_f32 v132, v132
    v_exp_f32 v133, v133
    v_exp_f32 v134, v134
    v_smfmac_f32_32x32x32_bf16 v[60:75], v[28:31], v[124:131], v3
    s_waitcnt vmcnt(10) lgkmcnt(2)
    buffer_load_dwordx4 v148, s[20:23], s93 offen lds
    buffer_load_dwordx4 v149, s[20:23], s93 offen offset:1024 lds
    ds_read_b64_tr_b16 a[16:17], v150 offset:4096
    ds_read_b64_tr_b16 a[20:21], v156 offset:4096
    v_exp_f32 v135, v135
    v_exp_f32 v136, v136
    v_exp_f32 v137, v137
    v_exp_f32 v138, v138
    v_exp_f32 v139, v139
    v_exp_f32 v76, v76
    v_mfma_f32_32x32x16_bf16 v[92:107], v[24:27], v[208:211], 0
    s_waitcnt lgkmcnt(2)
    v_exp_f32 v77, v77
    v_exp_f32 v78, v78
    v_exp_f32 v79, v79
    v_exp_f32 v80, v80
    v_exp_f32 v81, v81
    v_smfmac_f32_32x32x32_bf16 v[60:75], v[36:39], v[132:139], v3
    s_add_u32 s93, s93, 57344
    s_cmp_eq_u32 s93, s95
    v_exp_f32 v82, v82
    v_exp_f32 v83, v83
    v_exp_f32 v84, v84
    v_exp_f32 v85, v85
    v_exp_f32 v86, v86
    v_smfmac_f32_32x32x32_bf16 v[160:175], v[32:35], v[76:83], v3
    ds_read_b64_tr_b16 a[24:25], v150 offset:4608
    ds_read_b64_tr_b16 a[28:29], v156 offset:4608
    v_exp_f32 v87, v87
    v_exp_f32 v88, v88
    v_exp_f32 v89, v89
    v_exp_f32 v90, v90
    v_exp_f32 v91, v91
    v_exp_f32 v92, v92
    v_mfma_f32_32x32x16_bf16 v[108:123], v[24:27], v[4:7], 0
    v_exp_f32 v93, v93
    v_exp_f32 v94, v94
    v_exp_f32 v95, v95
    v_exp_f32 v96, v96
    v_exp_f32 v97, v97
    v_smfmac_f32_32x32x32_bf16 v[160:175], v[40:43], v[84:91], v3
    s_cselect_b32 s93, s94, s93
    s_add_u32 m0, s56, 4096
    v_exp_f32 v98, v98
    v_exp_f32 v99, v99
    v_exp_f32 v100, v100
    v_exp_f32 v101, v101
    v_exp_f32 v102, v102
    v_smfmac_f32_32x32x32_bf16 v[176:191], v[32:35], v[92:99], v3
    s_waitcnt lgkmcnt(0)
    buffer_load_dwordx4 v148, s[20:23], s93 offen lds
    buffer_load_dwordx4 v149, s[20:23], s93 offen offset:1024 lds
    v_exp_f32 v103, v103
    v_exp_f32 v104, v104
    v_exp_f32 v105, v105
    v_exp_f32 v106, v106
    v_exp_f32 v107, v107
    v_exp_f32 v108, v108
    v_mfma_f32_32x32x16_bf16 v[124:139], v[24:27], v[8:11], 0
    s_barrier
    ds_read_b128 v[20:23], v200 offset:8192
    v_exp_f32 v109, v109
    v_exp_f32 v110, v110
    v_exp_f32 v111, v111
    v_exp_f32 v112, v112
    v_exp_f32 v113, v113
    v_smfmac_f32_32x32x32_bf16 v[176:191], v[40:43], v[100:107], v3
    s_add_u32 m0, s53, 0
    s_add_u32 s52, s52, 8192
    v_exp_f32 v114, v114
    v_exp_f32 v115, v115
    v_exp_f32 v116, v116
    v_exp_f32 v117, v117
    v_exp_f32 v118, v118
    v_smfmac_f32_32x32x32_bf16 v[44:59], v[32:35], v[108:115], v3
    s_waitcnt lgkmcnt(0)
    buffer_load_dwordx4 v2, s[12:15], s52 offen offset:0 sc1 lds
    buffer_load_dwordx4 v2, s[12:15], s52 offen offset:1024 sc1 lds
    v_exp_f32 v119, v119
    v_exp_f32 v120, v120
    v_exp_f32 v121, v121
    v_exp_f32 v122, v122
    v_exp_f32 v123, v123
    v_exp_f32 v124, v124
    v_mfma_f32_32x32x16_bf16 v[76:91], v[20:23], v[204:207], 0
    ds_read_b128 v[28:31], v12 offset:8384
    v_exp_f32 v125, v125
    v_exp_f32 v126, v126
    v_exp_f32 v127, v127
    v_exp_f32 v128, v128
    v_exp_f32 v129, v129
    v_smfmac_f32_32x32x32_bf16 v[44:59], v[40:43], v[116:123], v3
    s_add_u32 m0, s54, 16384
    ds_read_b128 v[36:39], v13 offset:8384
    v_exp_f32 v130, v130
    v_exp_f32 v131, v131
    v_exp_f32 v132, v132
    v_exp_f32 v133, v133
    v_exp_f32 v134, v134
    v_smfmac_f32_32x32x32_bf16 v[60:75], v[32:35], v[124:131], v3
    s_waitcnt vmcnt(14)
    buffer_load_dwordx4 v153, s[12:15], s52 offen offset:0 sc1 lds
    buffer_load_dwordx4 v153, s[12:15], s52 offen offset:1024 sc1 lds
    ds_read_b64_tr_b16 a[18:19], v150 offset:6144
    ds_read_b64_tr_b16 a[22:23], v156 offset:6144
    v_exp_f32 v135, v135
    v_exp_f32 v136, v136
    v_exp_f32 v137, v137
    v_exp_f32 v138, v138
    v_exp_f32 v139, v139
    v_exp_f32 v76, v76
    v_mfma_f32_32x32x16_bf16 v[92:107], v[20:23], v[208:211], 0
    s_waitcnt lgkmcnt(2)
    v_exp_f32 v77, v77
    v_exp_f32 v78, v78
    v_exp_f32 v79, v79
    v_exp_f32 v80, v80
    v_exp_f32 v81, v81
    v_smfmac_f32_32x32x32_bf16 v[60:75], v[40:43], v[132:139], v3
    s_add_u32 m0, s58, 16384
    s_xor_b32 s57, s57, 131072
    v_exp_f32 v82, v82
    v_exp_f32 v83, v83
    v_exp_f32 v84, v84
    v_exp_f32 v85, v85
    v_exp_f32 v86, v86
    v_smfmac_f32_32x32x32_bf16 v[160:175], v[28:31], v[76:83], v3
    buffer_load_dwordx4 v140, s[16:19], s57 offen offset:0 lds
    buffer_load_dwordx4 v141, s[16:19], s57 offen offset:1024 lds
    ds_read_b64_tr_b16 a[26:27], v150 offset:6656
    ds_read_b64_tr_b16 a[30:31], v156 offset:6656
    v_exp_f32 v87, v87
    v_exp_f32 v88, v88
    v_exp_f32 v89, v89
    v_exp_f32 v90, v90
    v_exp_f32 v91, v91
    v_exp_f32 v92, v92
    v_mfma_f32_32x32x16_bf16 v[108:123], v[20:23], v[4:7], 0
    v_exp_f32 v93, v93
    v_exp_f32 v94, v94
    v_exp_f32 v95, v95
    v_exp_f32 v96, v96
    v_exp_f32 v97, v97
    v_smfmac_f32_32x32x32_bf16 v[160:175], v[36:39], v[84:91], v3
    s_add_u32 m0, s56, 6144
    s_add_u32 s93, s93, 57344
    v_exp_f32 v98, v98
    v_exp_f32 v99, v99
    v_exp_f32 v100, v100
    v_exp_f32 v101, v101
    v_exp_f32 v102, v102
    v_smfmac_f32_32x32x32_bf16 v[176:191], v[28:31], v[92:99], v3
    s_waitcnt vmcnt(16) lgkmcnt(0)
    buffer_load_dwordx4 v148, s[20:23], s93 offen lds
    buffer_load_dwordx4 v149, s[20:23], s93 offen offset:1024 lds
    ds_read_b64_tr_b16 a[32:33], v150 offset:8192
    ds_read_b64_tr_b16 a[36:37], v156 offset:8192
    v_exp_f32 v103, v103
    v_exp_f32 v104, v104
    v_exp_f32 v105, v105
    v_exp_f32 v106, v106
    v_exp_f32 v107, v107
    v_exp_f32 v108, v108
    v_mfma_f32_32x32x16_bf16 v[124:139], v[20:23], v[8:11], 0
    ds_read_b128 v[24:27], v200 offset:9216
    v_exp_f32 v109, v109
    v_exp_f32 v110, v110
    v_exp_f32 v111, v111
    v_exp_f32 v112, v112
    v_exp_f32 v113, v113
    v_smfmac_f32_32x32x32_bf16 v[176:191], v[36:39], v[100:107], v3
    v_exp_f32 v114, v114
    v_exp_f32 v115, v115
    v_exp_f32 v116, v116
    v_exp_f32 v117, v117
    v_exp_f32 v118, v118
    v_smfmac_f32_32x32x32_bf16 v[44:59], v[28:31], v[108:115], v3
    s_waitcnt lgkmcnt(0)
    ds_read_b64_tr_b16 a[40:41], v150 offset:8704
    ds_read_b64_tr_b16 a[44:45], v156 offset:8704
    v_exp_f32 v119, v119
    v_exp_f32 v120, v120
    v_exp_f32 v121, v121
    v_exp_f32 v122, v122
    v_exp_f32 v123, v123
    v_exp_f32 v124, v124
    v_mfma_f32_32x32x16_bf16 v[76:91], v[24:27], v[204:207], 0
    ds_read_b128 v[32:35], v14 offset:8384
    v_exp_f32 v125, v125
    v_exp_f32 v126, v126
    v_exp_f32 v127, v127
    v_exp_f32 v128, v128
    v_exp_f32 v129, v129
    v_smfmac_f32_32x32x32_bf16 v[44:59], v[36:39], v[116:123], v3
    s_add_u32 m0, s56, 8192
    s_add_u32 s93, s93, 57344
    ds_read_b128 v[40:43], v15 offset:8384
    v_exp_f32 v130, v130
    v_exp_f32 v131, v131
    v_exp_f32 v132, v132
    v_exp_f32 v133, v133
    v_exp_f32 v134, v134
    v_smfmac_f32_32x32x32_bf16 v[60:75], v[28:31], v[124:131], v3
    s_waitcnt vmcnt(16) lgkmcnt(2)
    buffer_load_dwordx4 v148, s[20:23], s93 offen lds
    buffer_load_dwordx4 v149, s[20:23], s93 offen offset:1024 lds
    ds_read_b64_tr_b16 a[34:35], v150 offset:10240
    ds_read_b64_tr_b16 a[38:39], v156 offset:10240
    v_exp_f32 v135, v135
    v_exp_f32 v136, v136
    v_exp_f32 v137, v137
    v_exp_f32 v138, v138
    v_exp_f32 v139, v139
    v_exp_f32 v76, v76
    v_mfma_f32_32x32x16_bf16 v[92:107], v[24:27], v[208:211], 0
    s_waitcnt lgkmcnt(2)
    v_exp_f32 v77, v77
    v_exp_f32 v78, v78
    v_exp_f32 v79, v79
    v_exp_f32 v80, v80
    v_exp_f32 v81, v81
    v_smfmac_f32_32x32x32_bf16 v[60:75], v[36:39], v[132:139], v3
    v_exp_f32 v82, v82
    v_exp_f32 v83, v83
    v_exp_f32 v84, v84
    v_exp_f32 v85, v85
    v_exp_f32 v86, v86
    v_smfmac_f32_32x32x32_bf16 v[160:175], v[32:35], v[76:83], v3
    ds_read_b64_tr_b16 a[42:43], v150 offset:10752
    ds_read_b64_tr_b16 a[46:47], v156 offset:10752
    v_exp_f32 v87, v87
    v_exp_f32 v88, v88
    v_exp_f32 v89, v89
    v_exp_f32 v90, v90
    v_exp_f32 v91, v91
    v_exp_f32 v92, v92
    v_mfma_f32_32x32x16_bf16 v[108:123], v[24:27], v[4:7], 0
    v_exp_f32 v93, v93
    v_exp_f32 v94, v94
    v_exp_f32 v95, v95
    v_exp_f32 v96, v96
    v_exp_f32 v97, v97
    v_smfmac_f32_32x32x32_bf16 v[160:175], v[40:43], v[84:91], v3
    s_add_u32 m0, s56, 10240
    s_add_u32 s93, s93, 57344
    v_exp_f32 v98, v98
    v_exp_f32 v99, v99
    v_exp_f32 v100, v100
    v_exp_f32 v101, v101
    v_exp_f32 v102, v102
    v_smfmac_f32_32x32x32_bf16 v[176:191], v[32:35], v[92:99], v3
    s_waitcnt vmcnt(14) lgkmcnt(0)
    buffer_load_dwordx4 v148, s[20:23], s93 offen lds
    buffer_load_dwordx4 v149, s[20:23], s93 offen offset:1024 lds
    ds_read_b64_tr_b16 a[48:49], v150 offset:0
    ds_read_b64_tr_b16 a[52:53], v156 offset:0
    v_exp_f32 v103, v103
    v_exp_f32 v104, v104
    v_exp_f32 v105, v105
    v_exp_f32 v106, v106
    v_exp_f32 v107, v107
    v_exp_f32 v108, v108
    v_mfma_f32_32x32x16_bf16 v[124:139], v[24:27], v[8:11], 0
    ds_read_b128 v[20:23], v200 offset:10240
    v_exp_f32 v109, v109
    v_exp_f32 v110, v110
    v_exp_f32 v111, v111
    v_exp_f32 v112, v112
    v_exp_f32 v113, v113
    v_smfmac_f32_32x32x32_bf16 v[176:191], v[40:43], v[100:107], v3
    s_add_u32 s93, s93, 57344
    s_cmp_eq_u32 s93, s95
    v_exp_f32 v114, v114
L_pad_3:
    s_cbranch_execz L_pad_7
    v_exp_f32 v115, v115
    v_exp_f32 v116, v116
    v_exp_f32 v117, v117
    v_exp_f32 v118, v118
    v_smfmac_f32_32x32x32_bf16 v[44:59], v[32:35], v[108:115], v3
    s_waitcnt lgkmcnt(0)
    ds_read_b64_tr_b16 a[56:57], v150 offset:512
    ds_read_b64_tr_b16 a[60:61], v156 offset:512
    v_exp_f32 v119, v119
    v_exp_f32 v120, v120
    v_exp_f32 v121, v121
    v_exp_f32 v122, v122
    v_exp_f32 v123, v123
    v_exp_f32 v124, v124
    v_mfma_f32_32x32x16_bf16 v[76:91], v[20:23], v[204:207], 0
    ds_read_b128 v[28:31], v16 offset:8384
    v_exp_f32 v125, v125
    v_exp_f32 v126, v126
    v_exp_f32 v127, v127
    v_exp_f32 v128, v128
    v_exp_f32 v129, v129
    v_smfmac_f32_32x32x32_bf16 v[44:59], v[40:43], v[116:123], v3
    s_cselect_b32 s93, s94, s93
    s_add_u32 m0, s56, 0
    ds_read_b128 v[36:39], v17 offset:8384
    v_exp_f32 v130, v130
    v_exp_f32 v131, v131
    v_exp_f32 v132, v132
    v_exp_f32 v133, v133
    v_exp_f32 v134, v134
    v_smfmac_f32_32x32x32_bf16 v[60:75], v[32:35], v[124:131], v3
    s_waitcnt vmcnt(14) lgkmcnt(2)
    buffer_load_dwordx4 v148, s[20:23], s93 offen lds
    buffer_load_dwordx4 v149, s[20:23], s93 offen offset:1024 lds
    ds_read_b64_tr_b16 a[50:51], v150 offset:2048
    ds_read_b64_tr_b16 a[54:55], v156 offset:2048
    v_exp_f32 v135, v135
    v_exp_f32 v136, v136
    v_exp_f32 v137, v137
    v_exp_f32 v138, v138
    v_exp_f32 v139, v139
    v_exp_f32 v76, v76
    v_mfma_f32_32x32x16_bf16 v[92:107], v[20:23], v[208:211], 0
    s_waitcnt lgkmcnt(2)
    v_exp_f32 v77, v77
    v_exp_f32 v78, v78
    v_exp_f32 v79, v79
    v_exp_f32 v80, v80
    v_exp_f32 v81, v81
    v_smfmac_f32_32x32x32_bf16 v[60:75], v[40:43], v[132:139], v3
    s_add_u32 m0, s58, 16384
    v_exp_f32 v82, v82
    v_exp_f32 v83, v83
    v_exp_f32 v84, v84
    v_exp_f32 v85, v85
    v_exp_f32 v86, v86
    v_smfmac_f32_32x32x32_bf16 v[160:175], v[28:31], v[76:83], v3
    buffer_load_dwordx4 v142, s[16:19], s57 offen offset:2048 lds
    buffer_load_dwordx4 v143, s[16:19], s57 offen offset:3072 lds
    ds_read_b64_tr_b16 a[58:59], v150 offset:2560
    ds_read_b64_tr_b16 a[62:63], v156 offset:2560
    v_exp_f32 v87, v87
    v_exp_f32 v88, v88
    v_exp_f32 v89, v89
    v_exp_f32 v90, v90
    v_exp_f32 v91, v91
    v_exp_f32 v92, v92
    v_mfma_f32_32x32x16_bf16 v[108:123], v[20:23], v[4:7], 0
    v_exp_f32 v93, v93
    v_exp_f32 v94, v94
    v_exp_f32 v95, v95
    v_exp_f32 v96, v96
    v_exp_f32 v97, v97
    v_smfmac_f32_32x32x32_bf16 v[160:175], v[36:39], v[84:91], v3
    s_add_u32 m0, s56, 2048
    s_add_u32 s93, s93, 57344
    v_exp_f32 v98, v98
    v_exp_f32 v99, v99
    v_exp_f32 v100, v100
    v_exp_f32 v101, v101
    v_exp_f32 v102, v102
    v_smfmac_f32_32x32x32_bf16 v[176:191], v[28:31], v[92:99], v3
    s_waitcnt vmcnt(16) lgkmcnt(0)
    buffer_load_dwordx4 v148, s[20:23], s93 offen lds
    buffer_load_dwordx4 v149, s[20:23], s93 offen offset:1024 lds
    ds_read_b64_tr_b16 a[64:65], v150 offset:4096
    ds_read_b64_tr_b16 a[68:69], v156 offset:4096
    v_exp_f32 v103, v103
    v_exp_f32 v104, v104
    v_exp_f32 v105, v105
    v_exp_f32 v106, v106
    v_exp_f32 v107, v107
    v_exp_f32 v108, v108
    v_mfma_f32_32x32x16_bf16 v[124:139], v[20:23], v[8:11], 0
    ds_read_b128 v[24:27], v200 offset:11264
    v_exp_f32 v109, v109
    v_exp_f32 v110, v110
    v_exp_f32 v111, v111
    v_exp_f32 v112, v112
    v_exp_f32 v113, v113
    v_smfmac_f32_32x32x32_bf16 v[176:191], v[36:39], v[100:107], v3
    v_exp_f32 v114, v114
    v_exp_f32 v115, v115
    v_exp_f32 v116, v116
    v_exp_f32 v117, v117
    v_exp_f32 v118, v118
    v_smfmac_f32_32x32x32_bf16 v[44:59], v[28:31], v[108:115], v3
    s_waitcnt lgkmcnt(0)
    buffer_store_dwordx4 v[236:239], v2, s[12:15], s9 offen offset:0 sc1
    ds_read_b64_tr_b16 a[72:73], v150 offset:4608
    ds_read_b64_tr_b16 a[76:77], v156 offset:4608
    v_exp_f32 v119, v119
    v_exp_f32 v120, v120
    v_exp_f32 v121, v121
    v_exp_f32 v122, v122
    v_exp_f32 v123, v123
    v_exp_f32 v124, v124
    v_mfma_f32_32x32x16_bf16 v[76:91], v[24:27], v[204:207], 0
    ds_read_b128 v[32:35], v18 offset:8384
    v_exp_f32 v125, v125
    v_exp_f32 v126, v126
    v_exp_f32 v127, v127
    v_exp_f32 v128, v128
    v_exp_f32 v129, v129
    v_smfmac_f32_32x32x32_bf16 v[44:59], v[36:39], v[116:123], v3
    s_add_u32 m0, s56, 4096
    s_add_u32 s93, s93, 57344
    ds_read_b128 v[40:43], v19 offset:8384
    v_exp_f32 v130, v130
    v_exp_f32 v131, v131
    v_exp_f32 v132, v132
    v_exp_f32 v133, v133
    v_exp_f32 v134, v134
    v_smfmac_f32_32x32x32_bf16 v[60:75], v[28:31], v[124:131], v3
    s_waitcnt vmcnt(11) lgkmcnt(2)
    buffer_load_dwordx4 v148, s[20:23], s93 offen lds
    buffer_load_dwordx4 v149, s[20:23], s93 offen offset:1024 lds
    ds_read_b64_tr_b16 a[66:67], v150 offset:6144
    ds_read_b64_tr_b16 a[70:71], v156 offset:6144
    v_exp_f32 v135, v135
    v_exp_f32 v136, v136
    v_exp_f32 v137, v137
    v_exp_f32 v138, v138
    v_exp_f32 v139, v139
    v_exp_f32 v76, v76
    v_mfma_f32_32x32x16_bf16 v[92:107], v[24:27], v[208:211], 0
    s_waitcnt lgkmcnt(2)
    v_exp_f32 v77, v77
    v_exp_f32 v78, v78
    v_exp_f32 v79, v79
    v_exp_f32 v80, v80
    v_exp_f32 v81, v81
    v_smfmac_f32_32x32x32_bf16 v[60:75], v[36:39], v[132:139], v3
    v_exp_f32 v82, v82
    v_exp_f32 v83, v83
    v_exp_f32 v84, v84
    v_exp_f32 v85, v85
    v_exp_f32 v86, v86
    v_smfmac_f32_32x32x32_bf16 v[160:175], v[32:35], v[76:83], v3
    ds_read_b64_tr_b16 a[74:75], v150 offset:6656
    ds_read_b64_tr_b16 a[78:79], v156 offset:6656
    v_exp_f32 v87, v87
    v_exp_f32 v88, v88
    v_exp_f32 v89, v89
    v_exp_f32 v90, v90
    v_exp_f32 v91, v91
    v_exp_f32 v92, v92
    v_mfma_f32_32x32x16_bf16 v[108:123], v[24:27], v[4:7], 0
    v_exp_f32 v93, v93
    v_exp_f32 v94, v94
    v_exp_f32 v95, v95
    v_exp_f32 v96, v96
    v_exp_f32 v97, v97
    v_smfmac_f32_32x32x32_bf16 v[160:175], v[40:43], v[84:91], v3
    s_add_u32 m0, s56, 6144
    s_add_u32 s93, s93, 57344
    v_exp_f32 v98, v98
    v_exp_f32 v99, v99
    v_exp_f32 v100, v100
    v_exp_f32 v101, v101
    v_exp_f32 v102, v102
    v_smfmac_f32_32x32x32_bf16 v[176:191], v[32:35], v[92:99], v3
    s_waitcnt lgkmcnt(0)
    buffer_load_dwordx4 v148, s[20:23], s93 offen lds
    buffer_load_dwordx4 v149, s[20:23], s93 offen offset:1024 lds
    v_exp_f32 v103, v103
    v_exp_f32 v104, v104
    v_exp_f32 v105, v105
    v_exp_f32 v106, v106
    v_exp_f32 v107, v107
    v_exp_f32 v108, v108
    v_mfma_f32_32x32x16_bf16 v[124:139], v[24:27], v[8:11], 0
    s_barrier
    ds_read_b128 v[20:23], v200 offset:0
    v_exp_f32 v109, v109
    v_exp_f32 v110, v110
    v_exp_f32 v111, v111
    v_exp_f32 v112, v112
    v_exp_f32 v113, v113
    v_smfmac_f32_32x32x32_bf16 v[176:191], v[40:43], v[100:107], v3
    s_add_u32 m0, s53, 8192
    s_add_u32 s52, s52, 8192
    v_exp_f32 v114, v114
    v_exp_f32 v115, v115
    v_exp_f32 v116, v116
    v_exp_f32 v117, v117
    v_exp_f32 v118, v118
    v_smfmac_f32_32x32x32_bf16 v[44:59], v[32:35], v[108:115], v3
    s_waitcnt lgkmcnt(0)
    buffer_load_dwordx4 v2, s[12:15], s52 offen offset:0 sc1 lds
    buffer_load_dwordx4 v2, s[12:15], s52 offen offset:1024 sc1 lds
    v_exp_f32 v119, v119
    v_exp_f32 v120, v120
    v_exp_f32 v121, v121
    v_exp_f32 v122, v122
    v_exp_f32 v123, v123
    v_exp_f32 v124, v124
    v_mfma_f32_32x32x16_bf16 v[76:91], v[20:23], v[204:207], 0
    ds_read_b128 v[28:31], v12 offset:0
    v_exp_f32 v125, v125
    v_exp_f32 v126, v126
    v_exp_f32 v127, v127
    v_exp_f32 v128, v128
    v_exp_f32 v129, v129
    v_smfmac_f32_32x32x32_bf16 v[44:59], v[40:43], v[116:123], v3
    s_add_u32 m0, s54, 24768
    ds_read_b128 v[36:39], v13 offset:0
    v_exp_f32 v130, v130
    v_exp_f32 v131, v131
    v_exp_f32 v132, v132
    v_exp_f32 v133, v133
    v_exp_f32 v134, v134
    v_smfmac_f32_32x32x32_bf16 v[60:75], v[32:35], v[124:131], v3
    buffer_load_dwordx4 v153, s[12:15], s52 offen offset:0 sc1 lds
    buffer_load_dwordx4 v153, s[12:15], s52 offen offset:1024 sc1 lds
    v_exp_f32 v135, v135
    v_exp_f32 v136, v136
    v_exp_f32 v137, v137
    v_exp_f32 v138, v138
    v_exp_f32 v139, v139
    v_exp_f32 v76, v76
    v_mfma_f32_32x32x16_bf16 v[92:107], v[20:23], v[208:211], 0
    s_waitcnt lgkmcnt(0)
    v_exp_f32 v77, v77
    v_exp_f32 v78, v78
    v_exp_f32 v79, v79
    v_exp_f32 v80, v80
    v_exp_f32 v81, v81
    v_smfmac_f32_32x32x32_bf16 v[60:75], v[40:43], v[132:139], v3
    s_add_u32 m0, s58, 32768
    s_xor_b32 s57, s57, 393216
    v_exp_f32 v82, v82
    v_exp_f32 v83, v83
    v_exp_f32 v84, v84
    v_exp_f32 v85, v85
    v_exp_f32 v86, v86
    v_smfmac_f32_32x32x32_bf16 v[160:175], v[28:31], v[76:83], v3
    buffer_load_dwordx4 v140, s[16:19], s57 offen offset:0 lds
    buffer_load_dwordx4 v141, s[16:19], s57 offen offset:1024 lds
    v_exp_f32 v87, v87
    v_exp_f32 v88, v88
    v_exp_f32 v89, v89
    v_exp_f32 v90, v90
    v_exp_f32 v91, v91
    v_exp_f32 v92, v92
    v_mfma_f32_32x32x16_bf16 v[108:123], v[20:23], v[4:7], 0
    v_exp_f32 v93, v93
    v_exp_f32 v94, v94
    v_exp_f32 v95, v95
    v_exp_f32 v96, v96
    v_exp_f32 v97, v97
    v_smfmac_f32_32x32x32_bf16 v[160:175], v[36:39], v[84:91], v3
    v_exp_f32 v98, v98
    v_exp_f32 v99, v99
    v_exp_f32 v100, v100
    v_exp_f32 v101, v101
    v_exp_f32 v102, v102
    v_smfmac_f32_32x32x32_bf16 v[176:191], v[28:31], v[92:99], v3
    v_exp_f32 v103, v103
    v_exp_f32 v104, v104
    v_exp_f32 v105, v105
    v_exp_f32 v106, v106
    v_exp_f32 v107, v107
    v_exp_f32 v108, v108
    v_mfma_f32_32x32x16_bf16 v[124:139], v[20:23], v[8:11], 0
    ds_read_b128 v[24:27], v200 offset:1024
    v_exp_f32 v109, v109
    v_exp_f32 v110, v110
    v_exp_f32 v111, v111
    v_exp_f32 v112, v112
    v_exp_f32 v113, v113
    v_smfmac_f32_32x32x32_bf16 v[176:191], v[36:39], v[100:107], v3
    v_exp_f32 v114, v114
    v_exp_f32 v115, v115
    v_exp_f32 v116, v116
    v_exp_f32 v117, v117
    v_exp_f32 v118, v118
    v_smfmac_f32_32x32x32_bf16 v[44:59], v[28:31], v[108:115], v3
    s_waitcnt vmcnt(19) lgkmcnt(0)
    buffer_store_dwordx4 v[236:239], v2, s[12:15], s9 offen offset:1024 sc1
    ds_read_b64_tr_b16 a[80:81], v150 offset:8192
    ds_read_b64_tr_b16 a[84:85], v156 offset:8192
    v_exp_f32 v119, v119
    v_exp_f32 v120, v120
    v_exp_f32 v121, v121
    v_exp_f32 v122, v122
    v_exp_f32 v123, v123
    v_exp_f32 v124, v124
    v_mfma_f32_32x32x16_bf16 v[76:91], v[24:27], v[204:207], 0
    ds_read_b128 v[32:35], v14 offset:0
    v_exp_f32 v125, v125
    v_exp_f32 v126, v126
    v_exp_f32 v127, v127
    v_exp_f32 v128, v128
    v_exp_f32 v129, v129
    v_smfmac_f32_32x32x32_bf16 v[44:59], v[36:39], v[116:123], v3
    s_add_u32 s93, s93, 57344
    s_cmp_eq_u32 s93, s95
    ds_read_b128 v[40:43], v15 offset:0
    v_exp_f32 v130, v130
    v_exp_f32 v131, v131
    v_exp_f32 v132, v132
    v_exp_f32 v133, v133
    v_exp_f32 v134, v134
    v_smfmac_f32_32x32x32_bf16 v[60:75], v[28:31], v[124:131], v3
    ds_read_b64_tr_b16 a[88:89], v150 offset:8704
    ds_read_b64_tr_b16 a[92:93], v156 offset:8704
    v_exp_f32 v135, v135
    v_exp_f32 v136, v136
    v_exp_f32 v137, v137
    v_exp_f32 v138, v138
    v_exp_f32 v139, v139
    v_exp_f32 v76, v76
    v_mfma_f32_32x32x16_bf16 v[92:107], v[24:27], v[208:211], 0
    s_waitcnt lgkmcnt(2)
    v_exp_f32 v77, v77
    v_exp_f32 v78, v78
    v_exp_f32 v79, v79
    v_exp_f32 v80, v80
    v_exp_f32 v81, v81
    v_smfmac_f32_32x32x32_bf16 v[60:75], v[36:39], v[132:139], v3
    s_cselect_b32 s93, s94, s93
    s_add_u32 m0, s56, 8192
    v_exp_f32 v82, v82
    v_exp_f32 v83, v83
    v_exp_f32 v84, v84
    v_exp_f32 v85, v85
    v_exp_f32 v86, v86
    v_smfmac_f32_32x32x32_bf16 v[160:175], v[32:35], v[76:83], v3
    s_waitcnt vmcnt(18) lgkmcnt(0)
    buffer_load_dwordx4 v148, s[20:23], s93 offen lds
    buffer_load_dwordx4 v149, s[20:23], s93 offen offset:1024 lds
    ds_read_b64_tr_b16 a[82:83], v150 offset:10240
    ds_read_b64_tr_b16 a[86:87], v156 offset:10240
    v_exp_f32 v87, v87
    v_exp_f32 v88, v88
    v_exp_f32 v89, v89
    v_exp_f32 v90, v90
    v_exp_f32 v91, v91
    v_exp_f32 v92, v92
    v_mfma_f32_32x32x16_bf16 v[108:123], v[24:27], v[4:7], 0
    v_exp_f32 v93, v93
    v_exp_f32 v94, v94
    v_exp_f32 v95, v95
    v_exp_f32 v96, v96
    v_exp_f32 v97, v97
    v_smfmac_f32_32x32x32_bf16 v[160:175], v[40:43], v[84:91], v3
    v_exp_f32 v98, v98
    v_exp_f32 v99, v99
    v_exp_f32 v100, v100
    v_exp_f32 v101, v101
    v_exp_f32 v102, v102
    v_smfmac_f32_32x32x32_bf16 v[176:191], v[32:35], v[92:99], v3
    ds_read_b64_tr_b16 a[90:91], v150 offset:10752
    ds_read_b64_tr_b16 a[94:95], v156 offset:10752
    v_exp_f32 v103, v103
    v_exp_f32 v104, v104
    v_exp_f32 v105, v105
    v_exp_f32 v106, v106
    v_exp_f32 v107, v107
    v_exp_f32 v108, v108
    v_mfma_f32_32x32x16_bf16 v[124:139], v[24:27], v[8:11], 0
    ds_read_b128 v[20:23], v200 offset:2048
    v_exp_f32 v109, v109
    v_exp_f32 v110, v110
    v_exp_f32 v111, v111
    v_exp_f32 v112, v112
    v_exp_f32 v113, v113
    v_smfmac_f32_32x32x32_bf16 v[176:191], v[40:43], v[100:107], v3
    s_add_u32 m0, s56, 10240
    s_add_u32 s93, s93, 57344
    v_exp_f32 v114, v114
    v_exp_f32 v115, v115
    v_exp_f32 v116, v116
    v_exp_f32 v117, v117
    v_exp_f32 v118, v118
    v_smfmac_f32_32x32x32_bf16 v[44:59], v[32:35], v[108:115], v3
    s_waitcnt lgkmcnt(0)
    buffer_load_dwordx4 v148, s[20:23], s93 offen lds
    buffer_load_dwordx4 v149, s[20:23], s93 offen offset:1024 lds
    v_exp_f32 v119, v119
    v_exp_f32 v120, v120
    v_exp_f32 v121, v121
    v_exp_f32 v122, v122
    v_exp_f32 v123, v123
    v_exp_f32 v124, v124
    v_mfma_f32_32x32x16_bf16 v[76:91], v[20:23], v[204:207], 0
    ds_read_b128 v[28:31], v16 offset:0
    v_exp_f32 v125, v125
    v_exp_f32 v126, v126
    v_exp_f32 v127, v127
    v_exp_f32 v128, v128
    v_exp_f32 v129, v129
    v_smfmac_f32_32x32x32_bf16 v[44:59], v[40:43], v[116:123], v3
    ds_read_b128 v[36:39], v17 offset:0
    v_exp_f32 v130, v130
    v_exp_f32 v131, v131
    v_exp_f32 v132, v132
    v_exp_f32 v133, v133
    v_exp_f32 v134, v134
    v_smfmac_f32_32x32x32_bf16 v[60:75], v[32:35], v[124:131], v3
    s_waitcnt vmcnt(20)
    ds_read_b64_tr_b16 a[96:97], v150 offset:0
    ds_read_b64_tr_b16 a[100:101], v156 offset:0
    v_exp_f32 v135, v135
    v_exp_f32 v136, v136
    v_exp_f32 v137, v137
    v_exp_f32 v138, v138
    v_exp_f32 v139, v139
    v_exp_f32 v76, v76
    v_mfma_f32_32x32x16_bf16 v[92:107], v[20:23], v[208:211], 0
    s_waitcnt lgkmcnt(2)
    v_exp_f32 v77, v77
    v_exp_f32 v78, v78
    v_exp_f32 v79, v79
    v_exp_f32 v80, v80
    v_exp_f32 v81, v81
    v_smfmac_f32_32x32x32_bf16 v[60:75], v[40:43], v[132:139], v3
    s_add_u32 m0, s58, 32768
    v_exp_f32 v82, v82
    v_exp_f32 v83, v83
    v_exp_f32 v84, v84
    v_exp_f32 v85, v85
    v_exp_f32 v86, v86
    v_smfmac_f32_32x32x32_bf16 v[160:175], v[28:31], v[76:83], v3
    buffer_load_dwordx4 v142, s[16:19], s57 offen offset:2048 lds
    buffer_load_dwordx4 v143, s[16:19], s57 offen offset:3072 lds
    ds_read_b64_tr_b16 a[104:105], v150 offset:512
    ds_read_b64_tr_b16 a[108:109], v156 offset:512
    v_exp_f32 v87, v87
    v_exp_f32 v88, v88
    v_exp_f32 v89, v89
    v_exp_f32 v90, v90
    v_exp_f32 v91, v91
    v_exp_f32 v92, v92
    v_mfma_f32_32x32x16_bf16 v[108:123], v[20:23], v[4:7], 0
    v_exp_f32 v93, v93
    v_exp_f32 v94, v94
    v_exp_f32 v95, v95
    v_exp_f32 v96, v96
    v_exp_f32 v97, v97
    v_smfmac_f32_32x32x32_bf16 v[160:175], v[36:39], v[84:91], v3
    s_add_u32 m0, s56, 0
    s_add_u32 s93, s93, 57344
    v_exp_f32 v98, v98
    v_exp_f32 v99, v99
    v_exp_f32 v100, v100
    v_exp_f32 v101, v101
    v_exp_f32 v102, v102
    v_smfmac_f32_32x32x32_bf16 v[176:191], v[28:31], v[92:99], v3
    s_waitcnt vmcnt(18) lgkmcnt(0)
    buffer_load_dwordx4 v148, s[20:23], s93 offen lds
    buffer_load_dwordx4 v149, s[20:23], s93 offen offset:1024 lds
    ds_read_b64_tr_b16 a[98:99], v150 offset:2048
    ds_read_b64_tr_b16 a[102:103], v156 offset:2048
    v_exp_f32 v103, v103
    v_exp_f32 v104, v104
    v_exp_f32 v105, v105
    v_exp_f32 v106, v106
    v_exp_f32 v107, v107
    v_exp_f32 v108, v108
    v_mfma_f32_32x32x16_bf16 v[124:139], v[20:23], v[8:11], 0
    ds_read_b128 v[24:27], v200 offset:3072
    v_exp_f32 v109, v109
    v_exp_f32 v110, v110
    v_exp_f32 v111, v111
    v_exp_f32 v112, v112
    v_exp_f32 v113, v113
    v_smfmac_f32_32x32x32_bf16 v[176:191], v[36:39], v[100:107], v3
    v_exp_f32 v114, v114
    v_exp_f32 v115, v115
    v_exp_f32 v116, v116
    v_exp_f32 v117, v117
    v_exp_f32 v118, v118
    v_smfmac_f32_32x32x32_bf16 v[44:59], v[28:31], v[108:115], v3
    s_waitcnt lgkmcnt(0)
    buffer_store_dwordx4 v[236:239], v2, s[12:15], s10 offen offset:0 sc1
    ds_read_b64_tr_b16 a[106:107], v150 offset:2560
    ds_read_b64_tr_b16 a[110:111], v156 offset:2560
    v_exp_f32 v119, v119
    v_exp_f32 v120, v120
    v_exp_f32 v121, v121
    v_exp_f32 v122, v122
    v_exp_f32 v123, v123
    v_exp_f32 v124, v124
    v_mfma_f32_32x32x16_bf16 v[76:91], v[24:27], v[204:207], 0
    ds_read_b128 v[32:35], v18 offset:0
    v_exp_f32 v125, v125
    v_exp_f32 v126, v126
    v_exp_f32 v127, v127
    v_exp_f32 v128, v128
    v_exp_f32 v129, v129
    v_smfmac_f32_32x32x32_bf16 v[44:59], v[36:39], v[116:123], v3
    s_add_u32 m0, s56, 2048
    s_add_u32 s93, s93, 57344
    ds_read_b128 v[40:43], v19 offset:0
    v_exp_f32 v130, v130
    v_exp_f32 v131, v131
    v_exp_f32 v132, v132
    v_exp_f32 v133, v133
    v_exp_f32 v134, v134
    v_smfmac_f32_32x32x32_bf16 v[60:75], v[28:31], v[124:131], v3
    s_waitcnt vmcnt(18) lgkmcnt(2)
    buffer_load_dwordx4 v148, s[20:23], s93 offen lds
    buffer_load_dwordx4 v149, s[20:23], s93 offen offset:1024 lds
    ds_read_b64_tr_b16 a[112:113], v150 offset:4096
    ds_read_b64_tr_b16 a[116:117], v156 offset:4096
    v_exp_f32 v135, v135
    v_exp_f32 v136, v136
    v_exp_f32 v137, v137
    v_exp_f32 v138, v138
    v_exp_f32 v139, v139
    v_exp_f32 v76, v76
    v_mfma_f32_32x32x16_bf16 v[92:107], v[24:27], v[208:211], 0
    s_waitcnt lgkmcnt(2)
    v_exp_f32 v77, v77
    v_exp_f32 v78, v78
    v_exp_f32 v79, v79
    v_exp_f32 v80, v80
    v_exp_f32 v81, v81
    v_smfmac_f32_32x32x32_bf16 v[60:75], v[36:39], v[132:139], v3
    s_add_u32 s93, s93, 57344
    s_cmp_eq_u32 s93, s95
    v_exp_f32 v82, v82
    v_exp_f32 v83, v83
    v_exp_f32 v84, v84
    v_exp_f32 v85, v85
    v_exp_f32 v86, v86
    v_smfmac_f32_32x32x32_bf16 v[160:175], v[32:35], v[76:83], v3
    ds_read_b64_tr_b16 a[120:121], v150 offset:4608
    ds_read_b64_tr_b16 a[124:125], v156 offset:4608
    v_exp_f32 v87, v87
    v_exp_f32 v88, v88
    v_exp_f32 v89, v89
    v_exp_f32 v90, v90
    v_exp_f32 v91, v91
    v_exp_f32 v92, v92
    v_mfma_f32_32x32x16_bf16 v[108:123], v[24:27], v[4:7], 0
    v_exp_f32 v93, v93
    v_exp_f32 v94, v94
    v_exp_f32 v95, v95
    v_exp_f32 v96, v96
    v_exp_f32 v97, v97
    v_smfmac_f32_32x32x32_bf16 v[160:175], v[40:43], v[84:91], v3
    s_cselect_b32 s93, s94, s93
    s_add_u32 m0, s56, 4096
    v_exp_f32 v98, v98
    v_exp_f32 v99, v99
    v_exp_f32 v100, v100
    v_exp_f32 v101, v101
    v_exp_f32 v102, v102
    v_smfmac_f32_32x32x32_bf16 v[176:191], v[32:35], v[92:99], v3
    s_waitcnt lgkmcnt(0)
    buffer_load_dwordx4 v148, s[20:23], s93 offen lds
    buffer_load_dwordx4 v149, s[20:23], s93 offen offset:1024 lds
    v_exp_f32 v103, v103
    v_exp_f32 v104, v104
    v_exp_f32 v105, v105
    v_exp_f32 v106, v106
    v_exp_f32 v107, v107
    v_exp_f32 v108, v108
    v_mfma_f32_32x32x16_bf16 v[124:139], v[24:27], v[8:11], 0
    s_waitcnt vmcnt(16)
    s_barrier
    ds_read_b128 v[20:23], v200 offset:8192
    v_exp_f32 v109, v109
    v_exp_f32 v110, v110
    v_exp_f32 v111, v111
    v_exp_f32 v112, v112
    v_exp_f32 v113, v113
    v_smfmac_f32_32x32x32_bf16 v[176:191], v[40:43], v[100:107], v3
    s_add_u32 m0, s53, 0
    s_add_u32 s52, s52, 8192
    v_exp_f32 v114, v114
    v_exp_f32 v115, v115
    v_exp_f32 v116, v116
    v_exp_f32 v117, v117
    v_exp_f32 v118, v118
    v_smfmac_f32_32x32x32_bf16 v[44:59], v[32:35], v[108:115], v3
    s_waitcnt lgkmcnt(0)
    buffer_load_dwordx4 v2, s[12:15], s52 offen offset:0 sc1 lds
    buffer_load_dwordx4 v2, s[12:15], s52 offen offset:1024 sc1 lds
    v_exp_f32 v119, v119
    v_exp_f32 v120, v120
    v_exp_f32 v121, v121
    v_exp_f32 v122, v122
    v_exp_f32 v123, v123
    v_exp_f32 v124, v124
    v_mfma_f32_32x32x16_bf16 v[76:91], v[20:23], v[204:207], 0
    ds_read_b128 v[28:31], v12 offset:8384
    v_exp_f32 v125, v125
    v_exp_f32 v126, v126
    v_exp_f32 v127, v127
    v_exp_f32 v128, v128
    v_exp_f32 v129, v129
    v_smfmac_f32_32x32x32_bf16 v[44:59], v[40:43], v[116:123], v3
    s_add_u32 m0, s54, 16384
    ds_read_b128 v[36:39], v13 offset:8384
    v_exp_f32 v130, v130
    v_exp_f32 v131, v131
    v_exp_f32 v132, v132
    v_exp_f32 v133, v133
    v_exp_f32 v134, v134
    v_smfmac_f32_32x32x32_bf16 v[60:75], v[32:35], v[124:131], v3
    buffer_load_dwordx4 v153, s[12:15], s52 offen offset:0 sc1 lds
    buffer_load_dwordx4 v153, s[12:15], s52 offen offset:1024 sc1 lds
    ds_read_b64_tr_b16 a[114:115], v150 offset:6144
    ds_read_b64_tr_b16 a[118:119], v156 offset:6144
    v_exp_f32 v135, v135
    v_exp_f32 v136, v136
    v_exp_f32 v137, v137
    v_exp_f32 v138, v138
    v_exp_f32 v139, v139
    v_exp_f32 v76, v76
    v_mfma_f32_32x32x16_bf16 v[92:107], v[20:23], v[208:211], 0
    s_waitcnt lgkmcnt(2)
    v_exp_f32 v77, v77
    v_exp_f32 v78, v78
    v_exp_f32 v79, v79
    v_exp_f32 v80, v80
    v_exp_f32 v81, v81
    v_smfmac_f32_32x32x32_bf16 v[60:75], v[40:43], v[132:139], v3
    s_add_u32 m0, s58, 49152
    s_xor_b32 s57, s57, 131072
    v_exp_f32 v82, v82
    v_exp_f32 v83, v83
    v_exp_f32 v84, v84
    v_exp_f32 v85, v85
    v_exp_f32 v86, v86
    v_smfmac_f32_32x32x32_bf16 v[160:175], v[28:31], v[76:83], v3
    buffer_load_dwordx4 v140, s[16:19], s57 offen offset:0 lds
    buffer_load_dwordx4 v141, s[16:19], s57 offen offset:1024 lds
    ds_read_b64_tr_b16 a[122:123], v150 offset:6656
    ds_read_b64_tr_b16 a[126:127], v156 offset:6656
    v_exp_f32 v87, v87
    v_exp_f32 v88, v88
    v_exp_f32 v89, v89
    v_exp_f32 v90, v90
    v_exp_f32 v91, v91
    v_exp_f32 v92, v92
    v_mfma_f32_32x32x16_bf16 v[108:123], v[20:23], v[4:7], 0
    v_exp_f32 v93, v93
    v_exp_f32 v94, v94
    v_exp_f32 v95, v95
    v_exp_f32 v96, v96
    v_exp_f32 v97, v97
    v_smfmac_f32_32x32x32_bf16 v[160:175], v[36:39], v[84:91], v3
    s_add_u32 m0, s56, 6144
    s_add_u32 s93, s93, 57344
    v_exp_f32 v98, v98
    v_exp_f32 v99, v99
    v_exp_f32 v100, v100
    v_exp_f32 v101, v101
    v_exp_f32 v102, v102
    v_smfmac_f32_32x32x32_bf16 v[176:191], v[28:31], v[92:99], v3
    s_waitcnt vmcnt(17) lgkmcnt(0)
    buffer_load_dwordx4 v148, s[20:23], s93 offen lds
    buffer_load_dwordx4 v149, s[20:23], s93 offen offset:1024 lds
    ds_read_b64_tr_b16 a[128:129], v150 offset:8192
    ds_read_b64_tr_b16 a[132:133], v156 offset:8192
    v_exp_f32 v103, v103
    v_exp_f32 v104, v104
    v_exp_f32 v105, v105
    v_exp_f32 v106, v106
    v_exp_f32 v107, v107
    v_exp_f32 v108, v108
    v_mfma_f32_32x32x16_bf16 v[124:139], v[20:23], v[8:11], 0
    ds_read_b128 v[24:27], v200 offset:9216
    v_exp_f32 v109, v109
    v_exp_f32 v110, v110
    v_exp_f32 v111, v111
    v_exp_f32 v112, v112
    v_exp_f32 v113, v113
    v_smfmac_f32_32x32x32_bf16 v[176:191], v[36:39], v[100:107], v3
    v_exp_f32 v114, v114
    v_exp_f32 v115, v115
    v_exp_f32 v116, v116
    v_exp_f32 v117, v117
    v_exp_f32 v118, v118
    v_smfmac_f32_32x32x32_bf16 v[44:59], v[28:31], v[108:115], v3
    s_waitcnt lgkmcnt(0)
    buffer_store_dwordx4 v[236:239], v2, s[12:15], s10 offen offset:1024 sc1
    ds_read_b64_tr_b16 a[136:137], v150 offset:8704
    ds_read_b64_tr_b16 a[140:141], v156 offset:8704
    v_exp_f32 v119, v119
    v_exp_f32 v120, v120
    v_exp_f32 v121, v121
    v_exp_f32 v122, v122
    v_exp_f32 v123, v123
    v_exp_f32 v124, v124
    v_mfma_f32_32x32x16_bf16 v[76:91], v[24:27], v[204:207], 0
    ds_read_b128 v[32:35], v14 offset:8384
    v_exp_f32 v125, v125
    v_exp_f32 v126, v126
    v_exp_f32 v127, v127
    v_exp_f32 v128, v128
    v_exp_f32 v129, v129
    v_smfmac_f32_32x32x32_bf16 v[44:59], v[36:39], v[116:123], v3
    s_add_u32 m0, s56, 8192
    s_add_u32 s93, s93, 57344
    ds_read_b128 v[40:43], v15 offset:8384
    v_exp_f32 v130, v130
    v_exp_f32 v131, v131
    v_exp_f32 v132, v132
    v_exp_f32 v133, v133
    v_exp_f32 v134, v134
    v_smfmac_f32_32x32x32_bf16 v[60:75], v[28:31], v[124:131], v3
    s_waitcnt vmcnt(18) lgkmcnt(2)
    buffer_load_dwordx4 v148, s[20:23], s93 offen lds
    buffer_load_dwordx4 v149, s[20:23], s93 offen offset:1024 lds
    ds_read_b64_tr_b16 a[130:131], v150 offset:10240
    ds_read_b64_tr_b16 a[134:135], v156 offset:10240
    v_exp_f32 v135, v135
    v_exp_f32 v136, v136
    v_exp_f32 v137, v137
    v_exp_f32 v138, v138
    v_exp_f32 v139, v139
    v_exp_f32 v76, v76
    v_mfma_f32_32x32x16_bf16 v[92:107], v[24:27], v[208:211], 0
    s_waitcnt lgkmcnt(2)
    v_exp_f32 v77, v77
    v_exp_f32 v78, v78
    v_exp_f32 v79, v79
    v_exp_f32 v80, v80
    v_exp_f32 v81, v81
    v_smfmac_f32_32x32x32_bf16 v[60:75], v[36:39], v[132:139], v3
    v_exp_f32 v82, v82
    v_exp_f32 v83, v83
    v_exp_f32 v84, v84
    v_exp_f32 v85, v85
    v_exp_f32 v86, v86
    v_smfmac_f32_32x32x32_bf16 v[160:175], v[32:35], v[76:83], v3
    ds_read_b64_tr_b16 a[138:139], v150 offset:10752
    ds_read_b64_tr_b16 a[142:143], v156 offset:10752
    v_exp_f32 v87, v87
    v_exp_f32 v88, v88
    v_exp_f32 v89, v89
    v_exp_f32 v90, v90
    v_exp_f32 v91, v91
    v_exp_f32 v92, v92
    v_mfma_f32_32x32x16_bf16 v[108:123], v[24:27], v[4:7], 0
    v_exp_f32 v93, v93
    v_exp_f32 v94, v94
    v_exp_f32 v95, v95
    v_exp_f32 v96, v96
    v_exp_f32 v97, v97
    v_smfmac_f32_32x32x32_bf16 v[160:175], v[40:43], v[84:91], v3
    s_add_u32 m0, s56, 10240
    s_add_u32 s93, s93, 57344
    v_exp_f32 v98, v98
    v_exp_f32 v99, v99
    v_exp_f32 v100, v100
    v_exp_f32 v101, v101
    v_exp_f32 v102, v102
    v_smfmac_f32_32x32x32_bf16 v[176:191], v[32:35], v[92:99], v3
    s_waitcnt vmcnt(16) lgkmcnt(0)
    buffer_load_dwordx4 v148, s[20:23], s93 offen lds
    buffer_load_dwordx4 v149, s[20:23], s93 offen offset:1024 lds
    ds_read_b64_tr_b16 a[144:145], v150 offset:0
    ds_read_b64_tr_b16 a[148:149], v156 offset:0
    v_exp_f32 v103, v103
    v_exp_f32 v104, v104
    v_exp_f32 v105, v105
    v_exp_f32 v106, v106
    v_exp_f32 v107, v107
    v_exp_f32 v108, v108
    v_mfma_f32_32x32x16_bf16 v[124:139], v[24:27], v[8:11], 0
L_pad_4:
    s_cbranch_execz L_pad_8
    ds_read_b128 v[20:23], v200 offset:10240
    v_exp_f32 v109, v109
    v_exp_f32 v110, v110
    v_exp_f32 v111, v111
    v_exp_f32 v112, v112
    v_exp_f32 v113, v113
    v_smfmac_f32_32x32x32_bf16 v[176:191], v[40:43], v[100:107], v3
    s_add_u32 s93, s93, 57344
    s_cmp_eq_u32 s93, s95
    v_exp_f32 v114, v114
    v_exp_f32 v115, v115
    v_exp_f32 v116, v116
    v_exp_f32 v117, v117
    v_exp_f32 v118, v118
    v_smfmac_f32_32x32x32_bf16 v[44:59], v[32:35], v[108:115], v3
    s_waitcnt lgkmcnt(0)
    ds_read_b64_tr_b16 a[152:153], v150 offset:512
    ds_read_b64_tr_b16 a[156:157], v156 offset:512
    v_exp_f32 v119, v119
    v_exp_f32 v120, v120
    v_exp_f32 v121, v121
    v_exp_f32 v122, v122
    v_exp_f32 v123, v123
    v_exp_f32 v124, v124
    v_mfma_f32_32x32x16_bf16 v[76:91], v[20:23], v[204:207], 0
    ds_read_b128 v[28:31], v16 offset:8384
    v_exp_f32 v125, v125
    v_exp_f32 v126, v126
    v_exp_f32 v127, v127
    v_exp_f32 v128, v128
    v_exp_f32 v129, v129
    v_smfmac_f32_32x32x32_bf16 v[44:59], v[40:43], v[116:123], v3
    s_cselect_b32 s93, s94, s93
    s_add_u32 m0, s56, 0
    ds_read_b128 v[36:39], v17 offset:8384
    v_exp_f32 v130, v130
    v_exp_f32 v131, v131
    v_exp_f32 v132, v132
    v_exp_f32 v133, v133
    v_exp_f32 v134, v134
    v_smfmac_f32_32x32x32_bf16 v[60:75], v[32:35], v[124:131], v3
    s_waitcnt vmcnt(15) lgkmcnt(2)
    buffer_load_dwordx4 v148, s[20:23], s93 offen lds
    buffer_load_dwordx4 v149, s[20:23], s93 offen offset:1024 lds
    ds_read_b64_tr_b16 a[146:147], v150 offset:2048
    ds_read_b64_tr_b16 a[150:151], v156 offset:2048
    v_exp_f32 v135, v135
    v_exp_f32 v136, v136
    v_exp_f32 v137, v137
    v_exp_f32 v138, v138
    v_exp_f32 v139, v139
    v_exp_f32 v76, v76
    v_mfma_f32_32x32x16_bf16 v[92:107], v[20:23], v[208:211], 0
    s_waitcnt lgkmcnt(2)
    v_exp_f32 v77, v77
    v_exp_f32 v78, v78
    v_exp_f32 v79, v79
    v_exp_f32 v80, v80
    v_exp_f32 v81, v81
    v_smfmac_f32_32x32x32_bf16 v[60:75], v[40:43], v[132:139], v3
    s_add_u32 m0, s58, 49152
    v_exp_f32 v82, v82
    v_exp_f32 v83, v83
    v_exp_f32 v84, v84
    v_exp_f32 v85, v85
    v_exp_f32 v86, v86
    v_smfmac_f32_32x32x32_bf16 v[160:175], v[28:31], v[76:83], v3
    buffer_load_dwordx4 v142, s[16:19], s57 offen offset:2048 lds
    buffer_load_dwordx4 v143, s[16:19], s57 offen offset:3072 lds
    ds_read_b64_tr_b16 a[154:155], v150 offset:2560
    ds_read_b64_tr_b16 a[158:159], v156 offset:2560
    v_exp_f32 v87, v87
    v_exp_f32 v88, v88
    v_exp_f32 v89, v89
    v_exp_f32 v90, v90
    v_exp_f32 v91, v91
    v_exp_f32 v92, v92
    v_mfma_f32_32x32x16_bf16 v[108:123], v[20:23], v[4:7], 0
    v_exp_f32 v93, v93
    v_exp_f32 v94, v94
    v_exp_f32 v95, v95
    v_exp_f32 v96, v96
    v_exp_f32 v97, v97
    v_smfmac_f32_32x32x32_bf16 v[160:175], v[36:39], v[84:91], v3
    s_add_u32 m0, s56, 2048
    s_add_u32 s93, s93, 57344
    v_exp_f32 v98, v98
    v_exp_f32 v99, v99
    v_exp_f32 v100, v100
    v_exp_f32 v101, v101
    v_exp_f32 v102, v102
    v_smfmac_f32_32x32x32_bf16 v[176:191], v[28:31], v[92:99], v3
    s_waitcnt lgkmcnt(0)
    buffer_load_dwordx4 v148, s[20:23], s93 offen lds
    buffer_load_dwordx4 v149, s[20:23], s93 offen offset:1024 lds
    v_exp_f32 v103, v103
    v_exp_f32 v104, v104
    v_exp_f32 v105, v105
    v_exp_f32 v106, v106
    v_exp_f32 v107, v107
    v_exp_f32 v108, v108
    v_mfma_f32_32x32x16_bf16 v[124:139], v[20:23], v[8:11], 0
    ds_read_b128 v[24:27], v200 offset:11264
    v_exp_f32 v109, v109
    v_exp_f32 v110, v110
    v_exp_f32 v111, v111
    v_exp_f32 v112, v112
    v_exp_f32 v113, v113
    v_smfmac_f32_32x32x32_bf16 v[176:191], v[36:39], v[100:107], v3
    v_exp_f32 v114, v114
    v_exp_f32 v115, v115
    v_exp_f32 v116, v116
    v_exp_f32 v117, v117
    v_exp_f32 v118, v118
    v_smfmac_f32_32x32x32_bf16 v[44:59], v[28:31], v[108:115], v3
    s_waitcnt vmcnt(19) lgkmcnt(0)
    ds_read_b64_tr_b16 a[160:161], v150 offset:4096
    ds_read_b64_tr_b16 a[164:165], v156 offset:4096
    v_exp_f32 v119, v119
    v_exp_f32 v120, v120
    v_exp_f32 v121, v121
    v_exp_f32 v122, v122
    v_exp_f32 v123, v123
    v_exp_f32 v124, v124
    v_mfma_f32_32x32x16_bf16 v[76:91], v[24:27], v[204:207], 0
    ds_read_b128 v[32:35], v18 offset:8384
    v_exp_f32 v125, v125
    v_exp_f32 v126, v126
    v_exp_f32 v127, v127
    v_exp_f32 v128, v128
    v_exp_f32 v129, v129
    v_smfmac_f32_32x32x32_bf16 v[44:59], v[36:39], v[116:123], v3
    s_add_u32 s47, s8, 0
    ds_read_b128 v[40:43], v19 offset:8384
    v_exp_f32 v130, v130
    v_exp_f32 v131, v131
    v_exp_f32 v132, v132
    v_exp_f32 v133, v133
    v_exp_f32 v134, v134
    v_smfmac_f32_32x32x32_bf16 v[60:75], v[28:31], v[124:131], v3
    buffer_store_dwordx4 v[236:239], v2, s[12:15], s47 offen sc1
    ds_read_b64_tr_b16 a[168:169], v150 offset:4608
    ds_read_b64_tr_b16 a[172:173], v156 offset:4608
    v_exp_f32 v135, v135
    v_exp_f32 v136, v136
    v_exp_f32 v137, v137
    v_exp_f32 v138, v138
    v_exp_f32 v139, v139
    v_exp_f32 v76, v76
    v_mfma_f32_32x32x16_bf16 v[92:107], v[24:27], v[208:211], 0
    s_waitcnt lgkmcnt(2)
    v_exp_f32 v77, v77
    v_exp_f32 v78, v78
    v_exp_f32 v79, v79
    v_exp_f32 v80, v80
    v_exp_f32 v81, v81
    v_smfmac_f32_32x32x32_bf16 v[60:75], v[36:39], v[132:139], v3
    s_add_u32 m0, s56, 4096
    s_add_u32 s93, s93, 57344
    v_exp_f32 v82, v82
    v_exp_f32 v83, v83
    v_exp_f32 v84, v84
    v_exp_f32 v85, v85
    v_exp_f32 v86, v86
    v_smfmac_f32_32x32x32_bf16 v[160:175], v[32:35], v[76:83], v3
    s_waitcnt lgkmcnt(0)
    buffer_load_dwordx4 v148, s[20:23], s93 offen lds
    buffer_load_dwordx4 v149, s[20:23], s93 offen offset:1024 lds
    v_exp_f32 v87, v87
    v_exp_f32 v88, v88
    v_exp_f32 v89, v89
    v_exp_f32 v90, v90
    v_exp_f32 v91, v91
    v_exp_f32 v92, v92
    v_mfma_f32_32x32x16_bf16 v[108:123], v[24:27], v[4:7], 0
    v_exp_f32 v93, v93
    v_exp_f32 v94, v94
    v_exp_f32 v95, v95
    v_exp_f32 v96, v96
    v_exp_f32 v97, v97
    v_smfmac_f32_32x32x32_bf16 v[160:175], v[40:43], v[84:91], v3
    s_add_u32 s47, s8, 32768
    v_exp_f32 v98, v98
    v_exp_f32 v99, v99
    v_exp_f32 v100, v100
    v_exp_f32 v101, v101
    v_exp_f32 v102, v102
    v_smfmac_f32_32x32x32_bf16 v[176:191], v[32:35], v[92:99], v3
    buffer_store_dwordx4 v[236:239], v2, s[12:15], s47 offen sc1
    v_exp_f32 v103, v103
    v_exp_f32 v104, v104
    v_exp_f32 v105, v105
    v_exp_f32 v106, v106
    v_exp_f32 v107, v107
    v_exp_f32 v108, v108
    v_mfma_f32_32x32x16_bf16 v[124:139], v[24:27], v[8:11], 0
    s_waitcnt vmcnt(19)
    s_barrier
    ds_read_b128 v[20:23], v200 offset:0
    v_exp_f32 v109, v109
    v_exp_f32 v110, v110
    v_exp_f32 v111, v111
    v_exp_f32 v112, v112
    v_exp_f32 v113, v113
    v_smfmac_f32_32x32x32_bf16 v[176:191], v[40:43], v[100:107], v3
    s_add_u32 m0, s53, 8192
    s_add_u32 s52, s52, 8192
    v_exp_f32 v114, v114
    v_exp_f32 v115, v115
    v_exp_f32 v116, v116
    v_exp_f32 v117, v117
    v_exp_f32 v118, v118
    v_smfmac_f32_32x32x32_bf16 v[44:59], v[32:35], v[108:115], v3
    s_waitcnt vmcnt(15) lgkmcnt(0)
    buffer_load_dwordx4 v2, s[12:15], s52 offen offset:0 sc1 lds
    buffer_load_dwordx4 v2, s[12:15], s52 offen offset:1024 sc1 lds
    ds_read_b64_tr_b16 a[162:163], v150 offset:6144
    ds_read_b64_tr_b16 a[166:167], v156 offset:6144
    v_exp_f32 v119, v119
    v_exp_f32 v120, v120
    v_exp_f32 v121, v121
    v_exp_f32 v122, v122
    v_exp_f32 v123, v123
    v_exp_f32 v124, v124
    v_mfma_f32_32x32x16_bf16 v[76:91], v[20:23], v[204:207], 0
    ds_read_b128 v[28:31], v12 offset:0
    v_exp_f32 v125, v125
    v_exp_f32 v126, v126
    v_exp_f32 v127, v127
    v_exp_f32 v128, v128
    v_exp_f32 v129, v129
    v_smfmac_f32_32x32x32_bf16 v[44:59], v[40:43], v[116:123], v3
    s_add_u32 m0, s54, 24768
    ds_read_b128 v[36:39], v13 offset:0
    v_exp_f32 v130, v130
    v_exp_f32 v131, v131
    v_exp_f32 v132, v132
    v_exp_f32 v133, v133
    v_exp_f32 v134, v134
    v_smfmac_f32_32x32x32_bf16 v[60:75], v[32:35], v[124:131], v3
    buffer_load_dwordx4 v153, s[12:15], s52 offen offset:0 sc1 lds
    buffer_load_dwordx4 v153, s[12:15], s52 offen offset:1024 sc1 lds
    ds_read_b64_tr_b16 a[170:171], v150 offset:6656
    ds_read_b64_tr_b16 a[174:175], v156 offset:6656
    v_exp_f32 v135, v135
    v_exp_f32 v136, v136
    v_exp_f32 v137, v137
    v_exp_f32 v138, v138
    v_exp_f32 v139, v139
    v_exp_f32 v76, v76
    v_mfma_f32_32x32x16_bf16 v[92:107], v[20:23], v[208:211], 0
    s_waitcnt lgkmcnt(2)
    v_exp_f32 v77, v77
    v_exp_f32 v78, v78
    v_exp_f32 v79, v79
    v_exp_f32 v80, v80
    v_exp_f32 v81, v81
    v_smfmac_f32_32x32x32_bf16 v[60:75], v[40:43], v[132:139], v3
    s_add_u32 m0, s56, 6144
    s_add_u32 s93, s93, 57344
    v_exp_f32 v82, v82
    v_exp_f32 v83, v83
    v_exp_f32 v84, v84
    v_exp_f32 v85, v85
    v_exp_f32 v86, v86
    v_smfmac_f32_32x32x32_bf16 v[160:175], v[28:31], v[76:83], v3
    s_waitcnt lgkmcnt(0)
    buffer_load_dwordx4 v148, s[20:23], s93 offen lds
    buffer_load_dwordx4 v149, s[20:23], s93 offen offset:1024 lds
    v_exp_f32 v87, v87
    v_exp_f32 v88, v88
    v_exp_f32 v89, v89
    v_exp_f32 v90, v90
    v_exp_f32 v91, v91
    v_exp_f32 v92, v92
    v_mfma_f32_32x32x16_bf16 v[108:123], v[20:23], v[4:7], 0
    v_exp_f32 v93, v93
    v_exp_f32 v94, v94
    v_exp_f32 v95, v95
    v_exp_f32 v96, v96
    v_exp_f32 v97, v97
    v_smfmac_f32_32x32x32_bf16 v[160:175], v[36:39], v[84:91], v3
    v_exp_f32 v98, v98
    v_exp_f32 v99, v99
    v_exp_f32 v100, v100
    v_exp_f32 v101, v101
    v_exp_f32 v102, v102
    v_smfmac_f32_32x32x32_bf16 v[176:191], v[28:31], v[92:99], v3
    s_waitcnt vmcnt(18)
    buffer_load_dword v145, v144, s[24:27], s60 offen
    ds_read_b64_tr_b16 a[176:177], v150 offset:8192
    ds_read_b64_tr_b16 a[180:181], v156 offset:8192
    v_exp_f32 v103, v103
    v_exp_f32 v104, v104
    v_exp_f32 v105, v105
    v_exp_f32 v106, v106
    v_exp_f32 v107, v107
    v_exp_f32 v108, v108
    v_mfma_f32_32x32x16_bf16 v[124:139], v[20:23], v[8:11], 0
    ds_read_b128 v[24:27], v200 offset:1024
    v_exp_f32 v109, v109
    v_exp_f32 v110, v110
    v_exp_f32 v111, v111
    v_exp_f32 v112, v112
    v_exp_f32 v113, v113
    v_smfmac_f32_32x32x32_bf16 v[176:191], v[36:39], v[100:107], v3
    s_add_u32 s93, s93, 57344
    s_cmp_eq_u32 s93, s95
    v_exp_f32 v114, v114
    v_exp_f32 v115, v115
    v_exp_f32 v116, v116
    v_exp_f32 v117, v117
    v_exp_f32 v118, v118
    v_smfmac_f32_32x32x32_bf16 v[44:59], v[28:31], v[108:115], v3
    s_waitcnt lgkmcnt(0)
    ds_read_b64_tr_b16 a[184:185], v150 offset:8704
    ds_read_b64_tr_b16 a[188:189], v156 offset:8704
    v_exp_f32 v119, v119
    v_exp_f32 v120, v120
    v_exp_f32 v121, v121
    v_exp_f32 v122, v122
    v_exp_f32 v123, v123
    v_exp_f32 v124, v124
    v_mfma_f32_32x32x16_bf16 v[76:91], v[24:27], v[204:207], 0
    ds_read_b128 v[32:35], v14 offset:0
    v_exp_f32 v125, v125
    v_exp_f32 v126, v126
    v_exp_f32 v127, v127
    v_exp_f32 v128, v128
    v_exp_f32 v129, v129
    v_smfmac_f32_32x32x32_bf16 v[44:59], v[36:39], v[116:123], v3
    s_cselect_b32 s93, s94, s93
    s_add_u32 m0, s56, 8192
    ds_read_b128 v[40:43], v15 offset:0
    v_exp_f32 v130, v130
    v_exp_f32 v131, v131
    v_exp_f32 v132, v132
    v_exp_f32 v133, v133
    v_exp_f32 v134, v134
    v_smfmac_f32_32x32x32_bf16 v[60:75], v[28:31], v[124:131], v3
    s_waitcnt vmcnt(17) lgkmcnt(2)
    buffer_load_dwordx4 v148, s[20:23], s93 offen lds
    buffer_load_dwordx4 v149, s[20:23], s93 offen offset:1024 lds
    ds_read_b64_tr_b16 a[178:179], v150 offset:10240
    ds_read_b64_tr_b16 a[182:183], v156 offset:10240
    v_exp_f32 v135, v135
    v_exp_f32 v136, v136
    v_exp_f32 v137, v137
    v_exp_f32 v138, v138
    v_exp_f32 v139, v139
    v_exp_f32 v76, v76
    v_mfma_f32_32x32x16_bf16 v[92:107], v[24:27], v[208:211], 0
    s_waitcnt lgkmcnt(2)
    v_exp_f32 v77, v77
    v_exp_f32 v78, v78
    v_exp_f32 v79, v79
    v_exp_f32 v80, v80
    v_exp_f32 v81, v81
    v_smfmac_f32_32x32x32_bf16 v[60:75], v[36:39], v[132:139], v3
    s_add_u32 s60, s60, 8192
    v_exp_f32 v82, v82
    v_exp_f32 v83, v83
    v_exp_f32 v84, v84
    v_exp_f32 v85, v85
    v_exp_f32 v86, v86
    v_smfmac_f32_32x32x32_bf16 v[160:175], v[32:35], v[76:83], v3
    buffer_load_dword v145, v144, s[24:27], s60 offen
    ds_read_b64_tr_b16 a[186:187], v150 offset:10752
    ds_read_b64_tr_b16 a[190:191], v156 offset:10752
    v_exp_f32 v87, v87
    v_exp_f32 v88, v88
    v_exp_f32 v89, v89
    v_exp_f32 v90, v90
    v_exp_f32 v91, v91
    v_exp_f32 v92, v92
    v_mfma_f32_32x32x16_bf16 v[108:123], v[24:27], v[4:7], 0
    v_exp_f32 v93, v93
    v_exp_f32 v94, v94
    v_exp_f32 v95, v95
    v_exp_f32 v96, v96
    v_exp_f32 v97, v97
    v_smfmac_f32_32x32x32_bf16 v[160:175], v[40:43], v[84:91], v3
    s_add_u32 m0, s56, 10240
    s_add_u32 s93, s93, 57344
    v_exp_f32 v98, v98
    v_exp_f32 v99, v99
    v_exp_f32 v100, v100
    v_exp_f32 v101, v101
    v_exp_f32 v102, v102
    v_smfmac_f32_32x32x32_bf16 v[176:191], v[32:35], v[92:99], v3
    s_waitcnt lgkmcnt(0)
    buffer_load_dwordx4 v148, s[20:23], s93 offen lds
    buffer_load_dwordx4 v149, s[20:23], s93 offen offset:1024 lds
    v_exp_f32 v103, v103
    v_exp_f32 v104, v104
    v_exp_f32 v105, v105
    v_exp_f32 v106, v106
    v_exp_f32 v107, v107
    v_exp_f32 v108, v108
    v_mfma_f32_32x32x16_bf16 v[124:139], v[24:27], v[8:11], 0
    ds_read_b128 v[20:23], v200 offset:2048
    v_exp_f32 v109, v109
    v_exp_f32 v110, v110
    v_exp_f32 v111, v111
    v_exp_f32 v112, v112
    v_exp_f32 v113, v113
    v_smfmac_f32_32x32x32_bf16 v[176:191], v[40:43], v[100:107], v3
    v_exp_f32 v114, v114
    v_exp_f32 v115, v115
    v_exp_f32 v116, v116
    v_exp_f32 v117, v117
    v_exp_f32 v118, v118
    v_smfmac_f32_32x32x32_bf16 v[44:59], v[32:35], v[108:115], v3
    s_waitcnt vmcnt(20) lgkmcnt(0)
    ds_read_b64_tr_b16 a[192:193], v150 offset:0
    ds_read_b64_tr_b16 a[196:197], v156 offset:0
    v_exp_f32 v119, v119
    v_exp_f32 v120, v120
    v_exp_f32 v121, v121
    v_exp_f32 v122, v122
    v_exp_f32 v123, v123
    v_exp_f32 v124, v124
    v_mfma_f32_32x32x16_bf16 v[76:91], v[20:23], v[204:207], 0
    ds_read_b128 v[28:31], v16 offset:0
    v_exp_f32 v125, v125
    v_exp_f32 v126, v126
    v_exp_f32 v127, v127
    v_exp_f32 v128, v128
    v_exp_f32 v129, v129
    v_smfmac_f32_32x32x32_bf16 v[44:59], v[40:43], v[116:123], v3
    s_add_u32 s60, s60, 8192
    ds_read_b128 v[36:39], v17 offset:0
    v_exp_f32 v130, v130
    v_exp_f32 v131, v131
    v_exp_f32 v132, v132
    v_exp_f32 v133, v133
    v_exp_f32 v134, v134
    v_smfmac_f32_32x32x32_bf16 v[60:75], v[32:35], v[124:131], v3
    buffer_load_dword v145, v144, s[24:27], s60 offen
    ds_read_b64_tr_b16 a[200:201], v150 offset:512
    ds_read_b64_tr_b16 a[204:205], v156 offset:512
    v_exp_f32 v135, v135
    v_exp_f32 v136, v136
    v_exp_f32 v137, v137
    v_exp_f32 v138, v138
    v_exp_f32 v139, v139
    v_exp_f32 v76, v76
    v_mfma_f32_32x32x16_bf16 v[92:107], v[20:23], v[208:211], 0
    s_waitcnt lgkmcnt(2)
    v_exp_f32 v77, v77
    v_exp_f32 v78, v78
    v_exp_f32 v79, v79
    v_exp_f32 v80, v80
    v_exp_f32 v81, v81
    v_smfmac_f32_32x32x32_bf16 v[60:75], v[40:43], v[132:139], v3
    s_add_u32 m0, s56, 0
    s_add_u32 s93, s93, 57344
    v_exp_f32 v82, v82
    v_exp_f32 v83, v83
    v_exp_f32 v84, v84
    v_exp_f32 v85, v85
    v_exp_f32 v86, v86
    v_smfmac_f32_32x32x32_bf16 v[160:175], v[28:31], v[76:83], v3
    s_waitcnt lgkmcnt(0)
    buffer_load_dwordx4 v148, s[20:23], s93 offen lds
    buffer_load_dwordx4 v149, s[20:23], s93 offen offset:1024 lds
    v_exp_f32 v87, v87
    v_exp_f32 v88, v88
    v_exp_f32 v89, v89
    v_exp_f32 v90, v90
    v_exp_f32 v91, v91
    v_exp_f32 v92, v92
    v_mfma_f32_32x32x16_bf16 v[108:123], v[20:23], v[4:7], 0
    v_exp_f32 v93, v93
    v_exp_f32 v94, v94
    v_exp_f32 v95, v95
    v_exp_f32 v96, v96
    v_exp_f32 v97, v97
    v_smfmac_f32_32x32x32_bf16 v[160:175], v[36:39], v[84:91], v3
    v_exp_f32 v98, v98
    v_exp_f32 v99, v99
    v_exp_f32 v100, v100
    v_exp_f32 v101, v101
    v_exp_f32 v102, v102
    v_smfmac_f32_32x32x32_bf16 v[176:191], v[28:31], v[92:99], v3
    s_waitcnt vmcnt(19)
    ds_read_b64_tr_b16 a[194:195], v150 offset:2048
    ds_read_b64_tr_b16 a[198:199], v156 offset:2048
    v_exp_f32 v103, v103
    v_exp_f32 v104, v104
    v_exp_f32 v105, v105
    v_exp_f32 v106, v106
    v_exp_f32 v107, v107
    v_exp_f32 v108, v108
    v_mfma_f32_32x32x16_bf16 v[124:139], v[20:23], v[8:11], 0
    ds_read_b128 v[24:27], v200 offset:3072
    v_exp_f32 v109, v109
    v_exp_f32 v110, v110
    v_exp_f32 v111, v111
    v_exp_f32 v112, v112
    v_exp_f32 v113, v113
    v_smfmac_f32_32x32x32_bf16 v[176:191], v[36:39], v[100:107], v3
    s_add_u32 s60, s60, 8192
    v_exp_f32 v114, v114
    v_exp_f32 v115, v115
    v_exp_f32 v116, v116
    v_exp_f32 v117, v117
    v_exp_f32 v118, v118
    v_smfmac_f32_32x32x32_bf16 v[44:59], v[28:31], v[108:115], v3
    s_waitcnt lgkmcnt(0)
    buffer_load_dword v145, v144, s[24:27], s60 offen
    ds_read_b64_tr_b16 a[202:203], v150 offset:2560
    ds_read_b64_tr_b16 a[206:207], v156 offset:2560
    v_exp_f32 v119, v119
    v_exp_f32 v120, v120
    v_exp_f32 v121, v121
    v_exp_f32 v122, v122
    v_exp_f32 v123, v123
    v_exp_f32 v124, v124
    v_mfma_f32_32x32x16_bf16 v[76:91], v[24:27], v[204:207], 0
    ds_read_b128 v[32:35], v18 offset:0
    v_exp_f32 v125, v125
    v_exp_f32 v126, v126
    v_exp_f32 v127, v127
    v_exp_f32 v128, v128
    v_exp_f32 v129, v129
    v_smfmac_f32_32x32x32_bf16 v[44:59], v[36:39], v[116:123], v3
    s_add_u32 m0, s56, 2048
    s_add_u32 s93, s93, 57344
    ds_read_b128 v[40:43], v19 offset:0
    v_exp_f32 v130, v130
    v_exp_f32 v131, v131
    v_exp_f32 v132, v132
    v_exp_f32 v133, v133
    v_exp_f32 v134, v134
    v_smfmac_f32_32x32x32_bf16 v[60:75], v[28:31], v[124:131], v3
    s_waitcnt vmcnt(17) lgkmcnt(2)
    buffer_load_dwordx4 v148, s[20:23], s93 offen lds
    buffer_load_dwordx4 v149, s[20:23], s93 offen offset:1024 lds
    ds_read_b64_tr_b16 a[208:209], v150 offset:4096
    ds_read_b64_tr_b16 a[212:213], v156 offset:4096
    v_exp_f32 v135, v135
    v_exp_f32 v136, v136
    v_exp_f32 v137, v137
    v_exp_f32 v138, v138
    v_exp_f32 v139, v139
    v_exp_f32 v76, v76
    v_mfma_f32_32x32x16_bf16 v[92:107], v[24:27], v[208:211], 0
    s_waitcnt lgkmcnt(2)
    v_exp_f32 v77, v77
    v_exp_f32 v78, v78
    v_exp_f32 v79, v79
    v_exp_f32 v80, v80
    v_exp_f32 v81, v81
    v_smfmac_f32_32x32x32_bf16 v[60:75], v[36:39], v[132:139], v3
    v_exp_f32 v82, v82
    v_exp_f32 v83, v83
    v_exp_f32 v84, v84
    v_exp_f32 v85, v85
    v_exp_f32 v86, v86
    v_smfmac_f32_32x32x32_bf16 v[160:175], v[32:35], v[76:83], v3
    ds_read_b64_tr_b16 a[216:217], v150 offset:4608
    ds_read_b64_tr_b16 a[220:221], v156 offset:4608
    v_exp_f32 v87, v87
    v_exp_f32 v88, v88
    v_exp_f32 v89, v89
    v_exp_f32 v90, v90
    v_exp_f32 v91, v91
    v_exp_f32 v92, v92
    v_mfma_f32_32x32x16_bf16 v[108:123], v[24:27], v[4:7], 0
    v_exp_f32 v93, v93
    v_exp_f32 v94, v94
    v_exp_f32 v95, v95
    v_exp_f32 v96, v96
    v_exp_f32 v97, v97
    v_smfmac_f32_32x32x32_bf16 v[160:175], v[40:43], v[84:91], v3
    s_add_u32 s60, s60, 8192
    v_exp_f32 v98, v98
    v_exp_f32 v99, v99
    v_exp_f32 v100, v100
    v_exp_f32 v101, v101
    v_exp_f32 v102, v102
    v_smfmac_f32_32x32x32_bf16 v[176:191], v[32:35], v[92:99], v3
    s_waitcnt vmcnt(12)
    buffer_load_dword v145, v144, s[24:27], s60 offen
    ds_read_b64_tr_b16 a[210:211], v150 offset:6144
    ds_read_b64_tr_b16 a[214:215], v156 offset:6144
    v_exp_f32 v103, v103
    v_exp_f32 v104, v104
    v_exp_f32 v105, v105
    v_exp_f32 v106, v106
    v_exp_f32 v107, v107
    v_exp_f32 v108, v108
    v_mfma_f32_32x32x16_bf16 v[124:139], v[24:27], v[8:11], 0
    s_barrier
    ds_read_b128 v[20:23], v200 offset:8192
    v_exp_f32 v109, v109
    v_exp_f32 v110, v110
    v_exp_f32 v111, v111
    v_exp_f32 v112, v112
    v_exp_f32 v113, v113
    v_smfmac_f32_32x32x32_bf16 v[176:191], v[40:43], v[100:107], v3
    v_exp_f32 v114, v114
    v_exp_f32 v115, v115
    v_exp_f32 v116, v116
    v_exp_f32 v117, v117
    v_exp_f32 v118, v118
    v_smfmac_f32_32x32x32_bf16 v[44:59], v[32:35], v[108:115], v3
    s_waitcnt lgkmcnt(0)
    ds_read_b64_tr_b16 a[218:219], v150 offset:6656
    ds_read_b64_tr_b16 a[222:223], v156 offset:6656
    v_exp_f32 v119, v119
    v_exp_f32 v120, v120
    v_exp_f32 v121, v121
    v_exp_f32 v122, v122
    v_exp_f32 v123, v123
    v_exp_f32 v124, v124
    v_mfma_f32_32x32x16_bf16 v[76:91], v[20:23], v[204:207], 0
    ds_read_b128 v[28:31], v12 offset:8384
    v_exp_f32 v125, v125
    v_exp_f32 v126, v126
    v_exp_f32 v127, v127
    v_exp_f32 v128, v128
    v_exp_f32 v129, v129
    v_smfmac_f32_32x32x32_bf16 v[44:59], v[40:43], v[116:123], v3
    ds_read_b128 v[36:39], v13 offset:8384
    v_exp_f32 v130, v130
    v_exp_f32 v131, v131
    v_exp_f32 v132, v132
    v_exp_f32 v133, v133
    v_exp_f32 v134, v134
    v_smfmac_f32_32x32x32_bf16 v[60:75], v[32:35], v[124:131], v3
    s_waitcnt vmcnt(10)
    ds_read_b64_tr_b16 a[224:225], v150 offset:8192
    ds_read_b64_tr_b16 a[228:229], v156 offset:8192
    v_exp_f32 v135, v135
    v_exp_f32 v136, v136
    v_exp_f32 v137, v137
    v_exp_f32 v138, v138
    v_exp_f32 v139, v139
    v_exp_f32 v76, v76
    v_mfma_f32_32x32x16_bf16 v[92:107], v[20:23], v[208:211], 0
    s_waitcnt lgkmcnt(2)
    v_exp_f32 v77, v77
    v_exp_f32 v78, v78
    v_exp_f32 v79, v79
    v_exp_f32 v80, v80
    v_exp_f32 v81, v81
    v_smfmac_f32_32x32x32_bf16 v[60:75], v[40:43], v[132:139], v3
    s_add_u32 s60, s60, 8192
    v_exp_f32 v82, v82
    v_exp_f32 v83, v83
    v_exp_f32 v84, v84
    v_exp_f32 v85, v85
    v_exp_f32 v86, v86
    v_smfmac_f32_32x32x32_bf16 v[160:175], v[28:31], v[76:83], v3
    buffer_load_dword v145, v144, s[24:27], s60 offen
    ds_read_b64_tr_b16 a[232:233], v150 offset:8704
    ds_read_b64_tr_b16 a[236:237], v156 offset:8704
    v_exp_f32 v87, v87
    v_exp_f32 v88, v88
    v_exp_f32 v89, v89
    v_exp_f32 v90, v90
    v_exp_f32 v91, v91
    v_exp_f32 v92, v92
    v_mfma_f32_32x32x16_bf16 v[108:123], v[20:23], v[4:7], 0
    v_exp_f32 v93, v93
    v_exp_f32 v94, v94
    v_exp_f32 v95, v95
    v_exp_f32 v96, v96
    v_exp_f32 v97, v97
    v_smfmac_f32_32x32x32_bf16 v[160:175], v[36:39], v[84:91], v3
    v_exp_f32 v98, v98
    v_exp_f32 v99, v99
    v_exp_f32 v100, v100
    v_exp_f32 v101, v101
    v_exp_f32 v102, v102
    v_smfmac_f32_32x32x32_bf16 v[176:191], v[28:31], v[92:99], v3
    s_waitcnt vmcnt(8)
    ds_read_b64_tr_b16 a[226:227], v150 offset:10240
    ds_read_b64_tr_b16 a[230:231], v156 offset:10240
    v_exp_f32 v103, v103
    v_exp_f32 v104, v104
    v_exp_f32 v105, v105
    v_exp_f32 v106, v106
    v_exp_f32 v107, v107
    v_exp_f32 v108, v108
    v_mfma_f32_32x32x16_bf16 v[124:139], v[20:23], v[8:11], 0
    ds_read_b128 v[24:27], v200 offset:9216
    v_exp_f32 v109, v109
    v_exp_f32 v110, v110
    v_exp_f32 v111, v111
    v_exp_f32 v112, v112
    v_exp_f32 v113, v113
    v_smfmac_f32_32x32x32_bf16 v[176:191], v[36:39], v[100:107], v3
    v_exp_f32 v114, v114
    v_exp_f32 v115, v115
    v_exp_f32 v116, v116
    v_exp_f32 v117, v117
    v_exp_f32 v118, v118
    v_smfmac_f32_32x32x32_bf16 v[44:59], v[28:31], v[108:115], v3
    s_waitcnt lgkmcnt(0)
    ds_read_b64_tr_b16 a[234:235], v150 offset:10752
    ds_read_b64_tr_b16 a[238:239], v156 offset:10752
    v_exp_f32 v119, v119
    v_exp_f32 v120, v120
    v_exp_f32 v121, v121
    v_exp_f32 v122, v122
    v_exp_f32 v123, v123
    v_exp_f32 v124, v124
    v_mfma_f32_32x32x16_bf16 v[76:91], v[24:27], v[204:207], 0
    ds_read_b128 v[32:35], v14 offset:8384
    v_exp_f32 v125, v125
    v_exp_f32 v126, v126
    v_exp_f32 v127, v127
    v_exp_f32 v128, v128
    v_exp_f32 v129, v129
    v_smfmac_f32_32x32x32_bf16 v[44:59], v[36:39], v[116:123], v3
    s_add_u32 s60, s60, 8192
    ds_read_b128 v[40:43], v15 offset:8384
    v_exp_f32 v130, v130
    v_exp_f32 v131, v131
    v_exp_f32 v132, v132
    v_exp_f32 v133, v133
    v_exp_f32 v134, v134
    v_smfmac_f32_32x32x32_bf16 v[60:75], v[28:31], v[124:131], v3
    s_waitcnt vmcnt(5)
    buffer_load_dword v145, v144, s[24:27], s60 offen
    ds_read_b64_tr_b16 a[240:241], v150 offset:0
    ds_read_b64_tr_b16 a[244:245], v156 offset:0
    v_exp_f32 v135, v135
    v_exp_f32 v136, v136
    v_exp_f32 v137, v137
    v_exp_f32 v138, v138
    v_exp_f32 v139, v139
    v_exp_f32 v76, v76
    v_mfma_f32_32x32x16_bf16 v[92:107], v[24:27], v[208:211], 0
    s_waitcnt lgkmcnt(2)
    v_exp_f32 v77, v77
    v_exp_f32 v78, v78
    v_exp_f32 v79, v79
    v_exp_f32 v80, v80
    v_exp_f32 v81, v81
    v_smfmac_f32_32x32x32_bf16 v[60:75], v[36:39], v[132:139], v3
    v_exp_f32 v82, v82
    v_exp_f32 v83, v83
    v_exp_f32 v84, v84
    v_exp_f32 v85, v85
    v_exp_f32 v86, v86
    v_smfmac_f32_32x32x32_bf16 v[160:175], v[32:35], v[76:83], v3
    ds_read_b64_tr_b16 a[248:249], v150 offset:512
    ds_read_b64_tr_b16 a[252:253], v156 offset:512
    v_exp_f32 v87, v87
    v_exp_f32 v88, v88
    v_exp_f32 v89, v89
    v_exp_f32 v90, v90
    v_exp_f32 v91, v91
    v_exp_f32 v92, v92
    v_mfma_f32_32x32x16_bf16 v[108:123], v[24:27], v[4:7], 0
    v_exp_f32 v93, v93
    v_exp_f32 v94, v94
    v_exp_f32 v95, v95
    v_exp_f32 v96, v96
    v_exp_f32 v97, v97
    v_smfmac_f32_32x32x32_bf16 v[160:175], v[40:43], v[84:91], v3
    v_exp_f32 v98, v98
    v_exp_f32 v99, v99
    v_exp_f32 v100, v100
    v_exp_f32 v101, v101
    v_exp_f32 v102, v102
    v_smfmac_f32_32x32x32_bf16 v[176:191], v[32:35], v[92:99], v3
    s_waitcnt vmcnt(3)
    ds_read_b64_tr_b16 a[242:243], v150 offset:2048
    ds_read_b64_tr_b16 a[246:247], v156 offset:2048
    v_exp_f32 v103, v103
    v_exp_f32 v104, v104
    v_exp_f32 v105, v105
    v_exp_f32 v106, v106
    v_exp_f32 v107, v107
    v_exp_f32 v108, v108
    v_mfma_f32_32x32x16_bf16 v[124:139], v[24:27], v[8:11], 0
    ds_read_b128 v[20:23], v200 offset:10240
    v_exp_f32 v109, v109
    v_exp_f32 v110, v110
    v_exp_f32 v111, v111
    v_exp_f32 v112, v112
    v_exp_f32 v113, v113
    v_smfmac_f32_32x32x32_bf16 v[176:191], v[40:43], v[100:107], v3
L_pad_5:
    s_cbranch_execz L_pad_ret
    v_exp_f32 v114, v114
    v_exp_f32 v115, v115
    v_exp_f32 v116, v116
    v_exp_f32 v117, v117
    v_exp_f32 v118, v118
    v_smfmac_f32_32x32x32_bf16 v[44:59], v[32:35], v[108:115], v3
    s_waitcnt lgkmcnt(0)
    ds_read_b64_tr_b16 a[250:251], v150 offset:2560
    ds_read_b64_tr_b16 a[254:255], v156 offset:2560
    v_exp_f32 v119, v119
    v_exp_f32 v120, v120
    v_exp_f32 v121, v121
    v_exp_f32 v122, v122
    v_exp_f32 v123, v123
    v_exp_f32 v124, v124
    v_mfma_f32_32x32x16_bf16 v[76:91], v[20:23], v[204:207], 0
    ds_read_b128 v[28:31], v16 offset:8384
    v_exp_f32 v125, v125
    v_exp_f32 v126, v126
    v_exp_f32 v127, v127
    v_exp_f32 v128, v128
    v_exp_f32 v129, v129
    v_smfmac_f32_32x32x32_bf16 v[44:59], v[40:43], v[116:123], v3
    ds_read_b128 v[36:39], v17 offset:8384
    v_exp_f32 v130, v130
    v_exp_f32 v131, v131
    v_exp_f32 v132, v132
    v_exp_f32 v133, v133
    v_exp_f32 v134, v134
    v_smfmac_f32_32x32x32_bf16 v[60:75], v[32:35], v[124:131], v3
    v_exp_f32 v135, v135
    v_exp_f32 v136, v136
    v_exp_f32 v137, v137
    v_exp_f32 v138, v138
    v_exp_f32 v139, v139
    v_exp_f32 v76, v76
    v_mfma_f32_32x32x16_bf16 v[92:107], v[20:23], v[208:211], 0
    s_waitcnt lgkmcnt(0)
    v_exp_f32 v77, v77
    v_exp_f32 v78, v78
    v_exp_f32 v79, v79
    v_exp_f32 v80, v80
    v_exp_f32 v81, v81
    v_smfmac_f32_32x32x32_bf16 v[60:75], v[40:43], v[132:139], v3
    s_bfe_u32 s48, s50, 0x20001
    s_lshl2_add_u32 s48, s51, s48
    v_exp_f32 v82, v82
    v_exp_f32 v83, v83
    v_exp_f32 v84, v84
    v_exp_f32 v85, v85
    v_exp_f32 v86, v86
    v_smfmac_f32_32x32x32_bf16 v[160:175], v[28:31], v[76:83], v3
    v_exp_f32 v87, v87
    v_exp_f32 v88, v88
    v_exp_f32 v89, v89
    v_exp_f32 v90, v90
    v_exp_f32 v91, v91
    v_exp_f32 v92, v92
    v_mfma_f32_32x32x16_bf16 v[108:123], v[20:23], v[4:7], 0
    v_exp_f32 v93, v93
    v_exp_f32 v94, v94
    v_exp_f32 v95, v95
    v_exp_f32 v96, v96
    v_exp_f32 v97, v97
    v_smfmac_f32_32x32x32_bf16 v[160:175], v[36:39], v[84:91], v3
    s_lshl_b32 s48, s48, 7
    s_lshr_b32 s62, s50, 3
    v_exp_f32 v98, v98
    v_exp_f32 v99, v99
    v_exp_f32 v100, v100
    v_exp_f32 v101, v101
    v_exp_f32 v102, v102
    v_smfmac_f32_32x32x32_bf16 v[176:191], v[28:31], v[92:99], v3
    v_exp_f32 v103, v103
    v_exp_f32 v104, v104
    v_exp_f32 v105, v105
    v_exp_f32 v106, v106
    v_exp_f32 v107, v107
    v_exp_f32 v108, v108
    v_mfma_f32_32x32x16_bf16 v[124:139], v[20:23], v[8:11], 0
    ds_read_b128 v[24:27], v200 offset:11264
    v_exp_f32 v109, v109
    v_exp_f32 v110, v110
    v_exp_f32 v111, v111
    v_exp_f32 v112, v112
    v_exp_f32 v113, v113
    v_smfmac_f32_32x32x32_bf16 v[176:191], v[36:39], v[100:107], v3
    s_lshl4_add_u32 s48, s62, s48
    s_and_b32 s62, s50, 1
    v_exp_f32 v114, v114
    v_exp_f32 v115, v115
    v_exp_f32 v116, v116
    v_exp_f32 v117, v117
    v_exp_f32 v118, v118
    v_smfmac_f32_32x32x32_bf16 v[44:59], v[28:31], v[108:115], v3
    s_waitcnt lgkmcnt(0)
    v_exp_f32 v119, v119
    v_exp_f32 v120, v120
    v_exp_f32 v121, v121
    v_exp_f32 v122, v122
    v_exp_f32 v123, v123
    v_exp_f32 v124, v124
    v_mfma_f32_32x32x16_bf16 v[76:91], v[24:27], v[204:207], 0
    ds_read_b128 v[32:35], v18 offset:8384
    v_exp_f32 v125, v125
    v_exp_f32 v126, v126
    v_exp_f32 v127, v127
    v_exp_f32 v128, v128
    v_exp_f32 v129, v129
    v_smfmac_f32_32x32x32_bf16 v[44:59], v[36:39], v[116:123], v3
    s_lshl3_add_u32 s48, s62, s48
    s_add_u32 s48, s48, 15220736
    ds_read_b128 v[40:43], v19 offset:8384
    v_exp_f32 v130, v130
    v_exp_f32 v131, v131
    v_exp_f32 v132, v132
    v_exp_f32 v133, v133
    v_exp_f32 v134, v134
    v_smfmac_f32_32x32x32_bf16 v[60:75], v[28:31], v[124:131], v3
    v_exp_f32 v135, v135
    v_exp_f32 v136, v136
    v_exp_f32 v137, v137
    v_exp_f32 v138, v138
    v_exp_f32 v139, v139
    v_exp_f32 v76, v76
    v_mfma_f32_32x32x16_bf16 v[92:107], v[24:27], v[208:211], 0
    s_waitcnt lgkmcnt(0)
    v_exp_f32 v77, v77
    v_exp_f32 v78, v78
    v_exp_f32 v79, v79
    v_exp_f32 v80, v80
    v_exp_f32 v81, v81
    v_smfmac_f32_32x32x32_bf16 v[60:75], v[36:39], v[132:139], v3
    s_mov_b32 s60, 0x207
    v_exp_f32 v82, v82
    v_exp_f32 v83, v83
    v_exp_f32 v84, v84
    v_exp_f32 v85, v85
    v_exp_f32 v86, v86
    v_smfmac_f32_32x32x32_bf16 v[160:175], v[32:35], v[76:83], v3
    v_exp_f32 v87, v87
    v_exp_f32 v88, v88
    v_exp_f32 v89, v89
    v_exp_f32 v90, v90
    v_exp_f32 v91, v91
    v_exp_f32 v92, v92
    v_mfma_f32_32x32x16_bf16 v[108:123], v[24:27], v[4:7], 0
    v_exp_f32 v93, v93
    v_exp_f32 v94, v94
    v_exp_f32 v95, v95
    v_exp_f32 v96, v96
    v_exp_f32 v97, v97
    v_smfmac_f32_32x32x32_bf16 v[160:175], v[40:43], v[84:91], v3
    v_exp_f32 v98, v98
    v_exp_f32 v99, v99
    v_exp_f32 v100, v100
    v_exp_f32 v101, v101
    v_exp_f32 v102, v102
    v_smfmac_f32_32x32x32_bf16 v[176:191], v[32:35], v[92:99], v3
    v_exp_f32 v103, v103
    v_exp_f32 v104, v104
    v_exp_f32 v105, v105
    v_exp_f32 v106, v106
    v_exp_f32 v107, v107
    v_exp_f32 v108, v108
    v_mfma_f32_32x32x16_bf16 v[124:139], v[24:27], v[8:11], 0
    ds_write_b128 v201, v[160:163] offset:0
    v_exp_f32 v109, v109
    v_exp_f32 v110, v110
    v_exp_f32 v111, v111
    v_exp_f32 v112, v112
    v_exp_f32 v113, v113
    v_smfmac_f32_32x32x32_bf16 v[176:191], v[40:43], v[100:107], v3
    ds_write_b128 v201, v[164:167] offset:1024
    v_exp_f32 v114, v114
    v_exp_f32 v115, v115
    v_exp_f32 v116, v116
    v_exp_f32 v117, v117
    v_exp_f32 v118, v118
    v_smfmac_f32_32x32x32_bf16 v[44:59], v[32:35], v[108:115], v3
    ds_write_b32 v201, v168 offset:2048
    v_exp_f32 v119, v119
    v_exp_f32 v120, v120
    v_exp_f32 v121, v121
    v_exp_f32 v122, v122
    v_exp_f32 v123, v123
    v_exp_f32 v124, v124
    v_exp_f32 v125, v125
    v_exp_f32 v126, v126
    v_exp_f32 v127, v127
    v_exp_f32 v128, v128
    v_exp_f32 v129, v129
    v_smfmac_f32_32x32x32_bf16 v[44:59], v[40:43], v[116:123], v3
    ds_write_b128 v201, v[176:179] offset:3072
    ds_write_b32 v201, v184 offset:5120
    v_exp_f32 v130, v130
    v_exp_f32 v131, v131
    v_exp_f32 v132, v132
    v_exp_f32 v133, v133
    v_exp_f32 v134, v134
    v_smfmac_f32_32x32x32_bf16 v[60:75], v[32:35], v[124:131], v3
    ds_write_b128 v201, v[180:183] offset:4096
    v_exp_f32 v135, v135
    v_exp_f32 v136, v136
    v_exp_f32 v137, v137
    v_exp_f32 v138, v138
    v_exp_f32 v139, v139
    s_nop 1
    v_smfmac_f32_32x32x32_bf16 v[60:75], v[40:43], v[132:139], v3
    s_waitcnt lgkmcnt(0)
    s_barrier
    ds_read_b32 v168, v202 offset:2048
    ds_read_b128 v[160:163], v202 offset:0
    ds_read_b128 v[164:167], v202 offset:1024
    ds_read_b32 v184, v202 offset:5120
    ds_read_b128 v[176:179], v202 offset:3072
    ds_read_b128 v[180:183], v202 offset:4096
    s_waitcnt lgkmcnt(5)
    v_add_f32 v52, v52, v168
    s_waitcnt lgkmcnt(4)
    v_pk_add_f32 v[44:45], v[44:45], v[160:161]
    v_pk_add_f32 v[46:47], v[46:47], v[162:163]
    s_waitcnt lgkmcnt(3)
    v_pk_add_f32 v[48:49], v[48:49], v[164:165]
    v_pk_add_f32 v[50:51], v[50:51], v[166:167]
    s_waitcnt lgkmcnt(2)
    v_add_f32 v68, v68, v184
    s_waitcnt lgkmcnt(1)
    v_pk_add_f32 v[60:61], v[60:61], v[176:177]
    v_pk_add_f32 v[62:63], v[62:63], v[178:179]
    s_waitcnt lgkmcnt(0)
    v_pk_add_f32 v[64:65], v[64:65], v[180:181]
    v_pk_add_f32 v[66:67], v[66:67], v[182:183]
L_attn_check:
    v_rcp_f32 v20, v52
    s_add_u32 s46, s8, 0
    v_pk_mul_f32 v[76:77], v[44:45], v[20:21] op_sel_hi:[1,0]
    v_pk_mul_f32 v[78:79], v[46:47], v[20:21] op_sel_hi:[1,0]
    v_pk_mul_f32 v[80:81], v[48:49], v[20:21] op_sel_hi:[1,0]
    v_pk_mul_f32 v[82:83], v[50:51], v[20:21] op_sel_hi:[1,0]
    v_cvt_pk_bf16_f32 v24, v76, v77
    v_cvt_pk_bf16_f32 v25, v78, v79
    v_cvt_pk_bf16_f32 v26, v80, v81
    v_cvt_pk_bf16_f32 v27, v82, v83
    buffer_store_dwordx4 v[24:27], v2, s[12:15], s46 offen sc1
    v_rcp_f32 v22, v68
    s_add_u32 s46, s8, 32768
    v_pk_mul_f32 v[84:85], v[60:61], v[22:23] op_sel_hi:[1,0]
    v_pk_mul_f32 v[86:87], v[62:63], v[22:23] op_sel_hi:[1,0]
    v_pk_mul_f32 v[88:89], v[64:65], v[22:23] op_sel_hi:[1,0]
    v_pk_mul_f32 v[90:91], v[66:67], v[22:23] op_sel_hi:[1,0]
    v_cvt_pk_bf16_f32 v28, v84, v85
    v_cvt_pk_bf16_f32 v29, v86, v87
    v_cvt_pk_bf16_f32 v30, v88, v89
    v_cvt_pk_bf16_f32 v31, v90, v91
    buffer_store_dwordx4 v[28:31], v2, s[12:15], s46 offen sc1
    v_pk_add_f32 v[76:77], v[76:77], v[78:79]
    v_pk_add_f32 v[80:81], v[80:81], v[82:83]
    v_pk_add_f32 v[84:85], v[84:85], v[86:87]
    v_pk_add_f32 v[88:89], v[88:89], v[90:91]
    v_subrev_u32 v32, 0x2b800000, v52
    v_pk_add_f32 v[76:77], v[76:77], v[80:81]
    v_pk_add_f32 v[84:85], v[84:85], v[88:89]
    v_subrev_u32 v33, 0x2b800000, v68
    v_pk_add_f32 v[76:77], v[76:77], v[84:85]
    v_max_u32 v32, v32, v33
    v_add_f32 v76, v76, v77
    v_cmp_le_u32 vcc, 671088640, v32
    v_cmp_class_f32 s[62:63], v76, s60
    s_nop 0
    s_or_b64 vcc, vcc, s[62:63]
    s_cselect_b32 s59, 1, 0
    s_cmp_gt_u32 s59, s55
    s_cbranch_scc1 L_attn_slow
    s_cmp_eq_u32 s55, 0
    s_cbranch_scc1 L_attn_done
    s_waitcnt vmcnt(0)
L_attn_done:
    v_mov_b32 v22, s44
    v_mov_b32 v23, s45
    s_mov_b64 exec, 1
    buffer_atomic_swap_x2 v[22:23], v254, s[12:15], s48 offen sc1
    s_mov_b64 exec, -1
    s_lshr_b32 s50, s40, 1
    s_and_b32 s51, s40, 1
    s_lshl2_add_u32 s56, s97, s40
    s_lshl_b32 s56, s56, 7
    s_add_u32 s56, s56, 15220736
    s_mov_b64 exec, 255
    v_mov_b32 v12, 0
    v_mov_b32 v13, 0
    buffer_atomic_or_x2 v[12:13], v255, s[12:15], s56 offen sc0 sc1
    s_mov_b64 exec, -1
    s_lshl_b32 s46, s50, 11
    v_add_u32 v3, s46, v2
    s_lshl_b32 s46, s51, 9
    s_add_u32 s46, s46, 90112
    v_lshrrev_b32 v7, 5, v1
    v_lshlrev_b32 v4, 8, v7
    v_bfe_u32 v8, v1, 2, 2
    v_lshl_add_u32 v4, v8, 6, v4
    v_bfe_u32 v8, v1, 4, 1
    v_lshlrev_b32 v9, 5, v8
    v_and_b32 v8, 1, v1
    v_lshl_add_u32 v9, v8, 4, v9
    v_bfe_u32 v8, v1, 1, 1
    v_lshl_add_u32 v9, v8, 3, v9
    v_add3_u32 v4, v4, v9, s46
    s_lshl_b32 s53, s40, 12
    s_lshl_b32 s52, s97, 16
    s_and_b32 s46, s41, 0
    s_lshl3_add_u32 s46, s46, s40
    s_lshl_b32 s46, s46, 11
    s_add_u32 s52, s52, s46
    s_add_u32 s52, s52, 6291456
    v_add_u32 v5, 30720, v2
    v_and_b32 v10, 31, v1
    s_barrier
    s_add_u32 m0, s92, 16384
    s_nop 0
    buffer_load_dwordx4 v250, s[24:27], s100 offen lds
    buffer_load_dwordx4 v251, s[24:27], s100 offen offset:1024 lds
    s_add_u32 m0, s92, 24576
    s_add_u32 s100, s100, 65536
    buffer_load_dwordx4 v250, s[24:27], s100 offen lds
    buffer_load_dwordx4 v251, s[24:27], s100 offen offset:1024 lds
    s_add_u32 m0, s92, 32768
    s_add_u32 s100, s100, 65536
    buffer_load_dwordx4 v250, s[24:27], s100 offen lds
    buffer_load_dwordx4 v251, s[24:27], s100 offen offset:1024 lds
    s_lshl_b32 s46, s50, 12
    s_add_u32 s46, s46, 155648
    s_lshl_b32 s47, s51, 6
    v_bfe_u32 v8, v1, 1, 3
    v_xor_b32 v8, v8, v7
    v_lshlrev_b32 v8, 4, v8
    v_xor_b32 v8, s47, v8
    v_lshl_add_u32 v8, v10, 7, v8
    v_add_u32 v14, s46, v8
    v_xor_b32 v15, 32, v14
    ds_read_b128 v[64:67], v14
    ds_read_b128 v[68:71], v15
    s_mov_b64 exec, 255
    s_waitcnt vmcnt(6)
    v_cmp_ne_u64 vcc, s[44:45], v[12:13]
    s_mov_b32 s49, 0
    s_cbranch_vccz L_seen_14
L_poll_12:
    v_mov_b32 v12, 0
    v_mov_b32 v13, 0
    buffer_atomic_or_x2 v[12:13], v255, s[12:15], s56 offen sc0 sc1
    s_add_u32 s49, s49, 1
    s_waitcnt vmcnt(0)
    v_cmp_ne_u64 vcc, s[44:45], v[12:13]
    s_nop 0
    s_cbranch_vccz L_seen_14
    s_cmp_lt_u32 s49, 131072
    s_cbranch_scc1 L_poll_12
L_seen_14:
    s_mov_b64 exec, -1
    s_add_u32 m0, s53, 0
    s_nop 0
    buffer_load_dwordx4 v2, s[12:15], s52 offen offset:0 sc1 lds
    buffer_load_dwordx4 v2, s[12:15], s52 offen offset:1024 sc1 lds
    buffer_load_dwordx4 v5, s[12:15], s52 offen offset:2048 sc1 lds
    buffer_load_dwordx4 v5, s[12:15], s52 offen offset:3072 sc1 lds
    s_add_u32 m0, s53, 16384
    s_xor_b32 s52, s52, 8192
    buffer_load_dwordx4 v2, s[12:15], s52 offen offset:0 sc1 lds
    buffer_load_dwordx4 v2, s[12:15], s52 offen offset:1024 sc1 lds
    buffer_load_dwordx4 v5, s[12:15], s52 offen offset:2048 sc1 lds
    buffer_load_dwordx4 v5, s[12:15], s52 offen offset:3072 sc1 lds
    ds_read_b64_tr_b16 v[96:97], v4 offset:0
    ds_read_b64_tr_b16 v[98:99], v4 offset:1024
    ds_read_b64_tr_b16 v[100:101], v4 offset:2048
    ds_read_b64_tr_b16 v[102:103], v4 offset:3072
    ds_read_b64_tr_b16 v[104:105], v4 offset:4096
    ds_read_b64_tr_b16 v[106:107], v4 offset:5120
    ds_read_b64_tr_b16 v[108:109], v4 offset:6144
    ds_read_b64_tr_b16 v[110:111], v4 offset:7168
    ds_read_b64_tr_b16 v[112:113], v4 offset:8192
    ds_read_b64_tr_b16 v[114:115], v4 offset:9216
    ds_read_b64_tr_b16 v[116:117], v4 offset:10240
    ds_read_b64_tr_b16 v[118:119], v4 offset:11264
    ds_read_b64_tr_b16 v[120:121], v4 offset:12288
    ds_read_b64_tr_b16 v[122:123], v4 offset:13312
    ds_read_b64_tr_b16 v[124:125], v4 offset:14336
    ds_read_b64_tr_b16 v[126:127], v4 offset:15360
    ds_read_b64_tr_b16 v[128:129], v4 offset:16384
    ds_read_b64_tr_b16 v[130:131], v4 offset:17408
    ds_read_b64_tr_b16 v[132:133], v4 offset:18432
    ds_read_b64_tr_b16 v[134:135], v4 offset:19456
    ds_read_b64_tr_b16 v[136:137], v4 offset:20480
    ds_read_b64_tr_b16 v[138:139], v4 offset:21504
    ds_read_b64_tr_b16 v[140:141], v4 offset:22528
    ds_read_b64_tr_b16 v[142:143], v4 offset:23552
    ds_read_b64_tr_b16 v[144:145], v4 offset:24576
    ds_read_b64_tr_b16 v[146:147], v4 offset:25600
    ds_read_b64_tr_b16 v[148:149], v4 offset:26624
    ds_read_b64_tr_b16 v[150:151], v4 offset:27648
    ds_read_b64_tr_b16 v[152:153], v4 offset:28672
    ds_read_b64_tr_b16 v[154:155], v4 offset:29696
    ds_read_b64_tr_b16 v[156:157], v4 offset:30720
    ds_read_b64_tr_b16 v[158:159], v4 offset:31744
    s_waitcnt lgkmcnt(14)
    v_lshlrev_b32 v80, 16, v64
    v_and_b32 v81, 0xffff0000, v64
    v_lshlrev_b32 v82, 16, v65
    v_and_b32 v83, 0xffff0000, v65
    v_lshlrev_b32 v84, 16, v66
    v_and_b32 v85, 0xffff0000, v66
    v_lshlrev_b32 v86, 16, v67
    v_and_b32 v87, 0xffff0000, v67
    v_lshlrev_b32 v88, 16, v68
    v_and_b32 v89, 0xffff0000, v68
    v_lshlrev_b32 v90, 16, v69
    v_and_b32 v91, 0xffff0000, v69
    v_lshlrev_b32 v92, 16, v70
    v_and_b32 v93, 0xffff0000, v70
    v_lshlrev_b32 v94, 16, v71
    v_and_b32 v95, 0xffff0000, v71
    s_lshl1_add_u32 s54, s97, s50
    s_lshl1_add_u32 s55, s43, s51
    s_lshl_b32 s46, s54, 12
    s_add_u32 s46, s46, 14680064
    s_lshl_b32 s47, s55, 8
    s_add_u32 s47, s47, s46
    v_lshlrev_b32 v11, 3, v10
    s_add_u32 m0, s53, 32768
    s_xor_b32 s52, s52, 24576
    buffer_load_dwordx4 v2, s[12:15], s52 offen offset:0 sc1 lds
    buffer_load_dwordx4 v2, s[12:15], s52 offen offset:1024 sc1 lds
    buffer_load_dwordx4 v5, s[12:15], s52 offen offset:2048 sc1 lds
    buffer_load_dwordx4 v5, s[12:15], s52 offen offset:3072 sc1 lds
    s_add_u32 m0, s53, 49152
    s_xor_b32 s52, s52, 8192
    buffer_load_dwordx4 v2, s[12:15], s52 offen offset:0 sc1 lds
    buffer_load_dwordx4 v2, s[12:15], s52 offen offset:1024 sc1 lds
    buffer_load_dwordx4 v5, s[12:15], s52 offen offset:2048 sc1 lds
    buffer_load_dwordx4 v5, s[12:15], s52 offen offset:3072 sc1 lds
    s_waitcnt vmcnt(12)
    s_barrier
    ds_read_b128 v[16:19], v3 offset:0
    ds_read_b128 v[20:23], v3 offset:1024
    ds_read_b128 v[24:27], v3 offset:4096
    s_waitcnt lgkmcnt(2)
    v_mfma_f32_32x32x16_bf16 v[48:63], v[96:99], v[16:19], v[80:95]
    ds_read_b128 v[28:31], v3 offset:5120
    s_waitcnt lgkmcnt(2)
    v_mfma_f32_32x32x16_bf16 v[48:63], v[100:103], v[20:23], v[48:63]
    ds_read_b128 v[32:35], v3 offset:8192
    ds_read_b64_tr_b16 v[96:97], v4 offset:32768
    ds_read_b64_tr_b16 v[98:99], v4 offset:33792
    s_waitcnt lgkmcnt(4)
    v_mfma_f32_32x32x16_bf16 v[48:63], v[104:107], v[24:27], v[48:63]
    ds_read_b128 v[36:39], v3 offset:9216
    ds_read_b64_tr_b16 v[100:101], v4 offset:34816
    ds_read_b64_tr_b16 v[102:103], v4 offset:35840
    s_waitcnt lgkmcnt(6)
    v_mfma_f32_32x32x16_bf16 v[48:63], v[108:111], v[28:31], v[48:63]
    ds_read_b128 v[40:43], v3 offset:12288
    ds_read_b64_tr_b16 v[104:105], v4 offset:36864
    ds_read_b64_tr_b16 v[106:107], v4 offset:37888
    s_waitcnt lgkmcnt(8)
    v_mfma_f32_32x32x16_bf16 v[48:63], v[112:115], v[32:35], v[48:63]
    ds_read_b128 v[44:47], v3 offset:13312
    ds_read_b64_tr_b16 v[108:109], v4 offset:38912
    ds_read_b64_tr_b16 v[110:111], v4 offset:39936
    s_waitcnt lgkmcnt(8)
    v_mfma_f32_32x32x16_bf16 v[48:63], v[116:119], v[36:39], v[48:63]
    s_waitcnt vmcnt(8)
    s_barrier
    ds_read_b128 v[16:19], v3 offset:16384
    ds_read_b64_tr_b16 v[112:113], v4 offset:40960
    ds_read_b64_tr_b16 v[114:115], v4 offset:41984
    s_waitcnt lgkmcnt(8)
    v_mfma_f32_32x32x16_bf16 v[48:63], v[120:123], v[40:43], v[48:63]
    ds_read_b128 v[20:23], v3 offset:17408
    ds_read_b64_tr_b16 v[116:117], v4 offset:43008
    ds_read_b64_tr_b16 v[118:119], v4 offset:44032
    s_waitcnt lgkmcnt(8)
    v_mfma_f32_32x32x16_bf16 v[48:63], v[124:127], v[44:47], v[48:63]
    ds_read_b128 v[24:27], v3 offset:20480
    ds_read_b64_tr_b16 v[120:121], v4 offset:45056
    ds_read_b64_tr_b16 v[122:123], v4 offset:46080
    s_waitcnt lgkmcnt(8)
    v_mfma_f32_32x32x16_bf16 v[48:63], v[128:131], v[16:19], v[48:63]
    ds_read_b128 v[28:31], v3 offset:21504
    ds_read_b64_tr_b16 v[124:125], v4 offset:47104
    ds_read_b64_tr_b16 v[126:127], v4 offset:48128
    s_waitcnt lgkmcnt(8)
    v_mfma_f32_32x32x16_bf16 v[48:63], v[132:135], v[20:23], v[48:63]
    ds_read_b128 v[32:35], v3 offset:24576
    ds_read_b64_tr_b16 v[128:129], v4 offset:49152
    ds_read_b64_tr_b16 v[130:131], v4 offset:50176
    s_waitcnt lgkmcnt(8)
    v_mfma_f32_32x32x16_bf16 v[48:63], v[136:139], v[24:27], v[48:63]
    ds_read_b128 v[36:39], v3 offset:25600
    ds_read_b64_tr_b16 v[132:133], v4 offset:51200
    ds_read_b64_tr_b16 v[134:135], v4 offset:52224
    s_waitcnt lgkmcnt(8)
    v_mfma_f32_32x32x16_bf16 v[48:63], v[140:143], v[28:31], v[48:63]
    ds_read_b128 v[40:43], v3 offset:28672
    ds_read_b64_tr_b16 v[136:137], v4 offset:53248
    ds_read_b64_tr_b16 v[138:139], v4 offset:54272
    s_waitcnt lgkmcnt(8)
    v_mfma_f32_32x32x16_bf16 v[48:63], v[144:147], v[32:35], v[48:63]
    ds_read_b128 v[44:47], v3 offset:29696
    ds_read_b64_tr_b16 v[140:141], v4 offset:55296
    ds_read_b64_tr_b16 v[142:143], v4 offset:56320
    s_waitcnt lgkmcnt(8)
    v_mfma_f32_32x32x16_bf16 v[48:63], v[148:151], v[36:39], v[48:63]
    s_waitcnt vmcnt(4)
    s_barrier
    ds_read_b128 v[16:19], v3 offset:32768
    ds_read_b64_tr_b16 v[144:145], v4 offset:57344
    ds_read_b64_tr_b16 v[146:147], v4 offset:58368
    s_waitcnt lgkmcnt(8)
    v_mfma_f32_32x32x16_bf16 v[48:63], v[152:155], v[40:43], v[48:63]
    ds_read_b128 v[20:23], v3 offset:33792
    ds_read_b64_tr_b16 v[148:149], v4 offset:59392
    ds_read_b64_tr_b16 v[150:151], v4 offset:60416
    s_waitcnt lgkmcnt(8)
    v_mfma_f32_32x32x16_bf16 v[48:63], v[156:159], v[44:47], v[48:63]
    ds_read_b128 v[24:27], v3 offset:36864
    ds_read_b64_tr_b16 v[152:153], v4 offset:61440
    ds_read_b64_tr_b16 v[154:155], v4 offset:62464
    s_waitcnt lgkmcnt(8)
    v_mfma_f32_32x32x16_bf16 v[48:63], v[96:99], v[16:19], v[48:63]
    ds_read_b128 v[28:31], v3 offset:37888
    ds_read_b64_tr_b16 v[156:157], v4 offset:63488
    ds_read_b64_tr_b16 v[158:159], v4 offset:64512
    s_waitcnt lgkmcnt(8)
    v_mfma_f32_32x32x16_bf16 v[48:63], v[100:103], v[20:23], v[48:63]
    ds_read_b128 v[32:35], v3 offset:40960
    s_waitcnt lgkmcnt(6)
    v_mfma_f32_32x32x16_bf16 v[48:63], v[104:107], v[24:27], v[48:63]
    ds_read_b128 v[36:39], v3 offset:41984
    s_waitcnt lgkmcnt(4)
    v_mfma_f32_32x32x16_bf16 v[48:63], v[108:111], v[28:31], v[48:63]
    ds_read_b128 v[40:43], v3 offset:45056
    s_waitcnt lgkmcnt(2)
    v_mfma_f32_32x32x16_bf16 v[48:63], v[112:115], v[32:35], v[48:63]
    ds_read_b128 v[44:47], v3 offset:46080
    s_waitcnt lgkmcnt(2)
    v_mfma_f32_32x32x16_bf16 v[48:63], v[116:119], v[36:39], v[48:63]
    s_waitcnt vmcnt(0)
    s_barrier
    ds_read_b128 v[16:19], v3 offset:49152
    s_waitcnt lgkmcnt(2)
    v_mfma_f32_32x32x16_bf16 v[48:63], v[120:123], v[40:43], v[48:63]
    ds_read_b128 v[20:23], v3 offset:50176
    s_waitcnt lgkmcnt(2)
    v_mfma_f32_32x32x16_bf16 v[48:63], v[124:127], v[44:47], v[48:63]
    ds_read_b128 v[24:27], v3 offset:53248
    s_waitcnt lgkmcnt(2)
    v_mfma_f32_32x32x16_bf16 v[48:63], v[128:131], v[16:19], v[48:63]
    ds_read_b128 v[28:31], v3 offset:54272
    s_waitcnt lgkmcnt(2)
    v_mfma_f32_32x32x16_bf16 v[48:63], v[132:135], v[20:23], v[48:63]
    ds_read_b128 v[32:35], v3 offset:57344
    s_waitcnt lgkmcnt(2)
    v_mfma_f32_32x32x16_bf16 v[48:63], v[136:139], v[24:27], v[48:63]
    ds_read_b128 v[36:39], v3 offset:58368
    s_waitcnt lgkmcnt(2)
    v_mfma_f32_32x32x16_bf16 v[48:63], v[140:143], v[28:31], v[48:63]
    ds_read_b128 v[40:43], v3 offset:61440
    s_waitcnt lgkmcnt(2)
    v_mfma_f32_32x32x16_bf16 v[48:63], v[144:147], v[32:35], v[48:63]
    ds_read_b128 v[44:47], v3 offset:62464
    s_waitcnt lgkmcnt(2)
    v_mfma_f32_32x32x16_bf16 v[48:63], v[148:151], v[36:39], v[48:63]
    s_waitcnt lgkmcnt(1)
    v_mfma_f32_32x32x16_bf16 v[48:63], v[152:155], v[40:43], v[48:63]
    s_waitcnt lgkmcnt(0)
    v_mfma_f32_32x32x16_bf16 v[48:63], v[156:159], v[44:47], v[48:63]
    s_nop 11
    v_cmp_u_f32 vcc, v48, v48
L_wo_done:
    v_pk_add_f32 v[96:97], v[48:49], v[50:51]
    v_pk_add_f32 v[98:99], v[52:53], v[54:55]
    v_pk_add_f32 v[100:101], v[56:57], v[58:59]
    v_pk_add_f32 v[102:103], v[60:61], v[62:63]
    v_pk_add_f32 v[96:97], v[96:97], v[98:99]
    v_pk_add_f32 v[100:101], v[100:101], v[102:103]
    v_pk_add_f32 v[96:97], v[96:97], v[100:101]
    v_add_f32 v96, v96, v97
    v_mov_b32 v97, v96
    s_cbranch_vccnz L_wo_redo
    s_nop 0
    v_permlane32_swap_b32 v97, v96
    v_add_f32 v96, v96, v97
    v_mul_f32 v96, 0x3d000000, v96
    v_pk_add_f32 v[98:99], v[48:49], v[96:97] op_sel_hi:[1,0] neg_lo:[0,1] neg_hi:[0,1]
    v_pk_add_f32 v[100:101], v[50:51], v[96:97] op_sel_hi:[1,0] neg_lo:[0,1] neg_hi:[0,1]
    v_pk_add_f32 v[102:103], v[52:53], v[96:97] op_sel_hi:[1,0] neg_lo:[0,1] neg_hi:[0,1]
    v_pk_add_f32 v[104:105], v[54:55], v[96:97] op_sel_hi:[1,0] neg_lo:[0,1] neg_hi:[0,1]
    v_pk_add_f32 v[106:107], v[56:57], v[96:97] op_sel_hi:[1,0] neg_lo:[0,1] neg_hi:[0,1]
    v_pk_add_f32 v[108:109], v[58:59], v[96:97] op_sel_hi:[1,0] neg_lo:[0,1] neg_hi:[0,1]
    v_pk_add_f32 v[110:111], v[60:61], v[96:97] op_sel_hi:[1,0] neg_lo:[0,1] neg_hi:[0,1]
    v_pk_add_f32 v[112:113], v[62:63], v[96:97] op_sel_hi:[1,0] neg_lo:[0,1] neg_hi:[0,1]
    v_pk_mul_f32 v[114:115], v[98:99], v[98:99]
    v_pk_mul_f32 v[116:117], v[100:101], v[100:101]
    v_pk_fma_f32 v[114:115], v[102:103], v[102:103], v[114:115]
    v_pk_fma_f32 v[116:117], v[104:105], v[104:105], v[116:117]
    v_pk_fma_f32 v[114:115], v[106:107], v[106:107], v[114:115]
    v_pk_fma_f32 v[116:117], v[108:109], v[108:109], v[116:117]
    v_pk_fma_f32 v[114:115], v[110:111], v[110:111], v[114:115]
    v_pk_fma_f32 v[116:117], v[112:113], v[112:113], v[116:117]
    v_pk_add_f32 v[114:115], v[114:115], v[116:117]
    v_add_f32 v97, v114, v115
    v_mov_b32 v116, v97
    s_nop 1
    v_permlane32_swap_b32 v116, v97
    v_add_f32 v97, v97, v116
    buffer_store_dwordx2 v[96:97], v11, s[12:15], s47 offen sc1
    v_lshlrev_b32 v248, 16, v248
    v_pk_add_f32 v[220:221], v[48:49], v[248:249] op_sel_hi:[1,0]
    v_pk_add_f32 v[222:223], v[50:51], v[248:249] op_sel_hi:[1,0]
    v_pk_add_f32 v[224:225], v[52:53], v[248:249] op_sel_hi:[1,0]
    v_pk_add_f32 v[226:227], v[54:55], v[248:249] op_sel_hi:[1,0]
    v_pk_add_f32 v[228:229], v[56:57], v[248:249] op_sel_hi:[1,0]
    v_pk_add_f32 v[230:231], v[58:59], v[248:249] op_sel_hi:[1,0]
    v_pk_add_f32 v[232:233], v[60:61], v[248:249] op_sel_hi:[1,0]
    v_pk_add_f32 v[234:235], v[62:63], v[248:249] op_sel_hi:[1,0]
    s_barrier
    s_add_u32 m0, s92, 40960
    s_add_u32 s100, s100, 65536
    buffer_load_dwordx4 v250, s[24:27], s100 offen lds
    buffer_load_dwordx4 v251, s[24:27], s100 offen offset:1024 lds
    s_add_u32 m0, s92, 49152
    s_add_u32 s100, s100, 65536
    s_cmp_eq_u32 s100, s3
    s_cselect_b32 s100, s101, s100
    buffer_load_dwordx4 v250, s[24:27], s100 offen lds
    buffer_load_dwordx4 v251, s[24:27], s100 offen offset:1024 lds
    s_add_u32 m0, s92, 57344
    s_add_u32 s100, s100, 65536
    buffer_load_dwordx4 v250, s[24:27], s100 offen lds
    buffer_load_dwordx4 v251, s[24:27], s100 offen offset:1024 lds
    s_add_u32 m0, s92, 65536
    s_add_u32 s100, s100, 65536
    buffer_load_dwordx4 v250, s[24:27], s100 offen lds
    buffer_load_dwordx4 v251, s[24:27], s100 offen offset:1024 lds
    s_add_u32 m0, s92, 73728
    s_add_u32 s100, s100, 65536
    buffer_load_dwordx4 v250, s[24:27], s100 offen lds
    buffer_load_dwordx4 v251, s[24:27], s100 offen offset:1024 lds
    s_lshl_b32 s57, s40, 11
    v_lshlrev_b32 v12, 6, v10
    v_lshl_add_u32 v12, v7, 4, v12
    v_add_u32 v12, s57, v12
    v_lshrrev_b32 v13, 2, v1
    v_lshl_add_u32 v13, v13, 6, s57
    v_and_b32 v8, 3, v1
    v_lshl_add_u32 v13, v8, 3, v13
    s_lshr_b32 s48, s97, 3
    s_lshl2_add_u32 s48, s43, s48
    s_lshl_b32 s48, s48, 7
    s_and_b32 s47, s97, 7
    s_lshl3_add_u32 s48, s47, s48
    s_add_u32 s48, s48, 15237120
    s_mov_b32 s49, 0
L_st_poll:
    buffer_load_dwordx2 v[16:17], v255, s[12:15], s46 offen offset:0 sc1
    buffer_load_dwordx2 v[18:19], v255, s[12:15], s46 offen offset:512 sc1
    buffer_load_dwordx2 v[20:21], v255, s[12:15], s46 offen offset:1024 sc1
    buffer_load_dwordx2 v[22:23], v255, s[12:15], s46 offen offset:1536 sc1
    buffer_load_dwordx2 v[24:25], v255, s[12:15], s46 offen offset:2048 sc1
    buffer_load_dwordx2 v[26:27], v255, s[12:15], s46 offen offset:2560 sc1
    buffer_load_dwordx2 v[28:29], v255, s[12:15], s46 offen offset:3072 sc1
    buffer_load_dwordx2 v[30:31], v255, s[12:15], s46 offen offset:3584 sc1
    s_waitcnt vmcnt(6)
    v_max3_u32 v32, v16, v17, v18
    s_waitcnt vmcnt(5)
    v_max3_u32 v33, v19, v20, v21
    s_waitcnt vmcnt(4)
    v_max3_u32 v32, v22, v23, v32
    s_waitcnt vmcnt(3)
L_pad_6:
    s_cbranch_execz L_pad_ret
    v_max3_u32 v33, v24, v25, v33
    s_waitcnt vmcnt(2)
    v_max3_u32 v32, v26, v27, v32
    s_waitcnt vmcnt(1)
    v_max3_u32 v33, v28, v29, v33
    s_waitcnt vmcnt(0)
    v_max3_u32 v32, v30, v31, v32
    v_max_u32 v32, v32, v33
    v_cmp_eq_u32 vcc, -1, v32
    s_add_u32 s49, s49, 1
    s_cbranch_vccz L_st_got
    s_cmp_lt_u32 s49, 131072
    s_cbranch_scc1 L_st_poll
L_st_got:
    v_pk_add_f32 v[32:33], v[16:17], v[18:19]
    v_pk_add_f32 v[34:35], v[20:21], v[22:23]
    v_pk_add_f32 v[36:37], v[24:25], v[26:27]
    v_pk_add_f32 v[38:39], v[28:29], v[30:31]
    v_pk_add_f32 v[32:33], v[32:33], v[34:35]
    v_pk_add_f32 v[36:37], v[36:37], v[38:39]
    v_pk_add_f32 v[32:33], v[32:33], v[36:37]
    v_mov_b32 v34, v32
    v_mul_f32 v33, 0x3d000000, v33
    s_nop 0
    v_permlane32_swap_b32 v34, v32
    v_add_f32 v32, v32, v34
    v_mul_f32 v32, 0x3d800000, v32
    v_sub_f32 v16, v16, v32
    v_sub_f32 v18, v18, v32
    v_sub_f32 v20, v20, v32
    v_sub_f32 v22, v22, v32
    v_sub_f32 v24, v24, v32
    v_sub_f32 v26, v26, v32
    v_sub_f32 v28, v28, v32
    v_sub_f32 v30, v30, v32
    v_mul_f32 v35, v16, v16
    v_fmac_f32 v33, v18, v18
    v_fmac_f32 v35, v20, v20
    v_fmac_f32 v33, v22, v22
    v_fmac_f32 v35, v24, v24
    v_fmac_f32 v33, v26, v26
    v_fmac_f32 v35, v28, v28
    v_fmac_f32 v33, v30, v30
    v_add_f32 v33, v33, v35
    v_mov_b32 v34, v33
    v_mov_b32 v35, 0x2edbe6ff
    s_nop 0
    v_permlane32_swap_b32 v34, v33
    v_add_f32 v33, v33, v34
    v_fmac_f32 v35, 0x3d800054, v33
    v_rsq_f32 v34, v35
    v_sub_f32 v32, v96, v32
    v_mul_f32 v32, v32, v34
    v_pk_fma_f32 v[48:49], v[98:99], v[34:35], v[32:33] op_sel_hi:[1,0,0]
    v_pk_fma_f32 v[50:51], v[100:101], v[34:35], v[32:33] op_sel_hi:[1,0,0]
    v_pk_fma_f32 v[52:53], v[102:103], v[34:35], v[32:33] op_sel_hi:[1,0,0]
    v_pk_fma_f32 v[54:55], v[104:105], v[34:35], v[32:33] op_sel_hi:[1,0,0]
    v_cvt_pk_bf16_f32 v16, v48, v49
    v_cvt_pk_bf16_f32 v17, v50, v51
    v_cvt_pk_bf16_f32 v18, v52, v53
    v_cvt_pk_bf16_f32 v19, v54, v55
    ds_write_b128 v12, v[16:19] offset:0
    v_pk_fma_f32 v[56:57], v[106:107], v[34:35], v[32:33] op_sel_hi:[1,0,0]
    v_pk_fma_f32 v[58:59], v[108:109], v[34:35], v[32:33] op_sel_hi:[1,0,0]
    v_pk_fma_f32 v[60:61], v[110:111], v[34:35], v[32:33] op_sel_hi:[1,0,0]
    v_pk_fma_f32 v[62:63], v[112:113], v[34:35], v[32:33] op_sel_hi:[1,0,0]
    v_cvt_pk_bf16_f32 v20, v56, v57
    v_cvt_pk_bf16_f32 v21, v58, v59
    v_cvt_pk_bf16_f32 v22, v60, v61
    v_cvt_pk_bf16_f32 v23, v62, v63
    ds_write_b128 v12, v[20:23] offset:32
    ds_read_b64_tr_b16 v[24:25], v13 offset:0
    ds_read_b64_tr_b16 v[26:27], v13 offset:1024
    ds_read_b64_tr_b16 v[28:29], v13 offset:32
    ds_read_b64_tr_b16 v[30:31], v13 offset:1056
    s_waitcnt lgkmcnt(2)
    buffer_store_dwordx4 v[24:27], v2, s[12:15], s9 offen sc1
    s_waitcnt lgkmcnt(0)
    buffer_store_dwordx4 v[28:31], v2, s[12:15], s9 offen offset:1024 sc1
    v_mov_b32 v8, s44
    v_mov_b32 v9, s45
    s_cmp_lg_u32 s40, 0
    s_barrier
    s_cbranch_scc1 L_nosig_17
    s_mov_b64 exec, 15
    buffer_atomic_swap_x2 v[8:9], v254, s[12:15], s48 offen sc1
    s_mov_b64 exec, -1
L_nosig_17:
    s_or_b32 s46, s2, s40
    s_cbranch_scc1 L_notag_18
    s_mov_b32 s46, 14942208
    v_mov_b32 v34, s44
    v_mov_b32 v35, s45
    buffer_store_dwordx2 v[34:35], off, s[12:15], s46 sc1
L_notag_18:
    s_lshr_b32 s55, s41, 1
    s_lshl3_add_u32 s55, s55, s43
    s_lshl2_add_u32 s55, s55, s40
    s_lshl_b32 s55, s55, 7
    s_add_u32 s55, s55, 15237120
    s_cmp_ge_u32 s42, 28
    s_cbranch_scc1 L_idle4
    s_mov_b64 exec, 255
    v_mov_b32 v8, 0
    v_mov_b32 v9, 0
    buffer_atomic_or_x2 v[8:9], v255, s[12:15], s55 offen sc0 sc1
    s_mov_b64 exec, -1
    s_add_u32 m0, s92, 81920
    s_add_u32 s100, s100, 65536
    s_cmp_eq_u32 s100, s3
    s_cselect_b32 s100, s101, s100
    buffer_load_dwordx4 v250, s[24:27], s100 offen lds
    buffer_load_dwordx4 v251, s[24:27], s100 offen offset:1024 lds
    s_add_u32 m0, s92, 90112
    s_add_u32 s100, s100, 65536
    buffer_load_dwordx4 v250, s[24:27], s100 offen lds
    buffer_load_dwordx4 v251, s[24:27], s100 offen offset:1024 lds
    s_add_u32 m0, s92, 98304
    s_add_u32 s100, s100, 65536
    buffer_load_dwordx4 v250, s[24:27], s100 offen lds
    buffer_load_dwordx4 v251, s[24:27], s100 offen offset:1024 lds
    s_add_u32 m0, s92, 0
    s_add_u32 s100, s100, 65536
    buffer_load_dwordx4 v250, s[24:27], s100 offen lds
    buffer_load_dwordx4 v251, s[24:27], s100 offen offset:1024 lds
    s_add_u32 m0, s92, 8192
    s_add_u32 s100, s100, 65536
    s_cmp_eq_u32 s100, s3
    s_cselect_b32 s100, s101, s100
    buffer_load_dwordx4 v250, s[24:27], s100 offen lds
    buffer_load_dwordx4 v251, s[24:27], s100 offen offset:1024 lds
    s_add_u32 m0, s92, 106496
    s_add_u32 s100, s100, 65536
    buffer_load_dwordx4 v250, s[24:27], s100 offen lds
    buffer_load_dwordx4 v251, s[24:27], s100 offen offset:1024 lds
    s_lshl2_add_u32 s51, s43, s40
    s_mul_i32 s51, s51, 65536
    s_add_u32 s51, s51, 10485760
    s_add_u32 s52, s51, 65536
    s_lshl_b32 s50, s98, 13
    s_add_u32 s50, s50, s51
    s_and_b32 s46, s40, 1
    v_lshl_add_u32 v3, s46, 11, v2
    v_xor_b32 v4, 2048, v3
    s_and_b32 s46, s40, 1
    s_lshl1_add_u32 s54, s43, s46
    v_lshlrev_b32 v16, 16, v240
    v_and_b32 v17, 0xffff0000, v240
    v_lshlrev_b32 v18, 16, v241
    v_and_b32 v19, 0xffff0000, v241
    v_lshlrev_b32 v20, 16, v242
    v_and_b32 v21, 0xffff0000, v242
    v_lshlrev_b32 v22, 16, v243
    v_and_b32 v23, 0xffff0000, v243
    s_xor_b32 s46, s40, 1
    s_mul_i32 s46, s46, 12288
    v_add_u32 v12, s46, v2
    s_xor_b32 s46, s40, 2
    s_mul_i32 s46, s46, 12288
    v_add_u32 v13, s46, v2
    s_xor_b32 s46, s40, 3
    s_mul_i32 s46, s46, 12288
    v_add_u32 v14, s46, v2
    s_mul_i32 s46, s40, 12288
    v_add_u32 v15, s46, v2
    s_mov_b64 exec, 255
    s_waitcnt vmcnt(12)
    v_cmp_ne_u64 vcc, s[44:45], v[8:9]
    s_mov_b32 s49, 0
    s_cbranch_vccz L_seen_21
L_poll_19:
    v_mov_b32 v8, 0
    v_mov_b32 v9, 0
    buffer_atomic_or_x2 v[8:9], v255, s[12:15], s55 offen sc0 sc1
    s_add_u32 s49, s49, 1
    s_waitcnt vmcnt(0)
    v_cmp_ne_u64 vcc, s[44:45], v[8:9]
    s_nop 0
    s_cbranch_vccz L_seen_21
    s_cmp_lt_u32 s49, 131072
    s_cbranch_scc1 L_poll_19
L_seen_21:
    s_mov_b64 exec, -1
L_loop4:
    buffer_load_dwordx4 v[96:99], v3, s[12:15], s50 offen offset:0 sc1
    buffer_load_dwordx4 v[100:103], v3, s[12:15], s50 offen offset:1024 sc1
    buffer_load_dwordx4 v[104:107], v4, s[12:15], s50 offen offset:0 sc1
    buffer_load_dwordx4 v[108:111], v4, s[12:15], s50 offen offset:1024 sc1
    s_add_u32 s50, s50, 4096
    buffer_load_dwordx4 v[112:115], v3, s[12:15], s50 offen offset:0 sc1
    buffer_load_dwordx4 v[116:119], v3, s[12:15], s50 offen offset:1024 sc1
    buffer_load_dwordx4 v[120:123], v4, s[12:15], s50 offen offset:0 sc1
    buffer_load_dwordx4 v[124:127], v4, s[12:15], s50 offen offset:1024 sc1
    s_add_u32 s50, s50, 4096
    s_cmp_eq_u32 s50, s52
    s_cselect_b32 s50, s51, s50
    buffer_load_dwordx4 v[128:131], v3, s[12:15], s50 offen offset:0 sc1
    buffer_load_dwordx4 v[132:135], v3, s[12:15], s50 offen offset:1024 sc1
    buffer_load_dwordx4 v[136:139], v4, s[12:15], s50 offen offset:0 sc1
    buffer_load_dwordx4 v[140:143], v4, s[12:15], s50 offen offset:1024 sc1
    s_waitcnt vmcnt(11)
    v_mfma_f32_16x16x32_bf16 v[32:35], a[0:3], v[96:99], v[16:19]
    s_add_u32 s50, s50, 4096
    s_waitcnt vmcnt(10)
    v_mfma_f32_16x16x32_bf16 v[40:43], a[0:3], v[100:103], v[16:19]
    buffer_load_dwordx4 v[144:147], v3, s[12:15], s50 offen offset:0 sc1
    v_mfma_f32_16x16x32_bf16 v[44:47], a[4:7], v[100:103], v[20:23]
    v_mfma_f32_16x16x32_bf16 v[36:39], a[4:7], v[96:99], v[20:23]
    buffer_load_dwordx4 v[148:151], v3, s[12:15], s50 offen offset:1024 sc1
    v_mfma_f32_16x16x32_bf16 v[64:67], a[8:11], v[96:99], 0
    v_mfma_f32_16x16x32_bf16 v[72:75], a[8:11], v[100:103], 0
    v_max3_u32 v11, v96, v100, 0
    v_mfma_f32_16x16x32_bf16 v[76:79], a[12:15], v[100:103], 0
    v_mfma_f32_16x16x32_bf16 v[68:71], a[12:15], v[96:99], 0
    s_waitcnt vmcnt(11)
    v_mfma_f32_16x16x32_bf16 v[48:51], a[0:3], v[104:107], 0
    s_waitcnt vmcnt(10)
    v_mfma_f32_16x16x32_bf16 v[56:59], a[0:3], v[108:111], 0
    buffer_load_dwordx4 v[96:99], v4, s[12:15], s50 offen offset:0 sc1
    v_mfma_f32_16x16x32_bf16 v[60:63], a[4:7], v[108:111], 0
    v_mfma_f32_16x16x32_bf16 v[52:55], a[4:7], v[104:107], 0
    buffer_load_dwordx4 v[100:103], v4, s[12:15], s50 offen offset:1024 sc1
    v_mfma_f32_16x16x32_bf16 v[80:83], a[8:11], v[104:107], 0
    v_mfma_f32_16x16x32_bf16 v[88:91], a[8:11], v[108:111], 0
    v_max3_u32 v11, v104, v108, v11
    v_mfma_f32_16x16x32_bf16 v[92:95], a[12:15], v[108:111], 0
    v_mfma_f32_16x16x32_bf16 v[84:87], a[12:15], v[104:107], 0
    s_waitcnt vmcnt(11)
    v_mfma_f32_16x16x32_bf16 v[32:35], a[16:19], v[112:115], v[32:35]
    s_add_u32 s50, s50, 4096
    s_cmp_eq_u32 s50, s52
    s_cselect_b32 s50, s51, s50
    ds_read_b64_tr_b16 a[0:1], v252 offset:16384
    s_waitcnt vmcnt(10)
    v_mfma_f32_16x16x32_bf16 v[40:43], a[16:19], v[116:119], v[40:43]
    buffer_load_dwordx4 v[104:107], v3, s[12:15], s50 offen offset:0 sc1
    v_mfma_f32_16x16x32_bf16 v[44:47], a[20:23], v[116:119], v[44:47]
    ds_read_b64_tr_b16 a[4:5], v244 offset:16384
    v_mfma_f32_16x16x32_bf16 v[36:39], a[20:23], v[112:115], v[36:39]
    buffer_load_dwordx4 v[108:111], v3, s[12:15], s50 offen offset:1024 sc1
    v_mfma_f32_16x16x32_bf16 v[64:67], a[24:27], v[112:115], v[64:67]
    ds_read_b64_tr_b16 a[8:9], v252 offset:16896
    v_mfma_f32_16x16x32_bf16 v[72:75], a[24:27], v[116:119], v[72:75]
    v_max3_u32 v11, v112, v116, v11
    v_mfma_f32_16x16x32_bf16 v[76:79], a[28:31], v[116:119], v[76:79]
    ds_read_b64_tr_b16 a[12:13], v244 offset:16896
    v_mfma_f32_16x16x32_bf16 v[68:71], a[28:31], v[112:115], v[68:71]
    s_waitcnt vmcnt(11)
    v_mfma_f32_16x16x32_bf16 v[48:51], a[16:19], v[120:123], v[48:51]
    ds_read_b64_tr_b16 a[2:3], v252 offset:24576
    s_waitcnt vmcnt(10)
    v_mfma_f32_16x16x32_bf16 v[56:59], a[16:19], v[124:127], v[56:59]
    buffer_load_dwordx4 v[112:115], v4, s[12:15], s50 offen offset:0 sc1
    v_mfma_f32_16x16x32_bf16 v[60:63], a[20:23], v[124:127], v[60:63]
    ds_read_b64_tr_b16 a[6:7], v244 offset:24576
    v_mfma_f32_16x16x32_bf16 v[52:55], a[20:23], v[120:123], v[52:55]
    buffer_load_dwordx4 v[116:119], v4, s[12:15], s50 offen offset:1024 sc1
    v_mfma_f32_16x16x32_bf16 v[80:83], a[24:27], v[120:123], v[80:83]
    ds_read_b64_tr_b16 a[10:11], v252 offset:25088
    v_mfma_f32_16x16x32_bf16 v[88:91], a[24:27], v[124:127], v[88:91]
    v_max3_u32 v11, v120, v124, v11
    v_mfma_f32_16x16x32_bf16 v[92:95], a[28:31], v[124:127], v[92:95]
    ds_read_b64_tr_b16 a[14:15], v244 offset:25088
    v_mfma_f32_16x16x32_bf16 v[84:87], a[28:31], v[120:123], v[84:87]
    s_waitcnt vmcnt(11)
    v_mfma_f32_16x16x32_bf16 v[32:35], a[32:35], v[128:131], v[32:35]
    s_add_u32 s50, s50, 4096
    ds_read_b64_tr_b16 a[16:17], v252 offset:32768
    s_waitcnt vmcnt(10)
    v_mfma_f32_16x16x32_bf16 v[40:43], a[32:35], v[132:135], v[40:43]
    buffer_load_dwordx4 v[120:123], v3, s[12:15], s50 offen offset:0 sc1
    v_mfma_f32_16x16x32_bf16 v[44:47], a[36:39], v[132:135], v[44:47]
    ds_read_b64_tr_b16 a[20:21], v244 offset:32768
    v_mfma_f32_16x16x32_bf16 v[36:39], a[36:39], v[128:131], v[36:39]
    buffer_load_dwordx4 v[124:127], v3, s[12:15], s50 offen offset:1024 sc1
    v_mfma_f32_16x16x32_bf16 v[64:67], a[40:43], v[128:131], v[64:67]
    ds_read_b64_tr_b16 a[24:25], v252 offset:33280
    v_mfma_f32_16x16x32_bf16 v[72:75], a[40:43], v[132:135], v[72:75]
    v_max3_u32 v11, v128, v132, v11
    v_mfma_f32_16x16x32_bf16 v[76:79], a[44:47], v[132:135], v[76:79]
    ds_read_b64_tr_b16 a[28:29], v244 offset:33280
    v_mfma_f32_16x16x32_bf16 v[68:71], a[44:47], v[128:131], v[68:71]
    s_waitcnt vmcnt(11)
    v_mfma_f32_16x16x32_bf16 v[48:51], a[32:35], v[136:139], v[48:51]
    ds_read_b64_tr_b16 a[18:19], v252 offset:40960
    s_waitcnt vmcnt(10)
    v_mfma_f32_16x16x32_bf16 v[56:59], a[32:35], v[140:143], v[56:59]
    buffer_load_dwordx4 v[128:131], v4, s[12:15], s50 offen offset:0 sc1
    v_mfma_f32_16x16x32_bf16 v[60:63], a[36:39], v[140:143], v[60:63]
    ds_read_b64_tr_b16 a[22:23], v244 offset:40960
    v_mfma_f32_16x16x32_bf16 v[52:55], a[36:39], v[136:139], v[52:55]
    buffer_load_dwordx4 v[132:135], v4, s[12:15], s50 offen offset:1024 sc1
    v_mfma_f32_16x16x32_bf16 v[80:83], a[40:43], v[136:139], v[80:83]
    ds_read_b64_tr_b16 a[26:27], v252 offset:41472
    v_mfma_f32_16x16x32_bf16 v[88:91], a[40:43], v[140:143], v[88:91]
    v_max3_u32 v11, v136, v140, v11
    v_mfma_f32_16x16x32_bf16 v[92:95], a[44:47], v[140:143], v[92:95]
    ds_read_b64_tr_b16 a[30:31], v244 offset:41472
    v_mfma_f32_16x16x32_bf16 v[84:87], a[44:47], v[136:139], v[84:87]
    s_waitcnt vmcnt(11)
    v_mfma_f32_16x16x32_bf16 v[32:35], a[48:51], v[144:147], v[32:35]
    s_add_u32 s50, s50, 4096
    s_cmp_eq_u32 s50, s52
    s_cselect_b32 s50, s51, s50
    ds_read_b64_tr_b16 a[32:33], v252 offset:49152
    s_waitcnt vmcnt(10)
    v_mfma_f32_16x16x32_bf16 v[40:43], a[48:51], v[148:151], v[40:43]
    buffer_load_dwordx4 v[136:139], v3, s[12:15], s50 offen offset:0 sc1
    v_mfma_f32_16x16x32_bf16 v[44:47], a[52:55], v[148:151], v[44:47]
    ds_read_b64_tr_b16 a[36:37], v244 offset:49152
    v_mfma_f32_16x16x32_bf16 v[36:39], a[52:55], v[144:147], v[36:39]
    buffer_load_dwordx4 v[140:143], v3, s[12:15], s50 offen offset:1024 sc1
    v_mfma_f32_16x16x32_bf16 v[64:67], a[56:59], v[144:147], v[64:67]
    ds_read_b64_tr_b16 a[40:41], v252 offset:49664
    v_mfma_f32_16x16x32_bf16 v[72:75], a[56:59], v[148:151], v[72:75]
    v_max3_u32 v11, v144, v148, v11
    v_mfma_f32_16x16x32_bf16 v[76:79], a[60:63], v[148:151], v[76:79]
    ds_read_b64_tr_b16 a[44:45], v244 offset:49664
    v_mfma_f32_16x16x32_bf16 v[68:71], a[60:63], v[144:147], v[68:71]
    s_waitcnt vmcnt(11)
    v_mfma_f32_16x16x32_bf16 v[48:51], a[48:51], v[96:99], v[48:51]
    ds_read_b64_tr_b16 a[34:35], v253 offset:0
    s_waitcnt vmcnt(10)
    v_mfma_f32_16x16x32_bf16 v[56:59], a[48:51], v[100:103], v[56:59]
    buffer_load_dwordx4 v[144:147], v4, s[12:15], s50 offen offset:0 sc1
    v_mfma_f32_16x16x32_bf16 v[60:63], a[52:55], v[100:103], v[60:63]
    ds_read_b64_tr_b16 a[38:39], v245 offset:0
    v_mfma_f32_16x16x32_bf16 v[52:55], a[52:55], v[96:99], v[52:55]
    buffer_load_dwordx4 v[148:151], v4, s[12:15], s50 offen offset:1024 sc1
    v_mfma_f32_16x16x32_bf16 v[80:83], a[56:59], v[96:99], v[80:83]
    ds_read_b64_tr_b16 a[42:43], v253 offset:512
    v_mfma_f32_16x16x32_bf16 v[88:91], a[56:59], v[100:103], v[88:91]
    v_max3_u32 v11, v96, v100, v11
    v_mfma_f32_16x16x32_bf16 v[92:95], a[60:63], v[100:103], v[92:95]
    ds_read_b64_tr_b16 a[46:47], v245 offset:512
    v_mfma_f32_16x16x32_bf16 v[84:87], a[60:63], v[96:99], v[84:87]
    s_waitcnt vmcnt(11)
    v_mfma_f32_16x16x32_bf16 v[32:35], a[64:67], v[104:107], v[32:35]
    s_add_u32 s50, s50, 4096
    ds_read_b64_tr_b16 a[48:49], v253 offset:8192
    s_waitcnt vmcnt(10)
    v_mfma_f32_16x16x32_bf16 v[40:43], a[64:67], v[108:111], v[40:43]
    buffer_load_dwordx4 v[96:99], v3, s[12:15], s50 offen offset:0 sc1
    v_mfma_f32_16x16x32_bf16 v[44:47], a[68:71], v[108:111], v[44:47]
    ds_read_b64_tr_b16 a[52:53], v245 offset:8192
    v_mfma_f32_16x16x32_bf16 v[36:39], a[68:71], v[104:107], v[36:39]
    buffer_load_dwordx4 v[100:103], v3, s[12:15], s50 offen offset:1024 sc1
    v_mfma_f32_16x16x32_bf16 v[64:67], a[72:75], v[104:107], v[64:67]
    ds_read_b64_tr_b16 a[56:57], v253 offset:8704
    v_mfma_f32_16x16x32_bf16 v[72:75], a[72:75], v[108:111], v[72:75]
    v_max3_u32 v11, v104, v108, v11
    v_mfma_f32_16x16x32_bf16 v[76:79], a[76:79], v[108:111], v[76:79]
    ds_read_b64_tr_b16 a[60:61], v245 offset:8704
    v_mfma_f32_16x16x32_bf16 v[68:71], a[76:79], v[104:107], v[68:71]
    s_waitcnt vmcnt(11)
    v_mfma_f32_16x16x32_bf16 v[48:51], a[64:67], v[112:115], v[48:51]
    ds_read_b64_tr_b16 a[50:51], v253 offset:16384
    s_waitcnt vmcnt(10)
    v_mfma_f32_16x16x32_bf16 v[56:59], a[64:67], v[116:119], v[56:59]
    buffer_load_dwordx4 v[104:107], v4, s[12:15], s50 offen offset:0 sc1
    v_mfma_f32_16x16x32_bf16 v[60:63], a[68:71], v[116:119], v[60:63]
    ds_read_b64_tr_b16 a[54:55], v245 offset:16384
    v_mfma_f32_16x16x32_bf16 v[52:55], a[68:71], v[112:115], v[52:55]
    buffer_load_dwordx4 v[108:111], v4, s[12:15], s50 offen offset:1024 sc1
    v_mfma_f32_16x16x32_bf16 v[80:83], a[72:75], v[112:115], v[80:83]
    ds_read_b64_tr_b16 a[58:59], v253 offset:16896
    v_mfma_f32_16x16x32_bf16 v[88:91], a[72:75], v[116:119], v[88:91]
    v_max3_u32 v11, v112, v116, v11
    v_mfma_f32_16x16x32_bf16 v[92:95], a[76:79], v[116:119], v[92:95]
    ds_read_b64_tr_b16 a[62:63], v245 offset:16896
    v_mfma_f32_16x16x32_bf16 v[84:87], a[76:79], v[112:115], v[84:87]
    s_waitcnt vmcnt(11)
    v_mfma_f32_16x16x32_bf16 v[32:35], a[80:83], v[120:123], v[32:35]
    s_add_u32 s50, s50, 4096
    s_cmp_eq_u32 s50, s52
    s_cselect_b32 s50, s51, s50
    ds_read_b64_tr_b16 a[64:65], v253 offset:24576
    s_waitcnt vmcnt(10)
    v_mfma_f32_16x16x32_bf16 v[40:43], a[80:83], v[124:127], v[40:43]
    buffer_load_dwordx4 v[112:115], v3, s[12:15], s50 offen offset:0 sc1
    v_mfma_f32_16x16x32_bf16 v[44:47], a[84:87], v[124:127], v[44:47]
    ds_read_b64_tr_b16 a[68:69], v245 offset:24576
    v_mfma_f32_16x16x32_bf16 v[36:39], a[84:87], v[120:123], v[36:39]
    buffer_load_dwordx4 v[116:119], v3, s[12:15], s50 offen offset:1024 sc1
    v_mfma_f32_16x16x32_bf16 v[64:67], a[88:91], v[120:123], v[64:67]
    ds_read_b64_tr_b16 a[72:73], v253 offset:25088
    v_mfma_f32_16x16x32_bf16 v[72:75], a[88:91], v[124:127], v[72:75]
    v_max3_u32 v11, v120, v124, v11
    v_mfma_f32_16x16x32_bf16 v[76:79], a[92:95], v[124:127], v[76:79]
    ds_read_b64_tr_b16 a[76:77], v245 offset:25088
    v_mfma_f32_16x16x32_bf16 v[68:71], a[92:95], v[120:123], v[68:71]
    s_waitcnt vmcnt(11)
    v_mfma_f32_16x16x32_bf16 v[48:51], a[80:83], v[128:131], v[48:51]
    ds_read_b64_tr_b16 a[66:67], v253 offset:32768
    s_waitcnt vmcnt(10)
    v_mfma_f32_16x16x32_bf16 v[56:59], a[80:83], v[132:135], v[56:59]
    buffer_load_dwordx4 v[120:123], v4, s[12:15], s50 offen offset:0 sc1
    v_mfma_f32_16x16x32_bf16 v[60:63], a[84:87], v[132:135], v[60:63]
    ds_read_b64_tr_b16 a[70:71], v245 offset:32768
    v_mfma_f32_16x16x32_bf16 v[52:55], a[84:87], v[128:131], v[52:55]
    buffer_load_dwordx4 v[124:127], v4, s[12:15], s50 offen offset:1024 sc1
    v_mfma_f32_16x16x32_bf16 v[80:83], a[88:91], v[128:131], v[80:83]
    ds_read_b64_tr_b16 a[74:75], v253 offset:33280
    v_mfma_f32_16x16x32_bf16 v[88:91], a[88:91], v[132:135], v[88:91]
    v_max3_u32 v11, v128, v132, v11
    v_mfma_f32_16x16x32_bf16 v[92:95], a[92:95], v[132:135], v[92:95]
    ds_read_b64_tr_b16 a[78:79], v245 offset:33280
    v_mfma_f32_16x16x32_bf16 v[84:87], a[92:95], v[128:131], v[84:87]
    s_waitcnt vmcnt(11)
    v_mfma_f32_16x16x32_bf16 v[32:35], a[96:99], v[136:139], v[32:35]
    s_add_u32 s50, s50, 4096
    ds_read_b64_tr_b16 a[80:81], v253 offset:40960
    s_waitcnt vmcnt(10)
    v_mfma_f32_16x16x32_bf16 v[40:43], a[96:99], v[140:143], v[40:43]
    buffer_load_dwordx4 v[128:131], v3, s[12:15], s50 offen offset:0 sc1
    v_mfma_f32_16x16x32_bf16 v[44:47], a[100:103], v[140:143], v[44:47]
    ds_read_b64_tr_b16 a[84:85], v245 offset:40960
    v_mfma_f32_16x16x32_bf16 v[36:39], a[100:103], v[136:139], v[36:39]
    buffer_load_dwordx4 v[132:135], v3, s[12:15], s50 offen offset:1024 sc1
    v_mfma_f32_16x16x32_bf16 v[64:67], a[104:107], v[136:139], v[64:67]
    ds_read_b64_tr_b16 a[88:89], v253 offset:41472
    v_mfma_f32_16x16x32_bf16 v[72:75], a[104:107], v[140:143], v[72:75]
    v_max3_u32 v11, v136, v140, v11
    v_mfma_f32_16x16x32_bf16 v[76:79], a[108:111], v[140:143], v[76:79]
    ds_read_b64_tr_b16 a[92:93], v245 offset:41472
    v_mfma_f32_16x16x32_bf16 v[68:71], a[108:111], v[136:139], v[68:71]
    s_waitcnt vmcnt(11)
    v_mfma_f32_16x16x32_bf16 v[48:51], a[96:99], v[144:147], v[48:51]
    ds_read_b64_tr_b16 a[82:83], v252 offset:0
    s_waitcnt vmcnt(10)
    v_mfma_f32_16x16x32_bf16 v[56:59], a[96:99], v[148:151], v[56:59]
    buffer_load_dwordx4 v[136:139], v4, s[12:15], s50 offen offset:0 sc1
    v_mfma_f32_16x16x32_bf16 v[60:63], a[100:103], v[148:151], v[60:63]
    ds_read_b64_tr_b16 a[86:87], v244 offset:0
    v_mfma_f32_16x16x32_bf16 v[52:55], a[100:103], v[144:147], v[52:55]
    buffer_load_dwordx4 v[140:143], v4, s[12:15], s50 offen offset:1024 sc1
    v_mfma_f32_16x16x32_bf16 v[80:83], a[104:107], v[144:147], v[80:83]
    ds_read_b64_tr_b16 a[90:91], v252 offset:512
    v_mfma_f32_16x16x32_bf16 v[88:91], a[104:107], v[148:151], v[88:91]
    v_max3_u32 v11, v144, v148, v11
    v_mfma_f32_16x16x32_bf16 v[92:95], a[108:111], v[148:151], v[92:95]
    ds_read_b64_tr_b16 a[94:95], v244 offset:512
    v_mfma_f32_16x16x32_bf16 v[84:87], a[108:111], v[144:147], v[84:87]
    s_waitcnt vmcnt(11)
    v_mfma_f32_16x16x32_bf16 v[32:35], a[112:115], v[96:99], v[32:35]
    s_add_u32 s50, s50, 4096
    s_cmp_eq_u32 s50, s52
    s_cselect_b32 s50, s51, s50
    ds_read_b64_tr_b16 a[96:97], v252 offset:8192
    s_waitcnt vmcnt(10)
    v_mfma_f32_16x16x32_bf16 v[40:43], a[112:115], v[100:103], v[40:43]
    buffer_load_dwordx4 v[144:147], v3, s[12:15], s50 offen offset:0 sc1
    v_mfma_f32_16x16x32_bf16 v[44:47], a[116:119], v[100:103], v[44:47]
    ds_read_b64_tr_b16 a[100:101], v244 offset:8192
    v_mfma_f32_16x16x32_bf16 v[36:39], a[116:119], v[96:99], v[36:39]
    buffer_load_dwordx4 v[148:151], v3, s[12:15], s50 offen offset:1024 sc1
    v_mfma_f32_16x16x32_bf16 v[64:67], a[120:123], v[96:99], v[64:67]
    ds_read_b64_tr_b16 a[104:105], v252 offset:8704
    v_mfma_f32_16x16x32_bf16 v[72:75], a[120:123], v[100:103], v[72:75]
    v_max3_u32 v11, v96, v100, v11
    v_mfma_f32_16x16x32_bf16 v[76:79], a[124:127], v[100:103], v[76:79]
    ds_read_b64_tr_b16 a[108:109], v244 offset:8704
    v_mfma_f32_16x16x32_bf16 v[68:71], a[124:127], v[96:99], v[68:71]
    s_waitcnt vmcnt(11)
    v_mfma_f32_16x16x32_bf16 v[48:51], a[112:115], v[104:107], v[48:51]
    ds_read_b64_tr_b16 a[98:99], v253 offset:49152
    s_waitcnt vmcnt(10)
    v_mfma_f32_16x16x32_bf16 v[56:59], a[112:115], v[108:111], v[56:59]
    buffer_load_dwordx4 v[96:99], v4, s[12:15], s50 offen offset:0 sc1
    v_mfma_f32_16x16x32_bf16 v[60:63], a[116:119], v[108:111], v[60:63]
    ds_read_b64_tr_b16 a[102:103], v245 offset:49152
    v_mfma_f32_16x16x32_bf16 v[52:55], a[116:119], v[104:107], v[52:55]
    buffer_load_dwordx4 v[100:103], v4, s[12:15], s50 offen offset:1024 sc1
    v_mfma_f32_16x16x32_bf16 v[80:83], a[120:123], v[104:107], v[80:83]
    ds_read_b64_tr_b16 a[106:107], v253 offset:49664
    v_mfma_f32_16x16x32_bf16 v[88:91], a[120:123], v[108:111], v[88:91]
    v_max3_u32 v11, v104, v108, v11
    v_mfma_f32_16x16x32_bf16 v[92:95], a[124:127], v[108:111], v[92:95]
    ds_read_b64_tr_b16 a[110:111], v245 offset:49664
    v_mfma_f32_16x16x32_bf16 v[84:87], a[124:127], v[104:107], v[84:87]
    s_waitcnt vmcnt(11)
    v_mfma_f32_16x16x32_bf16 v[32:35], a[128:131], v[112:115], v[32:35]
    s_add_u32 s50, s50, 4096
    s_waitcnt vmcnt(10)
    v_mfma_f32_16x16x32_bf16 v[40:43], a[128:131], v[116:119], v[40:43]
    buffer_load_dwordx4 v[104:107], v3, s[12:15], s50 offen offset:0 sc1
    v_mfma_f32_16x16x32_bf16 v[44:47], a[132:135], v[116:119], v[44:47]
    v_and_b32 v8, 7, v1
    v_mfma_f32_16x16x32_bf16 v[36:39], a[132:135], v[112:115], v[36:39]
    buffer_load_dwordx4 v[108:111], v3, s[12:15], s50 offen offset:1024 sc1
    v_mfma_f32_16x16x32_bf16 v[64:67], a[136:139], v[112:115], v[64:67]
    v_and_b32 v6, 15, v1
    v_mfma_f32_16x16x32_bf16 v[72:75], a[136:139], v[116:119], v[72:75]
    v_max3_u32 v11, v112, v116, v11
    v_mfma_f32_16x16x32_bf16 v[76:79], a[140:143], v[116:119], v[76:79]
    v_lshl_add_u32 v6, v6, 7, s92
    v_mfma_f32_16x16x32_bf16 v[68:71], a[140:143], v[112:115], v[68:71]
    s_waitcnt vmcnt(11)
    v_mfma_f32_16x16x32_bf16 v[48:51], a[128:131], v[120:123], v[48:51]
    s_waitcnt vmcnt(10)
    v_mfma_f32_16x16x32_bf16 v[56:59], a[128:131], v[124:127], v[56:59]
    buffer_load_dwordx4 v[112:115], v4, s[12:15], s50 offen offset:0 sc1
    v_mfma_f32_16x16x32_bf16 v[60:63], a[132:135], v[124:127], v[60:63]
    v_add_u32 v6, 90112, v6
    v_mfma_f32_16x16x32_bf16 v[52:55], a[132:135], v[120:123], v[52:55]
    buffer_load_dwordx4 v[116:119], v4, s[12:15], s50 offen offset:1024 sc1
    v_mfma_f32_16x16x32_bf16 v[80:83], a[136:139], v[120:123], v[80:83]
    v_lshlrev_b32 v9, 1, v7
    v_mfma_f32_16x16x32_bf16 v[88:91], a[136:139], v[124:127], v[88:91]
    v_max3_u32 v11, v120, v124, v11
    v_mfma_f32_16x16x32_bf16 v[92:95], a[140:143], v[124:127], v[92:95]
    v_xor_b32 v9, v9, v8
    v_mfma_f32_16x16x32_bf16 v[84:87], a[140:143], v[120:123], v[84:87]
    s_waitcnt vmcnt(11)
    v_mfma_f32_16x16x32_bf16 v[32:35], a[144:147], v[128:131], v[32:35]
    s_add_u32 s50, s50, 4096
    s_cmp_eq_u32 s50, s52
    s_cselect_b32 s50, s51, s50
    s_waitcnt vmcnt(10)
    v_mfma_f32_16x16x32_bf16 v[40:43], a[144:147], v[132:135], v[40:43]
    buffer_load_dwordx4 v[120:123], v3, s[12:15], s50 offen offset:0 sc1
    v_mfma_f32_16x16x32_bf16 v[44:47], a[148:151], v[132:135], v[44:47]
    v_lshl_add_u32 v9, v9, 4, v6
    v_mfma_f32_16x16x32_bf16 v[36:39], a[148:151], v[128:131], v[36:39]
    buffer_load_dwordx4 v[124:127], v3, s[12:15], s50 offen offset:1024 sc1
    v_mfma_f32_16x16x32_bf16 v[64:67], a[152:155], v[128:131], v[64:67]
    v_and_b32 v5, 16, v1
    v_mfma_f32_16x16x32_bf16 v[72:75], a[152:155], v[132:135], v[72:75]
    v_max3_u32 v11, v128, v132, v11
    v_mfma_f32_16x16x32_bf16 v[76:79], a[156:159], v[132:135], v[76:79]
    v_lshl_add_u32 v9, v5, 9, v9
    v_mfma_f32_16x16x32_bf16 v[68:71], a[156:159], v[128:131], v[68:71]
    s_waitcnt vmcnt(11)
    v_mfma_f32_16x16x32_bf16 v[48:51], a[144:147], v[136:139], v[48:51]
    s_waitcnt vmcnt(10)
    v_mfma_f32_16x16x32_bf16 v[56:59], a[144:147], v[140:143], v[56:59]
    buffer_load_dwordx4 v[128:131], v4, s[12:15], s50 offen offset:0 sc1
    v_mfma_f32_16x16x32_bf16 v[60:63], a[148:151], v[140:143], v[60:63]
    v_xor_b32 v5, 16, v9
    v_mfma_f32_16x16x32_bf16 v[52:55], a[148:151], v[136:139], v[52:55]
    buffer_load_dwordx4 v[132:135], v4, s[12:15], s50 offen offset:1024 sc1
    v_mfma_f32_16x16x32_bf16 v[80:83], a[152:155], v[136:139], v[80:83]
    ds_write_b128 v9, v[220:223]
    v_mfma_f32_16x16x32_bf16 v[88:91], a[152:155], v[140:143], v[88:91]
    v_max3_u32 v11, v136, v140, v11
    v_mfma_f32_16x16x32_bf16 v[92:95], a[156:159], v[140:143], v[92:95]
    ds_write_b128 v5, v[224:227]
    v_mfma_f32_16x16x32_bf16 v[84:87], a[156:159], v[136:139], v[84:87]
    s_waitcnt vmcnt(11)
    v_mfma_f32_16x16x32_bf16 v[32:35], a[160:163], v[144:147], v[32:35]
    s_add_u32 s50, s50, 4096
    s_waitcnt vmcnt(10)
    v_mfma_f32_16x16x32_bf16 v[40:43], a[160:163], v[148:151], v[40:43]
    buffer_load_dwordx4 v[136:139], v3, s[12:15], s50 offen offset:0 sc1
    v_mfma_f32_16x16x32_bf16 v[44:47], a[164:167], v[148:151], v[44:47]
    v_xor_b32 v9, 64, v9
    v_mfma_f32_16x16x32_bf16 v[36:39], a[164:167], v[144:147], v[36:39]
    buffer_load_dwordx4 v[140:143], v3, s[12:15], s50 offen offset:1024 sc1
    v_mfma_f32_16x16x32_bf16 v[64:67], a[168:171], v[144:147], v[64:67]
    v_xor_b32 v5, 64, v5
    v_mfma_f32_16x16x32_bf16 v[72:75], a[168:171], v[148:151], v[72:75]
    v_max3_u32 v11, v144, v148, v11
    v_mfma_f32_16x16x32_bf16 v[76:79], a[172:175], v[148:151], v[76:79]
    ds_write_b128 v9, v[228:231]
    v_mfma_f32_16x16x32_bf16 v[68:71], a[172:175], v[144:147], v[68:71]
    s_waitcnt vmcnt(11)
    v_mfma_f32_16x16x32_bf16 v[48:51], a[160:163], v[96:99], v[48:51]
    s_waitcnt vmcnt(10)
    v_mfma_f32_16x16x32_bf16 v[56:59], a[160:163], v[100:103], v[56:59]
    buffer_load_dwordx4 v[144:147], v4, s[12:15], s50 offen offset:0 sc1
    v_mfma_f32_16x16x32_bf16 v[60:63], a[164:167], v[100:103], v[60:63]
    ds_write_b128 v5, v[232:235]
    v_mfma_f32_16x16x32_bf16 v[52:55], a[164:167], v[96:99], v[52:55]
    buffer_load_dwordx4 v[148:151], v4, s[12:15], s50 offen offset:1024 sc1
    v_mfma_f32_16x16x32_bf16 v[80:83], a[168:171], v[96:99], v[80:83]
    v_lshrrev_b32 v9, 4, v1
    v_mfma_f32_16x16x32_bf16 v[88:91], a[168:171], v[100:103], v[88:91]
    v_max3_u32 v11, v96, v100, v11
    v_mfma_f32_16x16x32_bf16 v[92:95], a[172:175], v[100:103], v[92:95]
    v_xor_b32 v9, v9, v8
    v_mfma_f32_16x16x32_bf16 v[84:87], a[172:175], v[96:99], v[84:87]
    s_waitcnt vmcnt(11)
    v_mfma_f32_16x16x32_bf16 v[32:35], a[176:179], v[104:107], v[32:35]
    s_add_u32 s50, s50, 4096
    s_cmp_eq_u32 s50, s52
    s_cselect_b32 s50, s51, s50
    s_waitcnt vmcnt(10)
    v_mfma_f32_16x16x32_bf16 v[40:43], a[176:179], v[108:111], v[40:43]
    buffer_load_dwordx4 v[96:99], v3, s[12:15], s50 offen offset:0 sc1
    v_mfma_f32_16x16x32_bf16 v[44:47], a[180:183], v[108:111], v[44:47]
    v_lshl_add_u32 v9, v9, 4, v6
    v_mfma_f32_16x16x32_bf16 v[36:39], a[180:183], v[104:107], v[36:39]
    buffer_load_dwordx4 v[100:103], v3, s[12:15], s50 offen offset:1024 sc1
    v_mfma_f32_16x16x32_bf16 v[64:67], a[184:187], v[104:107], v[64:67]
    v_xor_b32 v5, 64, v9
    v_mfma_f32_16x16x32_bf16 v[72:75], a[184:187], v[108:111], v[72:75]
    v_max3_u32 v11, v104, v108, v11
    v_mfma_f32_16x16x32_bf16 v[76:79], a[188:191], v[108:111], v[76:79]
    ds_read_b128 v[200:203], v9
    v_mfma_f32_16x16x32_bf16 v[68:71], a[188:191], v[104:107], v[68:71]
    s_waitcnt vmcnt(11)
    v_mfma_f32_16x16x32_bf16 v[48:51], a[176:179], v[112:115], v[48:51]
    s_waitcnt vmcnt(10)
    v_mfma_f32_16x16x32_bf16 v[56:59], a[176:179], v[116:119], v[56:59]
L_pad_7:
    s_cbranch_execz L_pad_ret
    buffer_load_dwordx4 v[104:107], v4, s[12:15], s50 offen offset:0 sc1
    v_mfma_f32_16x16x32_bf16 v[60:63], a[180:183], v[116:119], v[60:63]
    ds_read_b128 v[204:207], v5
    v_mfma_f32_16x16x32_bf16 v[52:55], a[180:183], v[112:115], v[52:55]
    buffer_load_dwordx4 v[108:111], v4, s[12:15], s50 offen offset:1024 sc1
    v_mfma_f32_16x16x32_bf16 v[80:83], a[184:187], v[112:115], v[80:83]
    ds_read_b128 v[208:211], v9 offset:8192
    v_mfma_f32_16x16x32_bf16 v[88:91], a[184:187], v[116:119], v[88:91]
    v_max3_u32 v11, v112, v116, v11
    v_mfma_f32_16x16x32_bf16 v[92:95], a[188:191], v[116:119], v[92:95]
    ds_read_b128 v[212:215], v5 offset:8192
    v_mfma_f32_16x16x32_bf16 v[84:87], a[188:191], v[112:115], v[84:87]
    s_waitcnt vmcnt(11)
    v_mfma_f32_16x16x32_bf16 v[32:35], a[192:195], v[120:123], v[32:35]
    s_add_u32 s50, s50, 4096
    s_waitcnt vmcnt(10)
    v_mfma_f32_16x16x32_bf16 v[40:43], a[192:195], v[124:127], v[40:43]
    buffer_load_dwordx4 v[112:115], v3, s[12:15], s50 offen offset:0 sc1
    v_mfma_f32_16x16x32_bf16 v[44:47], a[196:199], v[124:127], v[44:47]
    v_mfma_f32_16x16x32_bf16 v[36:39], a[196:199], v[120:123], v[36:39]
    buffer_load_dwordx4 v[116:119], v3, s[12:15], s50 offen offset:1024 sc1
    v_mfma_f32_16x16x32_bf16 v[64:67], a[200:203], v[120:123], v[64:67]
    v_mfma_f32_16x16x32_bf16 v[72:75], a[200:203], v[124:127], v[72:75]
    v_max3_u32 v11, v120, v124, v11
    v_mfma_f32_16x16x32_bf16 v[76:79], a[204:207], v[124:127], v[76:79]
    v_mfma_f32_16x16x32_bf16 v[68:71], a[204:207], v[120:123], v[68:71]
    s_waitcnt vmcnt(11)
    v_mfma_f32_16x16x32_bf16 v[48:51], a[192:195], v[128:131], v[48:51]
    s_waitcnt vmcnt(10)
    v_mfma_f32_16x16x32_bf16 v[56:59], a[192:195], v[132:135], v[56:59]
    buffer_load_dwordx4 v[120:123], v4, s[12:15], s50 offen offset:0 sc1
    v_mfma_f32_16x16x32_bf16 v[60:63], a[196:199], v[132:135], v[60:63]
    v_mfma_f32_16x16x32_bf16 v[52:55], a[196:199], v[128:131], v[52:55]
    buffer_load_dwordx4 v[124:127], v4, s[12:15], s50 offen offset:1024 sc1
    v_mfma_f32_16x16x32_bf16 v[80:83], a[200:203], v[128:131], v[80:83]
    v_mfma_f32_16x16x32_bf16 v[88:91], a[200:203], v[132:135], v[88:91]
    v_max3_u32 v11, v128, v132, v11
    v_mfma_f32_16x16x32_bf16 v[92:95], a[204:207], v[132:135], v[92:95]
    v_mfma_f32_16x16x32_bf16 v[84:87], a[204:207], v[128:131], v[84:87]
    s_waitcnt vmcnt(11)
    v_mfma_f32_16x16x32_bf16 v[32:35], a[208:211], v[136:139], v[32:35]
    s_waitcnt lgkmcnt(0)
    s_add_u32 m0, s92, 16384
    s_add_u32 s100, s100, 65536
    buffer_load_dwordx4 v250, s[24:27], s100 offen lds
    buffer_load_dwordx4 v251, s[24:27], s100 offen offset:1024 lds
    s_waitcnt vmcnt(12)
    v_mfma_f32_16x16x32_bf16 v[40:43], a[208:211], v[140:143], v[40:43]
    v_mfma_f32_16x16x32_bf16 v[44:47], a[212:215], v[140:143], v[44:47]
    v_mfma_f32_16x16x32_bf16 v[36:39], a[212:215], v[136:139], v[36:39]
    v_mfma_f32_16x16x32_bf16 v[64:67], a[216:219], v[136:139], v[64:67]
    v_mfma_f32_16x16x32_bf16 v[72:75], a[216:219], v[140:143], v[72:75]
    v_max3_u32 v11, v136, v140, v11
    v_mfma_f32_16x16x32_bf16 v[76:79], a[220:223], v[140:143], v[76:79]
    v_mfma_f32_16x16x32_bf16 v[68:71], a[220:223], v[136:139], v[68:71]
    s_waitcnt vmcnt(11)
    v_mfma_f32_16x16x32_bf16 v[48:51], a[208:211], v[144:147], v[48:51]
    s_add_u32 m0, s92, 24576
    s_add_u32 s100, s100, 65536
    buffer_load_dwordx4 v250, s[24:27], s100 offen lds
    buffer_load_dwordx4 v251, s[24:27], s100 offen offset:1024 lds
    s_waitcnt vmcnt(12)
    v_mfma_f32_16x16x32_bf16 v[56:59], a[208:211], v[148:151], v[56:59]
    v_mfma_f32_16x16x32_bf16 v[60:63], a[212:215], v[148:151], v[60:63]
    v_mfma_f32_16x16x32_bf16 v[52:55], a[212:215], v[144:147], v[52:55]
    v_mfma_f32_16x16x32_bf16 v[80:83], a[216:219], v[144:147], v[80:83]
    v_mfma_f32_16x16x32_bf16 v[88:91], a[216:219], v[148:151], v[88:91]
    v_max3_u32 v11, v144, v148, v11
    v_mfma_f32_16x16x32_bf16 v[92:95], a[220:223], v[148:151], v[92:95]
    v_mfma_f32_16x16x32_bf16 v[84:87], a[220:223], v[144:147], v[84:87]
    s_waitcnt vmcnt(11)
    v_mfma_f32_16x16x32_bf16 v[64:67], a[232:235], v[96:99], v[64:67]
    s_add_u32 m0, s92, 32768
    s_add_u32 s100, s100, 65536
    s_cmp_eq_u32 s100, s3
    s_cselect_b32 s100, s101, s100
    buffer_load_dwordx4 v250, s[24:27], s100 offen lds
    buffer_load_dwordx4 v251, s[24:27], s100 offen offset:1024 lds
    s_waitcnt vmcnt(12)
    v_mfma_f32_16x16x32_bf16 v[72:75], a[232:235], v[100:103], v[72:75]
    v_mfma_f32_16x16x32_bf16 v[76:79], a[236:239], v[100:103], v[76:79]
    v_max3_u32 v11, v96, v100, v11
    v_mfma_f32_16x16x32_bf16 v[68:71], a[236:239], v[96:99], v[68:71]
    s_waitcnt vmcnt(9)
    v_mfma_f32_16x16x32_bf16 v[64:67], a[248:251], v[112:115], v[64:67]
    s_waitcnt vmcnt(8)
    v_mfma_f32_16x16x32_bf16 v[72:75], a[248:251], v[116:119], v[72:75]
    v_mfma_f32_16x16x32_bf16 v[76:79], a[252:255], v[116:119], v[76:79]
    v_max3_u32 v11, v112, v116, v11
    v_mfma_f32_16x16x32_bf16 v[68:71], a[252:255], v[112:115], v[68:71]
    v_mfma_f32_16x16x32_bf16 v[48:51], a[224:227], v[104:107], v[48:51]
    s_add_u32 m0, s92, 40960
    s_add_u32 s100, s100, 65536
    buffer_load_dwordx4 v250, s[24:27], s100 offen lds
    buffer_load_dwordx4 v251, s[24:27], s100 offen offset:1024 lds
    v_mfma_f32_16x16x32_bf16 v[56:59], a[224:227], v[108:111], v[56:59]
    ds_write_b128 v13, v[64:67] offset:4096
    v_mfma_f32_16x16x32_bf16 v[60:63], a[228:231], v[108:111], v[60:63]
    v_max3_u32 v11, v104, v108, v11
    v_mfma_f32_16x16x32_bf16 v[52:55], a[228:231], v[104:107], v[52:55]
    ds_write_b128 v13, v[72:75] offset:6144
    s_waitcnt vmcnt(9)
    v_mfma_f32_16x16x32_bf16 v[48:51], a[240:243], v[120:123], v[48:51]
    s_waitcnt vmcnt(8)
    v_mfma_f32_16x16x32_bf16 v[56:59], a[240:243], v[124:127], v[56:59]
    ds_write_b128 v13, v[76:79] offset:7168
    v_mfma_f32_16x16x32_bf16 v[60:63], a[244:247], v[124:127], v[60:63]
    v_max3_u32 v11, v120, v124, v11
    v_mfma_f32_16x16x32_bf16 v[52:55], a[244:247], v[120:123], v[52:55]
    ds_write_b128 v13, v[68:71] offset:5120
    v_mfma_f32_16x16x32_bf16 v[80:83], a[232:235], v[104:107], v[80:83]
    s_add_u32 m0, s92, 49152
    s_add_u32 s100, s100, 65536
    buffer_load_dwordx4 v250, s[24:27], s100 offen lds
    buffer_load_dwordx4 v251, s[24:27], s100 offen offset:1024 lds
    v_mfma_f32_16x16x32_bf16 v[88:91], a[232:235], v[108:111], v[88:91]
    ds_write_b128 v12, v[48:51] offset:0
    v_mfma_f32_16x16x32_bf16 v[92:95], a[236:239], v[108:111], v[92:95]
    v_mfma_f32_16x16x32_bf16 v[84:87], a[236:239], v[104:107], v[84:87]
    ds_write_b128 v12, v[56:59] offset:2048
    v_mfma_f32_16x16x32_bf16 v[80:83], a[248:251], v[120:123], v[80:83]
    v_mfma_f32_16x16x32_bf16 v[88:91], a[248:251], v[124:127], v[88:91]
    ds_write_b128 v12, v[60:63] offset:3072
    v_mfma_f32_16x16x32_bf16 v[92:95], a[252:255], v[124:127], v[92:95]
    v_cmp_eq_u32 vcc, -1, v11
    v_mfma_f32_16x16x32_bf16 v[84:87], a[252:255], v[120:123], v[84:87]
    ds_write_b128 v12, v[52:55] offset:1024
    v_mfma_f32_16x16x32_bf16 v[32:35], a[224:227], v[96:99], v[32:35]
    s_add_u32 m0, s92, 57344
    s_add_u32 s100, s100, 65536
    buffer_load_dwordx4 v250, s[24:27], s100 offen lds
    buffer_load_dwordx4 v251, s[24:27], s100 offen offset:1024 lds
    v_mfma_f32_16x16x32_bf16 v[40:43], a[224:227], v[100:103], v[40:43]
    ds_write_b128 v14, v[80:83] offset:8192
    v_mfma_f32_16x16x32_bf16 v[44:47], a[228:231], v[100:103], v[44:47]
    v_mfma_f32_16x16x32_bf16 v[36:39], a[228:231], v[96:99], v[36:39]
    ds_write_b128 v14, v[88:91] offset:10240
    v_mfma_f32_16x16x32_bf16 v[32:35], a[240:243], v[112:115], v[32:35]
    s_add_u32 m0, s92, 65536
    s_add_u32 s100, s100, 65536
    s_cmp_eq_u32 s100, s3
    s_cselect_b32 s100, s101, s100
    buffer_load_dwordx4 v250, s[24:27], s100 offen lds
    buffer_load_dwordx4 v251, s[24:27], s100 offen offset:1024 lds
    v_mfma_f32_16x16x32_bf16 v[40:43], a[240:243], v[116:119], v[40:43]
    ds_write_b128 v14, v[92:95] offset:11264
    v_mfma_f32_16x16x32_bf16 v[44:47], a[244:247], v[116:119], v[44:47]
    v_mfma_f32_16x16x32_bf16 v[36:39], a[244:247], v[112:115], v[36:39]
    ds_write_b128 v14, v[84:87] offset:9216
    s_cbranch_vccnz L_redo4
L_done4:
    v_mov_b32 v8, 0xbdd2d3e8
    v_mov_b32 v16, 0xc0135761
    s_lshr_b32 s48, s41, 1
    s_lshl2_add_u32 s48, s43, s48
    s_lshl_b32 s48, s48, 7
    s_lshr_b32 s47, s42, 2
    s_lshl3_add_u32 s48, s47, s48
    s_add_u32 s48, s48, 15253504
    s_waitcnt lgkmcnt(0)
    s_barrier
    ds_read_b128 v[48:51], v15 offset:0
    ds_read_b128 v[64:67], v15 offset:4096
    ds_read_b128 v[80:83], v15 offset:8192
    ds_read_b128 v[52:55], v15 offset:1024
    ds_read_b128 v[68:71], v15 offset:5120
    ds_read_b128 v[84:87], v15 offset:9216
    ds_read_b128 v[56:59], v15 offset:2048
    ds_read_b128 v[72:75], v15 offset:6144
    ds_read_b128 v[88:91], v15 offset:10240
    ds_read_b128 v[60:63], v15 offset:3072
    ds_read_b128 v[76:79], v15 offset:7168
    ds_read_b128 v[92:95], v15 offset:11264
    s_waitcnt lgkmcnt(11)
    v_pk_add_f32 v[32:33], v[32:33], v[48:49]
    v_pk_add_f32 v[34:35], v[34:35], v[50:51]
    s_waitcnt lgkmcnt(10)
    v_pk_add_f32 v[32:33], v[32:33], v[64:65]
    v_pk_add_f32 v[34:35], v[34:35], v[66:67]
    s_waitcnt lgkmcnt(9)
    v_pk_add_f32 v[32:33], v[32:33], v[80:81]
    v_pk_add_f32 v[34:35], v[34:35], v[82:83]
    s_waitcnt lgkmcnt(8)
    v_pk_add_f32 v[36:37], v[36:37], v[52:53]
    v_pk_add_f32 v[38:39], v[38:39], v[54:55]
    s_waitcnt lgkmcnt(7)
    v_pk_add_f32 v[36:37], v[36:37], v[68:69]
    v_pk_add_f32 v[38:39], v[38:39], v[70:71]
    s_waitcnt lgkmcnt(6)
    v_pk_add_f32 v[36:37], v[36:37], v[84:85]
    v_pk_add_f32 v[38:39], v[38:39], v[86:87]
    v_pk_mul_f32 v[96:97], v[32:33], v[32:33]
    v_pk_mul_f32 v[98:99], v[34:35], v[34:35]
    v_pk_mul_f32 v[100:101], v[36:37], v[36:37]
    v_pk_mul_f32 v[102:103], v[38:39], v[38:39]
    v_pk_fma_f32 v[96:97], v[96:97], v[8:9], v[16:17] op_sel_hi:[1,0,0]
    v_pk_fma_f32 v[98:99], v[98:99], v[8:9], v[16:17] op_sel_hi:[1,0,0]
    v_pk_fma_f32 v[100:101], v[100:101], v[8:9], v[16:17] op_sel_hi:[1,0,0]
    v_pk_fma_f32 v[102:103], v[102:103], v[8:9], v[16:17] op_sel_hi:[1,0,0]
    v_pk_mul_f32 v[96:97], v[96:97], v[32:33]
    v_pk_mul_f32 v[98:99], v[98:99], v[34:35]
    v_pk_mul_f32 v[100:101], v[100:101], v[36:37]
    v_pk_mul_f32 v[102:103], v[102:103], v[38:39]
    v_exp_f32 v96, v96
    v_exp_f32 v97, v97
    v_exp_f32 v98, v98
    v_exp_f32 v99, v99
    v_exp_f32 v100, v100
    v_exp_f32 v101, v101
    v_exp_f32 v102, v102
    v_exp_f32 v103, v103
    v_pk_add_f32 v[96:97], v[96:97], 1.0 op_sel_hi:[1,0]
    v_pk_add_f32 v[98:99], v[98:99], 1.0 op_sel_hi:[1,0]
    v_pk_add_f32 v[100:101], v[100:101], 1.0 op_sel_hi:[1,0]
    v_pk_add_f32 v[102:103], v[102:103], 1.0 op_sel_hi:[1,0]
    v_rcp_f32 v96, v96
    v_rcp_f32 v97, v97
    v_rcp_f32 v98, v98
    v_rcp_f32 v99, v99
    v_rcp_f32 v100, v100
    v_rcp_f32 v101, v101
    v_rcp_f32 v102, v102
    v_rcp_f32 v103, v103
    v_pk_mul_f32 v[32:33], v[32:33], v[96:97]
    v_pk_mul_f32 v[34:35], v[34:35], v[98:99]
    v_pk_mul_f32 v[36:37], v[36:37], v[100:101]
    v_pk_mul_f32 v[38:39], v[38:39], v[102:103]
    v_cvt_pk_bf16_f32 v112, v32, v33
    v_cvt_pk_bf16_f32 v113, v34, v35
    v_cvt_pk_bf16_f32 v114, v36, v37
    v_cvt_pk_bf16_f32 v115, v38, v39
    buffer_store_dwordx4 v[112:115], v2, s[12:15], s10 offen offset:0 sc1
    s_waitcnt lgkmcnt(5)
    v_pk_add_f32 v[40:41], v[40:41], v[56:57]
    v_pk_add_f32 v[42:43], v[42:43], v[58:59]
    s_waitcnt lgkmcnt(4)
    v_pk_add_f32 v[40:41], v[40:41], v[72:73]
    v_pk_add_f32 v[42:43], v[42:43], v[74:75]
    s_waitcnt lgkmcnt(3)
    v_pk_add_f32 v[40:41], v[40:41], v[88:89]
    v_pk_add_f32 v[42:43], v[42:43], v[90:91]
    s_waitcnt lgkmcnt(2)
    v_pk_add_f32 v[44:45], v[44:45], v[60:61]
    v_pk_add_f32 v[46:47], v[46:47], v[62:63]
    s_waitcnt lgkmcnt(1)
    v_pk_add_f32 v[44:45], v[44:45], v[76:77]
    v_pk_add_f32 v[46:47], v[46:47], v[78:79]
    s_waitcnt lgkmcnt(0)
    v_pk_add_f32 v[44:45], v[44:45], v[92:93]
    v_pk_add_f32 v[46:47], v[46:47], v[94:95]
    v_pk_mul_f32 v[104:105], v[40:41], v[40:41]
    v_pk_mul_f32 v[106:107], v[42:43], v[42:43]
    v_pk_mul_f32 v[108:109], v[44:45], v[44:45]
    v_pk_mul_f32 v[110:111], v[46:47], v[46:47]
    v_pk_fma_f32 v[104:105], v[104:105], v[8:9], v[16:17] op_sel_hi:[1,0,0]
    v_pk_fma_f32 v[106:107], v[106:107], v[8:9], v[16:17] op_sel_hi:[1,0,0]
    v_pk_fma_f32 v[108:109], v[108:109], v[8:9], v[16:17] op_sel_hi:[1,0,0]
    v_pk_fma_f32 v[110:111], v[110:111], v[8:9], v[16:17] op_sel_hi:[1,0,0]
    v_pk_mul_f32 v[104:105], v[104:105], v[40:41]
    v_pk_mul_f32 v[106:107], v[106:107], v[42:43]
    v_pk_mul_f32 v[108:109], v[108:109], v[44:45]
    v_pk_mul_f32 v[110:111], v[110:111], v[46:47]
    v_exp_f32 v104, v104
    v_exp_f32 v105, v105
    v_exp_f32 v106, v106
    v_exp_f32 v107, v107
    v_exp_f32 v108, v108
    v_exp_f32 v109, v109
    v_exp_f32 v110, v110
    v_exp_f32 v111, v111
    v_pk_add_f32 v[104:105], v[104:105], 1.0 op_sel_hi:[1,0]
    v_pk_add_f32 v[106:107], v[106:107], 1.0 op_sel_hi:[1,0]
    v_pk_add_f32 v[108:109], v[108:109], 1.0 op_sel_hi:[1,0]
    v_pk_add_f32 v[110:111], v[110:111], 1.0 op_sel_hi:[1,0]
    v_rcp_f32 v104, v104
    v_rcp_f32 v105, v105
    v_rcp_f32 v106, v106
    v_rcp_f32 v107, v107
    v_rcp_f32 v108, v108
    v_rcp_f32 v109, v109
    v_rcp_f32 v110, v110
    v_rcp_f32 v111, v111
    v_pk_mul_f32 v[40:41], v[40:41], v[104:105]
    v_pk_mul_f32 v[42:43], v[42:43], v[106:107]
    v_pk_mul_f32 v[44:45], v[44:45], v[108:109]
    v_pk_mul_f32 v[46:47], v[46:47], v[110:111]
    v_cvt_pk_bf16_f32 v116, v40, v41
    v_cvt_pk_bf16_f32 v117, v42, v43
    v_cvt_pk_bf16_f32 v118, v44, v45
    v_cvt_pk_bf16_f32 v119, v46, v47
    buffer_store_dwordx4 v[116:119], v2, s[12:15], s10 offen offset:1024 sc1
    v_mov_b32 v8, s44
    v_mov_b32 v9, s45
    s_cmp_lg_u32 s40, 0
    s_barrier
    s_cbranch_scc1 L_nosig_22
    s_mov_b64 exec, 15
    buffer_atomic_swap_x2 v[8:9], v254, s[12:15], s48 offen sc1
    s_mov_b64 exec, -1
L_nosig_22:
L_join5:
    s_add_u32 s55, s55, 16384
    s_mov_b64 exec, 127
    v_mov_b32 v8, 0
    v_mov_b32 v9, 0
    buffer_atomic_or_x2 v[8:9], v255, s[12:15], s55 offen sc0 sc1
    s_mov_b64 exec, -1
    s_add_u32 m0, s92, 73728
    s_add_u32 s100, s100, 65536
    buffer_load_dwordx4 v250, s[24:27], s100 offen lds
    buffer_load_dwordx4 v251, s[24:27], s100 offen offset:1024 lds
    s_add_u32 m0, s92, 81920
    s_add_u32 s100, s100, 65536
    buffer_load_dwordx4 v250, s[24:27], s100 offen lds
    buffer_load_dwordx4 v251, s[24:27], s100 offen offset:1024 lds
    s_add_u32 m0, s92, 90112
    s_add_u32 s100, s100, 65536
    buffer_load_dwordx4 v250, s[24:27], s100 offen lds
    buffer_load_dwordx4 v251, s[24:27], s100 offen offset:1024 lds
    s_add_u32 m0, s92, 98304
    s_add_u32 s100, s100, 65536
    s_cmp_eq_u32 s100, s3
    s_cselect_b32 s100, s101, s100
    buffer_load_dwordx4 v250, s[24:27], s100 offen lds
    buffer_load_dwordx4 v251, s[24:27], s100 offen offset:1024 lds
    s_add_u32 m0, s92, 0
    s_add_u32 s100, s100, 65536
    buffer_load_dwordx4 v250, s[24:27], s100 offen lds
    buffer_load_dwordx4 v251, s[24:27], s100 offen offset:1024 lds
    s_add_u32 m0, s92, 8192
    s_add_u32 s100, s100, 65536
    buffer_load_dwordx4 v250, s[24:27], s100 offen lds
    buffer_load_dwordx4 v251, s[24:27], s100 offen offset:1024 lds
    s_add_u32 m0, s92, 106496
    s_add_u32 s100, s100, 65536
    buffer_load_dwordx4 v250, s[24:27], s100 offen lds
    buffer_load_dwordx4 v251, s[24:27], s100 offen offset:1024 lds
    s_lshl2_add_u32 s51, s43, s40
    s_mul_i32 s51, s51, 57344
    s_add_u32 s51, s51, 12582912
    s_add_u32 s52, s51, 57344
    s_lshl_b32 s50, s99, 13
    s_add_u32 s50, s50, s51
    s_and_b32 s46, s40, 1
    v_lshl_add_u32 v3, s46, 11, v2
    v_xor_b32 v4, 2048, v3
    s_mov_b64 exec, 127
    s_waitcnt vmcnt(14)
    v_cmp_ne_u64 vcc, s[44:45], v[8:9]
    s_mov_b32 s49, 0
    s_cbranch_vccz L_seen_25
L_poll_23:
    v_mov_b32 v8, 0
    v_mov_b32 v9, 0
    buffer_atomic_or_x2 v[8:9], v255, s[12:15], s55 offen sc0 sc1
    s_add_u32 s49, s49, 1
    s_waitcnt vmcnt(0)
    v_cmp_ne_u64 vcc, s[44:45], v[8:9]
    s_nop 0
    s_cbranch_vccz L_seen_25
    s_cmp_lt_u32 s49, 131072
    s_cbranch_scc1 L_poll_23
L_seen_25:
    s_mov_b64 exec, -1
L_loop5:
    buffer_load_dwordx4 v[96:99], v3, s[12:15], s50 offen offset:0 sc1
    buffer_load_dwordx4 v[100:103], v3, s[12:15], s50 offen offset:1024 sc1
    buffer_load_dwordx4 v[104:107], v4, s[12:15], s50 offen offset:0 sc1
    buffer_load_dwordx4 v[108:111], v4, s[12:15], s50 offen offset:1024 sc1
    s_add_u32 s50, s50, 4096
    buffer_load_dwordx4 v[112:115], v3, s[12:15], s50 offen offset:0 sc1
    buffer_load_dwordx4 v[116:119], v3, s[12:15], s50 offen offset:1024 sc1
    buffer_load_dwordx4 v[120:123], v4, s[12:15], s50 offen offset:0 sc1
    buffer_load_dwordx4 v[124:127], v4, s[12:15], s50 offen offset:1024 sc1
    s_add_u32 s50, s50, 4096
    s_cmp_eq_u32 s50, s52
    s_cselect_b32 s50, s51, s50
    buffer_load_dwordx4 v[128:131], v3, s[12:15], s50 offen offset:0 sc1
    buffer_load_dwordx4 v[132:135], v3, s[12:15], s50 offen offset:1024 sc1
    s_waitcnt vmcnt(9)
    v_mfma_f32_16x16x32_bf16 v[32:35], v[96:99], a[0:3], v[200:203]
    ds_read_b64_tr_b16 a[112:113], v252 offset:16384
    s_waitcnt vmcnt(8)
    v_mfma_f32_16x16x32_bf16 v[36:39], v[100:103], a[0:3], v[204:207]
    buffer_load_dwordx4 v[136:139], v4, s[12:15], s50 offen offset:0 sc1
    v_mfma_f32_16x16x32_bf16 v[44:47], v[100:103], a[4:7], v[212:215]
    ds_read_b64_tr_b16 a[116:117], v244 offset:16384
    v_mfma_f32_16x16x32_bf16 v[40:43], v[96:99], a[4:7], v[208:211]
    buffer_load_dwordx4 v[140:143], v4, s[12:15], s50 offen offset:1024 sc1
    v_mfma_f32_16x16x32_bf16 v[64:67], v[96:99], a[8:11], 0
    ds_read_b64_tr_b16 a[120:121], v252 offset:16896
    v_mfma_f32_16x16x32_bf16 v[68:71], v[100:103], a[8:11], 0
    v_max3_u32 v11, v96, v100, 0
    v_mfma_f32_16x16x32_bf16 v[76:79], v[100:103], a[12:15], 0
    ds_read_b64_tr_b16 a[124:125], v244 offset:16896
    v_mfma_f32_16x16x32_bf16 v[72:75], v[96:99], a[12:15], 0
    s_waitcnt vmcnt(9)
    v_mfma_f32_16x16x32_bf16 v[48:51], v[104:107], a[0:3], 0
    s_add_u32 s50, s50, 4096
    ds_read_b64_tr_b16 a[114:115], v252 offset:24576
    s_waitcnt vmcnt(8)
    v_mfma_f32_16x16x32_bf16 v[52:55], v[108:111], a[0:3], 0
    buffer_load_dwordx4 v[96:99], v3, s[12:15], s50 offen offset:0 sc1
    v_mfma_f32_16x16x32_bf16 v[60:63], v[108:111], a[4:7], 0
    ds_read_b64_tr_b16 a[118:119], v244 offset:24576
    v_mfma_f32_16x16x32_bf16 v[56:59], v[104:107], a[4:7], 0
    buffer_load_dwordx4 v[100:103], v3, s[12:15], s50 offen offset:1024 sc1
    v_mfma_f32_16x16x32_bf16 v[80:83], v[104:107], a[8:11], 0
    ds_read_b64_tr_b16 a[122:123], v252 offset:25088
    v_mfma_f32_16x16x32_bf16 v[84:87], v[108:111], a[8:11], 0
    v_max3_u32 v11, v104, v108, v11
    v_mfma_f32_16x16x32_bf16 v[92:95], v[108:111], a[12:15], 0
    ds_read_b64_tr_b16 a[126:127], v244 offset:25088
    v_mfma_f32_16x16x32_bf16 v[88:91], v[104:107], a[12:15], 0
    s_waitcnt vmcnt(9)
    v_mfma_f32_16x16x32_bf16 v[32:35], v[112:115], a[16:19], v[32:35]
    ds_read_b64_tr_b16 a[128:129], v252 offset:32768
    s_waitcnt vmcnt(8)
    v_mfma_f32_16x16x32_bf16 v[36:39], v[116:119], a[16:19], v[36:39]
    buffer_load_dwordx4 v[104:107], v4, s[12:15], s50 offen offset:0 sc1
    v_mfma_f32_16x16x32_bf16 v[44:47], v[116:119], a[20:23], v[44:47]
    ds_read_b64_tr_b16 a[132:133], v244 offset:32768
    v_mfma_f32_16x16x32_bf16 v[40:43], v[112:115], a[20:23], v[40:43]
    buffer_load_dwordx4 v[108:111], v4, s[12:15], s50 offen offset:1024 sc1
    v_mfma_f32_16x16x32_bf16 v[64:67], v[112:115], a[24:27], v[64:67]
    ds_read_b64_tr_b16 a[136:137], v252 offset:33280
    v_mfma_f32_16x16x32_bf16 v[68:71], v[116:119], a[24:27], v[68:71]
    v_max3_u32 v11, v112, v116, v11
    v_mfma_f32_16x16x32_bf16 v[76:79], v[116:119], a[28:31], v[76:79]
    ds_read_b64_tr_b16 a[140:141], v244 offset:33280
    v_mfma_f32_16x16x32_bf16 v[72:75], v[112:115], a[28:31], v[72:75]
    s_waitcnt vmcnt(9)
    v_mfma_f32_16x16x32_bf16 v[48:51], v[120:123], a[16:19], v[48:51]
    s_add_u32 s50, s50, 4096
    s_cmp_eq_u32 s50, s52
    s_cselect_b32 s50, s51, s50
    ds_read_b64_tr_b16 a[130:131], v252 offset:40960
    s_waitcnt vmcnt(8)
    v_mfma_f32_16x16x32_bf16 v[52:55], v[124:127], a[16:19], v[52:55]
    buffer_load_dwordx4 v[112:115], v3, s[12:15], s50 offen offset:0 sc1
    v_mfma_f32_16x16x32_bf16 v[60:63], v[124:127], a[20:23], v[60:63]
    ds_read_b64_tr_b16 a[134:135], v244 offset:40960
    v_mfma_f32_16x16x32_bf16 v[56:59], v[120:123], a[20:23], v[56:59]
    buffer_load_dwordx4 v[116:119], v3, s[12:15], s50 offen offset:1024 sc1
    v_mfma_f32_16x16x32_bf16 v[80:83], v[120:123], a[24:27], v[80:83]
    ds_read_b64_tr_b16 a[138:139], v252 offset:41472
    v_mfma_f32_16x16x32_bf16 v[84:87], v[124:127], a[24:27], v[84:87]
    v_max3_u32 v11, v120, v124, v11
    v_mfma_f32_16x16x32_bf16 v[92:95], v[124:127], a[28:31], v[92:95]
    ds_read_b64_tr_b16 a[142:143], v244 offset:41472
    v_mfma_f32_16x16x32_bf16 v[88:91], v[120:123], a[28:31], v[88:91]
    s_waitcnt vmcnt(9)
    v_mfma_f32_16x16x32_bf16 v[32:35], v[128:131], a[32:35], v[32:35]
    ds_read_b64_tr_b16 a[144:145], v252 offset:49152
    s_waitcnt vmcnt(8)
    v_mfma_f32_16x16x32_bf16 v[36:39], v[132:135], a[32:35], v[36:39]
    buffer_load_dwordx4 v[120:123], v4, s[12:15], s50 offen offset:0 sc1
    v_mfma_f32_16x16x32_bf16 v[44:47], v[132:135], a[36:39], v[44:47]
    ds_read_b64_tr_b16 a[148:149], v244 offset:49152
    v_mfma_f32_16x16x32_bf16 v[40:43], v[128:131], a[36:39], v[40:43]
    buffer_load_dwordx4 v[124:127], v4, s[12:15], s50 offen offset:1024 sc1
    v_mfma_f32_16x16x32_bf16 v[64:67], v[128:131], a[40:43], v[64:67]
    ds_read_b64_tr_b16 a[152:153], v252 offset:49664
    v_mfma_f32_16x16x32_bf16 v[68:71], v[132:135], a[40:43], v[68:71]
    v_max3_u32 v11, v128, v132, v11
    v_mfma_f32_16x16x32_bf16 v[76:79], v[132:135], a[44:47], v[76:79]
    ds_read_b64_tr_b16 a[156:157], v244 offset:49664
    v_mfma_f32_16x16x32_bf16 v[72:75], v[128:131], a[44:47], v[72:75]
    s_waitcnt vmcnt(9)
    v_mfma_f32_16x16x32_bf16 v[48:51], v[136:139], a[32:35], v[48:51]
    s_add_u32 s50, s50, 4096
    ds_read_b64_tr_b16 a[146:147], v253 offset:0
    s_waitcnt vmcnt(8)
    v_mfma_f32_16x16x32_bf16 v[52:55], v[140:143], a[32:35], v[52:55]
    buffer_load_dwordx4 v[128:131], v3, s[12:15], s50 offen offset:0 sc1
    v_mfma_f32_16x16x32_bf16 v[60:63], v[140:143], a[36:39], v[60:63]
    ds_read_b64_tr_b16 a[150:151], v245 offset:0
    v_mfma_f32_16x16x32_bf16 v[56:59], v[136:139], a[36:39], v[56:59]
    buffer_load_dwordx4 v[132:135], v3, s[12:15], s50 offen offset:1024 sc1
    v_mfma_f32_16x16x32_bf16 v[80:83], v[136:139], a[40:43], v[80:83]
    ds_read_b64_tr_b16 a[154:155], v253 offset:512
    v_mfma_f32_16x16x32_bf16 v[84:87], v[140:143], a[40:43], v[84:87]
    v_max3_u32 v11, v136, v140, v11
    v_mfma_f32_16x16x32_bf16 v[92:95], v[140:143], a[44:47], v[92:95]
    ds_read_b64_tr_b16 a[158:159], v245 offset:512
    v_mfma_f32_16x16x32_bf16 v[88:91], v[136:139], a[44:47], v[88:91]
    s_waitcnt vmcnt(9)
    v_mfma_f32_16x16x32_bf16 v[32:35], v[96:99], a[48:51], v[32:35]
    ds_read_b64_tr_b16 a[160:161], v253 offset:8192
    s_waitcnt vmcnt(8)
    v_mfma_f32_16x16x32_bf16 v[36:39], v[100:103], a[48:51], v[36:39]
    buffer_load_dwordx4 v[136:139], v4, s[12:15], s50 offen offset:0 sc1
    v_mfma_f32_16x16x32_bf16 v[44:47], v[100:103], a[52:55], v[44:47]
    ds_read_b64_tr_b16 a[164:165], v245 offset:8192
    v_mfma_f32_16x16x32_bf16 v[40:43], v[96:99], a[52:55], v[40:43]
    buffer_load_dwordx4 v[140:143], v4, s[12:15], s50 offen offset:1024 sc1
    v_mfma_f32_16x16x32_bf16 v[64:67], v[96:99], a[56:59], v[64:67]
    ds_read_b64_tr_b16 a[168:169], v253 offset:8704
    v_mfma_f32_16x16x32_bf16 v[68:71], v[100:103], a[56:59], v[68:71]
    v_max3_u32 v11, v96, v100, v11
    v_mfma_f32_16x16x32_bf16 v[76:79], v[100:103], a[60:63], v[76:79]
    ds_read_b64_tr_b16 a[172:173], v245 offset:8704
    v_mfma_f32_16x16x32_bf16 v[72:75], v[96:99], a[60:63], v[72:75]
    s_waitcnt vmcnt(9)
    v_mfma_f32_16x16x32_bf16 v[48:51], v[104:107], a[48:51], v[48:51]
    s_add_u32 s50, s50, 4096
    s_cmp_eq_u32 s50, s52
    s_cselect_b32 s50, s51, s50
    ds_read_b64_tr_b16 a[162:163], v253 offset:16384
    s_waitcnt vmcnt(8)
    v_mfma_f32_16x16x32_bf16 v[52:55], v[108:111], a[48:51], v[52:55]
    buffer_load_dwordx4 v[96:99], v3, s[12:15], s50 offen offset:0 sc1
    v_mfma_f32_16x16x32_bf16 v[60:63], v[108:111], a[52:55], v[60:63]
    ds_read_b64_tr_b16 a[166:167], v245 offset:16384
    v_mfma_f32_16x16x32_bf16 v[56:59], v[104:107], a[52:55], v[56:59]
    buffer_load_dwordx4 v[100:103], v3, s[12:15], s50 offen offset:1024 sc1
    v_mfma_f32_16x16x32_bf16 v[80:83], v[104:107], a[56:59], v[80:83]
    ds_read_b64_tr_b16 a[170:171], v253 offset:16896
    v_mfma_f32_16x16x32_bf16 v[84:87], v[108:111], a[56:59], v[84:87]
    v_max3_u32 v11, v104, v108, v11
    v_mfma_f32_16x16x32_bf16 v[92:95], v[108:111], a[60:63], v[92:95]
    ds_read_b64_tr_b16 a[174:175], v245 offset:16896
    v_mfma_f32_16x16x32_bf16 v[88:91], v[104:107], a[60:63], v[88:91]
    s_waitcnt vmcnt(9)
    v_mfma_f32_16x16x32_bf16 v[32:35], v[112:115], a[64:67], v[32:35]
    ds_read_b64_tr_b16 a[176:177], v253 offset:24576
    s_waitcnt vmcnt(8)
    v_mfma_f32_16x16x32_bf16 v[36:39], v[116:119], a[64:67], v[36:39]
    buffer_load_dwordx4 v[104:107], v4, s[12:15], s50 offen offset:0 sc1
    v_mfma_f32_16x16x32_bf16 v[44:47], v[116:119], a[68:71], v[44:47]
    ds_read_b64_tr_b16 a[180:181], v245 offset:24576
    v_mfma_f32_16x16x32_bf16 v[40:43], v[112:115], a[68:71], v[40:43]
    buffer_load_dwordx4 v[108:111], v4, s[12:15], s50 offen offset:1024 sc1
    v_mfma_f32_16x16x32_bf16 v[64:67], v[112:115], a[72:75], v[64:67]
    ds_read_b64_tr_b16 a[184:185], v253 offset:25088
    v_mfma_f32_16x16x32_bf16 v[68:71], v[116:119], a[72:75], v[68:71]
    v_max3_u32 v11, v112, v116, v11
    v_mfma_f32_16x16x32_bf16 v[76:79], v[116:119], a[76:79], v[76:79]
    ds_read_b64_tr_b16 a[188:189], v245 offset:25088
    v_mfma_f32_16x16x32_bf16 v[72:75], v[112:115], a[76:79], v[72:75]
    s_waitcnt vmcnt(9)
    v_mfma_f32_16x16x32_bf16 v[48:51], v[120:123], a[64:67], v[48:51]
    s_add_u32 s50, s50, 4096
    ds_read_b64_tr_b16 a[178:179], v253 offset:32768
    s_waitcnt vmcnt(8)
    v_mfma_f32_16x16x32_bf16 v[52:55], v[124:127], a[64:67], v[52:55]
    buffer_load_dwordx4 v[112:115], v3, s[12:15], s50 offen offset:0 sc1
    v_mfma_f32_16x16x32_bf16 v[60:63], v[124:127], a[68:71], v[60:63]
    ds_read_b64_tr_b16 a[182:183], v245 offset:32768
    v_mfma_f32_16x16x32_bf16 v[56:59], v[120:123], a[68:71], v[56:59]
    buffer_load_dwordx4 v[116:119], v3, s[12:15], s50 offen offset:1024 sc1
    v_mfma_f32_16x16x32_bf16 v[80:83], v[120:123], a[72:75], v[80:83]
    ds_read_b64_tr_b16 a[186:187], v253 offset:33280
    v_mfma_f32_16x16x32_bf16 v[84:87], v[124:127], a[72:75], v[84:87]
    v_max3_u32 v11, v120, v124, v11
    v_mfma_f32_16x16x32_bf16 v[92:95], v[124:127], a[76:79], v[92:95]
    ds_read_b64_tr_b16 a[190:191], v245 offset:33280
    v_mfma_f32_16x16x32_bf16 v[88:91], v[120:123], a[76:79], v[88:91]
    s_waitcnt vmcnt(9)
    v_mfma_f32_16x16x32_bf16 v[32:35], v[128:131], a[80:83], v[32:35]
    ds_read_b64_tr_b16 a[192:193], v253 offset:40960
    s_waitcnt vmcnt(8)
    v_mfma_f32_16x16x32_bf16 v[36:39], v[132:135], a[80:83], v[36:39]
    buffer_load_dwordx4 v[120:123], v4, s[12:15], s50 offen offset:0 sc1
    v_mfma_f32_16x16x32_bf16 v[44:47], v[132:135], a[84:87], v[44:47]
    ds_read_b64_tr_b16 a[196:197], v245 offset:40960
    v_mfma_f32_16x16x32_bf16 v[40:43], v[128:131], a[84:87], v[40:43]
    buffer_load_dwordx4 v[124:127], v4, s[12:15], s50 offen offset:1024 sc1
    v_mfma_f32_16x16x32_bf16 v[64:67], v[128:131], a[88:91], v[64:67]
    ds_read_b64_tr_b16 a[200:201], v253 offset:41472
    v_mfma_f32_16x16x32_bf16 v[68:71], v[132:135], a[88:91], v[68:71]
    v_max3_u32 v11, v128, v132, v11
    v_mfma_f32_16x16x32_bf16 v[76:79], v[132:135], a[92:95], v[76:79]
    ds_read_b64_tr_b16 a[204:205], v245 offset:41472
    v_mfma_f32_16x16x32_bf16 v[72:75], v[128:131], a[92:95], v[72:75]
    s_waitcnt vmcnt(9)
    v_mfma_f32_16x16x32_bf16 v[48:51], v[136:139], a[80:83], v[48:51]
    s_add_u32 s50, s50, 4096
    s_cmp_eq_u32 s50, s52
    s_cselect_b32 s50, s51, s50
    ds_read_b64_tr_b16 a[194:195], v252 offset:0
    s_waitcnt vmcnt(8)
    v_mfma_f32_16x16x32_bf16 v[52:55], v[140:143], a[80:83], v[52:55]
L_pad_8:
    s_cbranch_execz L_pad_ret
    buffer_load_dwordx4 v[128:131], v3, s[12:15], s50 offen offset:0 sc1
    v_mfma_f32_16x16x32_bf16 v[60:63], v[140:143], a[84:87], v[60:63]
    ds_read_b64_tr_b16 a[198:199], v244 offset:0
    v_mfma_f32_16x16x32_bf16 v[56:59], v[136:139], a[84:87], v[56:59]
    buffer_load_dwordx4 v[132:135], v3, s[12:15], s50 offen offset:1024 sc1
    v_mfma_f32_16x16x32_bf16 v[80:83], v[136:139], a[88:91], v[80:83]
    ds_read_b64_tr_b16 a[202:203], v252 offset:512
    v_mfma_f32_16x16x32_bf16 v[84:87], v[140:143], a[88:91], v[84:87]
    v_max3_u32 v11, v136, v140, v11
    v_mfma_f32_16x16x32_bf16 v[92:95], v[140:143], a[92:95], v[92:95]
    ds_read_b64_tr_b16 a[206:207], v244 offset:512
    v_mfma_f32_16x16x32_bf16 v[88:91], v[136:139], a[92:95], v[88:91]
    s_waitcnt vmcnt(9)
    v_mfma_f32_16x16x32_bf16 v[32:35], v[96:99], a[96:99], v[32:35]
    ds_read_b64_tr_b16 a[208:209], v252 offset:8192
    s_waitcnt vmcnt(8)
    v_mfma_f32_16x16x32_bf16 v[36:39], v[100:103], a[96:99], v[36:39]
    buffer_load_dwordx4 v[136:139], v4, s[12:15], s50 offen offset:0 sc1
    v_mfma_f32_16x16x32_bf16 v[44:47], v[100:103], a[100:103], v[44:47]
    ds_read_b64_tr_b16 a[212:213], v244 offset:8192
    v_mfma_f32_16x16x32_bf16 v[40:43], v[96:99], a[100:103], v[40:43]
    buffer_load_dwordx4 v[140:143], v4, s[12:15], s50 offen offset:1024 sc1
    v_mfma_f32_16x16x32_bf16 v[64:67], v[96:99], a[104:107], v[64:67]
    ds_read_b64_tr_b16 a[216:217], v252 offset:8704
    v_mfma_f32_16x16x32_bf16 v[68:71], v[100:103], a[104:107], v[68:71]
    v_max3_u32 v11, v96, v100, v11
    v_mfma_f32_16x16x32_bf16 v[76:79], v[100:103], a[108:111], v[76:79]
    ds_read_b64_tr_b16 a[220:221], v244 offset:8704
    v_mfma_f32_16x16x32_bf16 v[72:75], v[96:99], a[108:111], v[72:75]
    s_waitcnt vmcnt(9)
    v_mfma_f32_16x16x32_bf16 v[48:51], v[104:107], a[96:99], v[48:51]
    s_add_u32 s50, s50, 4096
    ds_read_b64_tr_b16 a[210:211], v253 offset:49152
    s_waitcnt vmcnt(8)
    v_mfma_f32_16x16x32_bf16 v[52:55], v[108:111], a[96:99], v[52:55]
    buffer_load_dwordx4 v[96:99], v3, s[12:15], s50 offen offset:0 sc1
    v_mfma_f32_16x16x32_bf16 v[60:63], v[108:111], a[100:103], v[60:63]
    ds_read_b64_tr_b16 a[214:215], v245 offset:49152
    v_mfma_f32_16x16x32_bf16 v[56:59], v[104:107], a[100:103], v[56:59]
    buffer_load_dwordx4 v[100:103], v3, s[12:15], s50 offen offset:1024 sc1
    v_mfma_f32_16x16x32_bf16 v[80:83], v[104:107], a[104:107], v[80:83]
    ds_read_b64_tr_b16 a[218:219], v253 offset:49664
    v_mfma_f32_16x16x32_bf16 v[84:87], v[108:111], a[104:107], v[84:87]
    v_max3_u32 v11, v104, v108, v11
    v_mfma_f32_16x16x32_bf16 v[92:95], v[108:111], a[108:111], v[92:95]
    ds_read_b64_tr_b16 a[222:223], v245 offset:49664
    v_mfma_f32_16x16x32_bf16 v[88:91], v[104:107], a[108:111], v[88:91]
    s_waitcnt vmcnt(9) lgkmcnt(14)
    v_mfma_f32_16x16x32_bf16 v[32:35], v[112:115], a[112:115], v[32:35]
    s_waitcnt vmcnt(8)
    v_mfma_f32_16x16x32_bf16 v[36:39], v[116:119], a[112:115], v[36:39]
    buffer_load_dwordx4 v[104:107], v4, s[12:15], s50 offen offset:0 sc1
    v_mfma_f32_16x16x32_bf16 v[44:47], v[116:119], a[116:119], v[44:47]
    v_mfma_f32_16x16x32_bf16 v[40:43], v[112:115], a[116:119], v[40:43]
    buffer_load_dwordx4 v[108:111], v4, s[12:15], s50 offen offset:1024 sc1
    v_mfma_f32_16x16x32_bf16 v[64:67], v[112:115], a[120:123], v[64:67]
    v_mfma_f32_16x16x32_bf16 v[68:71], v[116:119], a[120:123], v[68:71]
    v_max3_u32 v11, v112, v116, v11
    v_mfma_f32_16x16x32_bf16 v[76:79], v[116:119], a[124:127], v[76:79]
    v_mfma_f32_16x16x32_bf16 v[72:75], v[112:115], a[124:127], v[72:75]
    s_waitcnt vmcnt(9)
    v_mfma_f32_16x16x32_bf16 v[48:51], v[120:123], a[112:115], v[48:51]
    s_add_u32 s50, s50, 4096
    s_cmp_eq_u32 s50, s52
    s_cselect_b32 s50, s51, s50
    s_waitcnt vmcnt(8)
    v_mfma_f32_16x16x32_bf16 v[52:55], v[124:127], a[112:115], v[52:55]
    buffer_load_dwordx4 v[112:115], v3, s[12:15], s50 offen offset:0 sc1
    v_mfma_f32_16x16x32_bf16 v[60:63], v[124:127], a[116:119], v[60:63]
    v_mfma_f32_16x16x32_bf16 v[56:59], v[120:123], a[116:119], v[56:59]
    buffer_load_dwordx4 v[116:119], v3, s[12:15], s50 offen offset:1024 sc1
    v_mfma_f32_16x16x32_bf16 v[80:83], v[120:123], a[120:123], v[80:83]
    v_mfma_f32_16x16x32_bf16 v[84:87], v[124:127], a[120:123], v[84:87]
    v_max3_u32 v11, v120, v124, v11
    v_mfma_f32_16x16x32_bf16 v[92:95], v[124:127], a[124:127], v[92:95]
    v_mfma_f32_16x16x32_bf16 v[88:91], v[120:123], a[124:127], v[88:91]
    s_waitcnt vmcnt(9)
    v_mfma_f32_16x16x32_bf16 v[32:35], v[128:131], a[128:131], v[32:35]
    s_waitcnt vmcnt(8)
    v_mfma_f32_16x16x32_bf16 v[36:39], v[132:135], a[128:131], v[36:39]
    buffer_load_dwordx4 v[120:123], v4, s[12:15], s50 offen offset:0 sc1
    v_mfma_f32_16x16x32_bf16 v[44:47], v[132:135], a[132:135], v[44:47]
    v_mfma_f32_16x16x32_bf16 v[40:43], v[128:131], a[132:135], v[40:43]
    buffer_load_dwordx4 v[124:127], v4, s[12:15], s50 offen offset:1024 sc1
    v_mfma_f32_16x16x32_bf16 v[64:67], v[128:131], a[136:139], v[64:67]
    v_mfma_f32_16x16x32_bf16 v[68:71], v[132:135], a[136:139], v[68:71]
    v_max3_u32 v11, v128, v132, v11
    v_mfma_f32_16x16x32_bf16 v[76:79], v[132:135], a[140:143], v[76:79]
    v_mfma_f32_16x16x32_bf16 v[72:75], v[128:131], a[140:143], v[72:75]
    s_waitcnt vmcnt(9)
    v_mfma_f32_16x16x32_bf16 v[48:51], v[136:139], a[128:131], v[48:51]
    s_add_u32 s50, s50, 4096
    s_waitcnt vmcnt(8)
    v_mfma_f32_16x16x32_bf16 v[52:55], v[140:143], a[128:131], v[52:55]
    buffer_load_dwordx4 v[128:131], v3, s[12:15], s50 offen offset:0 sc1
    v_mfma_f32_16x16x32_bf16 v[60:63], v[140:143], a[132:135], v[60:63]
    v_mfma_f32_16x16x32_bf16 v[56:59], v[136:139], a[132:135], v[56:59]
    buffer_load_dwordx4 v[132:135], v3, s[12:15], s50 offen offset:1024 sc1
    v_mfma_f32_16x16x32_bf16 v[80:83], v[136:139], a[136:139], v[80:83]
    v_mfma_f32_16x16x32_bf16 v[84:87], v[140:143], a[136:139], v[84:87]
    v_max3_u32 v11, v136, v140, v11
    v_mfma_f32_16x16x32_bf16 v[92:95], v[140:143], a[140:143], v[92:95]
    v_mfma_f32_16x16x32_bf16 v[88:91], v[136:139], a[140:143], v[88:91]
    s_waitcnt vmcnt(9)
    v_mfma_f32_16x16x32_bf16 v[32:35], v[96:99], a[144:147], v[32:35]
    s_waitcnt vmcnt(8)
    v_mfma_f32_16x16x32_bf16 v[36:39], v[100:103], a[144:147], v[36:39]
    buffer_load_dwordx4 v[136:139], v4, s[12:15], s50 offen offset:0 sc1
    v_mfma_f32_16x16x32_bf16 v[44:47], v[100:103], a[148:151], v[44:47]
    v_mfma_f32_16x16x32_bf16 v[40:43], v[96:99], a[148:151], v[40:43]
    buffer_load_dwordx4 v[140:143], v4, s[12:15], s50 offen offset:1024 sc1
    v_mfma_f32_16x16x32_bf16 v[64:67], v[96:99], a[152:155], v[64:67]
    v_mfma_f32_16x16x32_bf16 v[68:71], v[100:103], a[152:155], v[68:71]
    v_max3_u32 v11, v96, v100, v11
    v_mfma_f32_16x16x32_bf16 v[76:79], v[100:103], a[156:159], v[76:79]
    v_mfma_f32_16x16x32_bf16 v[72:75], v[96:99], a[156:159], v[72:75]
    s_waitcnt vmcnt(9)
    v_mfma_f32_16x16x32_bf16 v[48:51], v[104:107], a[144:147], v[48:51]
    s_add_u32 s50, s50, 4096
    s_cmp_eq_u32 s50, s52
    s_cselect_b32 s50, s51, s50
    s_waitcnt vmcnt(8)
    v_mfma_f32_16x16x32_bf16 v[52:55], v[108:111], a[144:147], v[52:55]
    buffer_load_dwordx4 v[96:99], v3, s[12:15], s50 offen offset:0 sc1
    v_mfma_f32_16x16x32_bf16 v[60:63], v[108:111], a[148:151], v[60:63]
    v_mfma_f32_16x16x32_bf16 v[56:59], v[104:107], a[148:151], v[56:59]
    buffer_load_dwordx4 v[100:103], v3, s[12:15], s50 offen offset:1024 sc1
    v_mfma_f32_16x16x32_bf16 v[80:83], v[104:107], a[152:155], v[80:83]
    v_mfma_f32_16x16x32_bf16 v[84:87], v[108:111], a[152:155], v[84:87]
    v_max3_u32 v11, v104, v108, v11
    v_mfma_f32_16x16x32_bf16 v[92:95], v[108:111], a[156:159], v[92:95]
    v_mfma_f32_16x16x32_bf16 v[88:91], v[104:107], a[156:159], v[88:91]
    s_waitcnt vmcnt(9)
    v_mfma_f32_16x16x32_bf16 v[32:35], v[112:115], a[160:163], v[32:35]
    s_waitcnt vmcnt(8)
    v_mfma_f32_16x16x32_bf16 v[36:39], v[116:119], a[160:163], v[36:39]
    buffer_load_dwordx4 v[104:107], v4, s[12:15], s50 offen offset:0 sc1
    v_mfma_f32_16x16x32_bf16 v[44:47], v[116:119], a[164:167], v[44:47]
    v_mfma_f32_16x16x32_bf16 v[40:43], v[112:115], a[164:167], v[40:43]
    buffer_load_dwordx4 v[108:111], v4, s[12:15], s50 offen offset:1024 sc1
    v_mfma_f32_16x16x32_bf16 v[64:67], v[112:115], a[168:171], v[64:67]
    v_mfma_f32_16x16x32_bf16 v[68:71], v[116:119], a[168:171], v[68:71]
    v_max3_u32 v11, v112, v116, v11
    v_mfma_f32_16x16x32_bf16 v[76:79], v[116:119], a[172:175], v[76:79]
    v_mfma_f32_16x16x32_bf16 v[72:75], v[112:115], a[172:175], v[72:75]
    s_waitcnt vmcnt(9)
    v_mfma_f32_16x16x32_bf16 v[48:51], v[120:123], a[160:163], v[48:51]
    s_add_u32 s50, s50, 4096
    s_waitcnt vmcnt(8)
    v_mfma_f32_16x16x32_bf16 v[52:55], v[124:127], a[160:163], v[52:55]
    buffer_load_dwordx4 v[112:115], v3, s[12:15], s50 offen offset:0 sc1
    v_mfma_f32_16x16x32_bf16 v[60:63], v[124:127], a[164:167], v[60:63]
    v_mfma_f32_16x16x32_bf16 v[56:59], v[120:123], a[164:167], v[56:59]
    buffer_load_dwordx4 v[116:119], v3, s[12:15], s50 offen offset:1024 sc1
    v_mfma_f32_16x16x32_bf16 v[80:83], v[120:123], a[168:171], v[80:83]
    v_mfma_f32_16x16x32_bf16 v[84:87], v[124:127], a[168:171], v[84:87]
    v_max3_u32 v11, v120, v124, v11
    v_mfma_f32_16x16x32_bf16 v[92:95], v[124:127], a[172:175], v[92:95]
    v_mfma_f32_16x16x32_bf16 v[88:91], v[120:123], a[172:175], v[88:91]
    s_waitcnt vmcnt(9)
    v_mfma_f32_16x16x32_bf16 v[32:35], v[128:131], a[176:179], v[32:35]
    s_waitcnt vmcnt(8)
    v_mfma_f32_16x16x32_bf16 v[36:39], v[132:135], a[176:179], v[36:39]
    buffer_load_dwordx4 v[120:123], v4, s[12:15], s50 offen offset:0 sc1
    v_mfma_f32_16x16x32_bf16 v[44:47], v[132:135], a[180:183], v[44:47]
    v_mfma_f32_16x16x32_bf16 v[40:43], v[128:131], a[180:183], v[40:43]
    buffer_load_dwordx4 v[124:127], v4, s[12:15], s50 offen offset:1024 sc1
    v_mfma_f32_16x16x32_bf16 v[64:67], v[128:131], a[184:187], v[64:67]
    v_mfma_f32_16x16x32_bf16 v[68:71], v[132:135], a[184:187], v[68:71]
    v_max3_u32 v11, v128, v132, v11
    v_mfma_f32_16x16x32_bf16 v[76:79], v[132:135], a[188:191], v[76:79]
    v_mfma_f32_16x16x32_bf16 v[72:75], v[128:131], a[188:191], v[72:75]
    s_waitcnt vmcnt(9)
    v_mfma_f32_16x16x32_bf16 v[48:51], v[136:139], a[176:179], v[48:51]
    s_waitcnt vmcnt(8)
    v_mfma_f32_16x16x32_bf16 v[52:55], v[140:143], a[176:179], v[52:55]
    v_mfma_f32_16x16x32_bf16 v[60:63], v[140:143], a[180:183], v[60:63]
    v_mfma_f32_16x16x32_bf16 v[56:59], v[136:139], a[180:183], v[56:59]
    v_mfma_f32_16x16x32_bf16 v[80:83], v[136:139], a[184:187], v[80:83]
    v_mfma_f32_16x16x32_bf16 v[84:87], v[140:143], a[184:187], v[84:87]
    v_max3_u32 v11, v136, v140, v11
    v_mfma_f32_16x16x32_bf16 v[92:95], v[140:143], a[188:191], v[92:95]
    v_mfma_f32_16x16x32_bf16 v[88:91], v[136:139], a[188:191], v[88:91]
    s_waitcnt vmcnt(7) lgkmcnt(9)
    v_mfma_f32_16x16x32_bf16 v[64:67], v[96:99], a[200:203], v[64:67]
    s_waitcnt vmcnt(6)
    v_mfma_f32_16x16x32_bf16 v[68:71], v[100:103], a[200:203], v[68:71]
    s_waitcnt lgkmcnt(8)
    v_mfma_f32_16x16x32_bf16 v[76:79], v[100:103], a[204:207], v[76:79]
    v_max3_u32 v11, v96, v100, v11
    v_mfma_f32_16x16x32_bf16 v[72:75], v[96:99], a[204:207], v[72:75]
    s_waitcnt vmcnt(3) lgkmcnt(1)
    v_mfma_f32_16x16x32_bf16 v[64:67], v[112:115], a[216:219], v[64:67]
    s_waitcnt vmcnt(2)
    v_mfma_f32_16x16x32_bf16 v[68:71], v[116:119], a[216:219], v[68:71]
    s_waitcnt lgkmcnt(0)
    v_mfma_f32_16x16x32_bf16 v[76:79], v[116:119], a[220:223], v[76:79]
    v_max3_u32 v11, v112, v116, v11
    v_mfma_f32_16x16x32_bf16 v[72:75], v[112:115], a[220:223], v[72:75]
    v_mfma_f32_16x16x32_bf16 v[48:51], v[104:107], a[192:195], v[48:51]
    v_mfma_f32_16x16x32_bf16 v[52:55], v[108:111], a[192:195], v[52:55]
    ds_write_b128 v13, v[64:67] offset:4096
    v_mfma_f32_16x16x32_bf16 v[60:63], v[108:111], a[196:199], v[60:63]
    v_max3_u32 v11, v104, v108, v11
    v_mfma_f32_16x16x32_bf16 v[56:59], v[104:107], a[196:199], v[56:59]
    ds_write_b128 v13, v[68:71] offset:5120
    s_waitcnt vmcnt(1)
    v_mfma_f32_16x16x32_bf16 v[48:51], v[120:123], a[208:211], v[48:51]
    s_waitcnt vmcnt(0)
    v_mfma_f32_16x16x32_bf16 v[52:55], v[124:127], a[208:211], v[52:55]
    ds_write_b128 v13, v[76:79] offset:7168
    v_mfma_f32_16x16x32_bf16 v[60:63], v[124:127], a[212:215], v[60:63]
    v_max3_u32 v11, v120, v124, v11
    v_mfma_f32_16x16x32_bf16 v[56:59], v[120:123], a[212:215], v[56:59]
    ds_write_b128 v13, v[72:75] offset:6144
    v_mfma_f32_16x16x32_bf16 v[80:83], v[104:107], a[200:203], v[80:83]
    v_mfma_f32_16x16x32_bf16 v[84:87], v[108:111], a[200:203], v[84:87]
    ds_write_b128 v12, v[48:51] offset:0
    v_mfma_f32_16x16x32_bf16 v[92:95], v[108:111], a[204:207], v[92:95]
    v_mfma_f32_16x16x32_bf16 v[88:91], v[104:107], a[204:207], v[88:91]
    ds_write_b128 v12, v[52:55] offset:1024
    v_mfma_f32_16x16x32_bf16 v[80:83], v[120:123], a[216:219], v[80:83]
    v_mfma_f32_16x16x32_bf16 v[84:87], v[124:127], a[216:219], v[84:87]
    ds_write_b128 v12, v[60:63] offset:3072
    v_mfma_f32_16x16x32_bf16 v[92:95], v[124:127], a[220:223], v[92:95]
    v_cmp_eq_u32 vcc, -1, v11
    v_mfma_f32_16x16x32_bf16 v[88:91], v[120:123], a[220:223], v[88:91]
    ds_write_b128 v12, v[56:59] offset:2048
    v_mfma_f32_16x16x32_bf16 v[32:35], v[96:99], a[192:195], v[32:35]
    v_mfma_f32_16x16x32_bf16 v[36:39], v[100:103], a[192:195], v[36:39]
    ds_write_b128 v14, v[80:83] offset:8192
    v_mfma_f32_16x16x32_bf16 v[44:47], v[100:103], a[196:199], v[44:47]
    v_mfma_f32_16x16x32_bf16 v[40:43], v[96:99], a[196:199], v[40:43]
    ds_write_b128 v14, v[84:87] offset:9216
    v_mfma_f32_16x16x32_bf16 v[32:35], v[112:115], a[208:211], v[32:35]
    v_mfma_f32_16x16x32_bf16 v[36:39], v[116:119], a[208:211], v[36:39]
    ds_write_b128 v14, v[92:95] offset:11264
    v_mfma_f32_16x16x32_bf16 v[44:47], v[116:119], a[212:215], v[44:47]
    v_mfma_f32_16x16x32_bf16 v[40:43], v[112:115], a[212:215], v[40:43]
    ds_write_b128 v14, v[88:91] offset:10240
    s_cbranch_vccnz L_redo5
L_done5:
    s_lshl2_add_u32 s46, s97, s40
    s_lshl_b32 s46, s46, 14
    s_lshl_b32 s47, s43, 7
    s_add_u32 s46, s46, s47
    s_lshr_b32 s47, s40, 1
    s_lshl_b32 s47, s47, 12
    s_add_u32 s47, s47, 49152
    s_and_b32 s48, s40, 1
    s_lshl_b32 s48, s48, 2
    v_and_b32 v8, 7, v1
    v_xor_b32 v9, s48, v8
    v_xor_b32 v9, v9, v7
    v_lshlrev_b32 v9, 4, v9
    v_and_b32 v10, 15, v1
    v_lshl_add_u32 v9, v10, 7, v9
    v_bfe_u32 v10, v1, 4, 1
    v_lshl_add_u32 v9, v10, 3, v9
    v_add_u32 v5, s47, v9
    v_xor_b32 v6, 32, v5
    v_lshrrev_b32 v10, 3, v1
    v_xor_b32 v11, v8, v10
    v_lshlrev_b32 v11, 4, v11
    v_lshl_add_u32 v11, v10, 7, v11
    s_lshl_b32 s47, s40, 11
    s_add_u32 s47, s47, 49152
    v_add_u32 v9, s47, v11
    v_lshlrev_b32 v8, 4, v8
    v_lshl_add_u32 v10, v10, 10, v8
    s_add_u32 s47, s46, 8192
    s_waitcnt lgkmcnt(0)
    s_barrier
    ds_read_b128 v[48:51], v15 offset:0
    ds_read_b128 v[64:67], v15 offset:4096
    ds_read_b128 v[80:83], v15 offset:8192
    ds_read_b128 v[52:55], v15 offset:1024
    ds_read_b128 v[68:71], v15 offset:5120
    ds_read_b128 v[84:87], v15 offset:9216
    ds_read_b128 v[56:59], v15 offset:2048
    ds_read_b128 v[72:75], v15 offset:6144
    ds_read_b128 v[88:91], v15 offset:10240
    ds_read_b128 v[60:63], v15 offset:3072
    ds_read_b128 v[76:79], v15 offset:7168
    ds_read_b128 v[92:95], v15 offset:11264
    s_waitcnt lgkmcnt(11)
    v_pk_add_f32 v[32:33], v[32:33], v[48:49]
    v_pk_add_f32 v[34:35], v[34:35], v[50:51]
    s_waitcnt lgkmcnt(10)
    v_pk_add_f32 v[32:33], v[32:33], v[64:65]
    v_pk_add_f32 v[34:35], v[34:35], v[66:67]
    s_waitcnt lgkmcnt(9)
    v_pk_add_f32 v[32:33], v[32:33], v[80:81]
    v_pk_add_f32 v[34:35], v[34:35], v[82:83]
    s_waitcnt lgkmcnt(8)
    v_pk_add_f32 v[36:37], v[36:37], v[52:53]
    v_pk_add_f32 v[38:39], v[38:39], v[54:55]
    s_waitcnt lgkmcnt(7)
    v_pk_add_f32 v[36:37], v[36:37], v[68:69]
    v_pk_add_f32 v[38:39], v[38:39], v[70:71]
    s_waitcnt lgkmcnt(6)
    v_pk_add_f32 v[36:37], v[36:37], v[84:85]
    v_pk_add_f32 v[38:39], v[38:39], v[86:87]
    v_cvt_pk_bf16_f32 v96, v32, v33
    v_cvt_pk_bf16_f32 v97, v34, v35
    v_cvt_pk_bf16_f32 v98, v36, v37
    v_cvt_pk_bf16_f32 v99, v38, v39
    ds_write_b64 v5, v[96:97] offset:0
    ds_write_b64 v6, v[98:99] offset:0
    s_waitcnt lgkmcnt(7)
    v_pk_add_f32 v[40:41], v[40:41], v[56:57]
    v_pk_add_f32 v[42:43], v[42:43], v[58:59]
    s_waitcnt lgkmcnt(6)
    v_pk_add_f32 v[40:41], v[40:41], v[72:73]
    v_pk_add_f32 v[42:43], v[42:43], v[74:75]
    s_waitcnt lgkmcnt(5)
    v_pk_add_f32 v[40:41], v[40:41], v[88:89]
    v_pk_add_f32 v[42:43], v[42:43], v[90:91]
    s_waitcnt lgkmcnt(4)
    v_pk_add_f32 v[44:45], v[44:45], v[60:61]
    v_pk_add_f32 v[46:47], v[46:47], v[62:63]
    s_waitcnt lgkmcnt(3)
    v_pk_add_f32 v[44:45], v[44:45], v[76:77]
    v_pk_add_f32 v[46:47], v[46:47], v[78:79]
    s_waitcnt lgkmcnt(2)
    v_pk_add_f32 v[44:45], v[44:45], v[92:93]
    v_pk_add_f32 v[46:47], v[46:47], v[94:95]
    v_cvt_pk_bf16_f32 v100, v40, v41
    v_cvt_pk_bf16_f32 v101, v42, v43
    v_cvt_pk_bf16_f32 v102, v44, v45
    v_cvt_pk_bf16_f32 v103, v46, v47
    ds_write_b64 v5, v[100:101] offset:2048
    ds_write_b64 v6, v[102:103] offset:2048
    s_waitcnt lgkmcnt(0)
    s_barrier
    ds_read_b128 v[104:107], v9
    ds_read_b128 v[108:111], v9 offset:1024
    s_waitcnt lgkmcnt(1)
    buffer_store_dwordx4 v[104:107], v10, s[36:39], s46 offen sc1
    s_waitcnt lgkmcnt(0)
    buffer_store_dwordx4 v[108:111], v10, s[36:39], s47 offen sc1
L_end:
    s_endpgm
L_attn_slow:
    s_mov_b32 s55, 1
    s_lshl_b32 s46, s50, 16
    s_add_u32 s46, s46, 2097152
    s_add_u32 s47, s46, 65536
    v_mov_b32 v29, 0xff800000
    v_mov_b32 v30, 0xff800000
L_again_6:
    buffer_load_dwordx4 v[4:7], v2, s[12:15], s61 offen sc1
    buffer_load_dwordx4 v[8:11], v2, s[12:15], s61 offen offset:1024 sc1
    s_waitcnt vmcnt(0)
    v_max_u32 v31, v4, v8
    v_cmp_eq_u32 vcc, -1, v31
    s_nop 0
    s_cbranch_vccz L_valid_7
    s_sub_u32 s11, s11, 1
    s_cbranch_scc0 L_again_6
    s_mov_b32 s11, 0
L_valid_7:
L_attn_max:
L_again_8:
    buffer_load_dwordx4 v[20:23], v2, s[12:15], s46 offen sc1
    s_waitcnt vmcnt(0)
    v_max_u32 v31, v20, v20
    v_cmp_eq_u32 vcc, -1, v31
    s_nop 0
    s_cbranch_vccz L_valid_9
    s_sub_u32 s11, s11, 1
    s_cbranch_scc0 L_again_8
    s_mov_b32 s11, 0
L_valid_9:
    v_mfma_f32_32x32x16_bf16 v[76:91], v[20:23], v[4:7], 0
    v_mfma_f32_32x32x16_bf16 v[92:107], v[20:23], v[8:11], 0
    s_nop 10
    v_max3_f32 v29, v76, v77, v29
    v_max3_f32 v29, v78, v79, v29
    v_max3_f32 v29, v80, v81, v29
    v_max3_f32 v29, v82, v83, v29
    v_max3_f32 v29, v84, v85, v29
    v_max3_f32 v29, v86, v87, v29
    v_max3_f32 v29, v88, v89, v29
    v_max3_f32 v29, v90, v91, v29
    v_max3_f32 v30, v92, v93, v30
    v_max3_f32 v30, v94, v95, v30
    v_max3_f32 v30, v96, v97, v30
    v_max3_f32 v30, v98, v99, v30
    v_max3_f32 v30, v100, v101, v30
    v_max3_f32 v30, v102, v103, v30
    v_max3_f32 v30, v104, v105, v30
    v_max3_f32 v30, v106, v107, v30
    s_add_u32 s46, s46, 1024
    s_cmp_lt_u32 s46, s47
    s_cbranch_scc1 L_attn_max
    v_mov_b32 v31, v29
    v_mov_b32 v32, v30
    s_nop 0
    v_permlane32_swap_b32 v31, v29
    v_permlane32_swap_b32 v32, v30
    v_max_f32 v29, v29, v31
    v_max_f32 v30, v30, v32
    v_sub_f32 v108, 0, v29
    v_sub_f32 v109, 0, v29
    v_sub_f32 v110, 0, v29
    v_sub_f32 v111, 0, v29
    v_sub_f32 v112, 0, v29
    v_sub_f32 v113, 0, v29
    v_sub_f32 v114, 0, v29
    v_sub_f32 v115, 0, v29
    v_sub_f32 v116, 0, v29
    v_sub_f32 v117, 0, v29
    v_sub_f32 v118, 0, v29
    v_sub_f32 v119, 0, v29
    v_sub_f32 v120, 0, v29
    v_sub_f32 v121, 0, v29
    v_sub_f32 v122, 0, v29
    v_sub_f32 v123, 0, v29
    v_sub_f32 v124, 0, v30
    v_sub_f32 v125, 0, v30
    v_sub_f32 v126, 0, v30
    v_sub_f32 v127, 0, v30
    v_sub_f32 v128, 0, v30
    v_sub_f32 v129, 0, v30
    v_sub_f32 v130, 0, v30
    v_sub_f32 v131, 0, v30
    v_sub_f32 v132, 0, v30
    v_sub_f32 v133, 0, v30
    v_sub_f32 v134, 0, v30
    v_sub_f32 v135, 0, v30
    v_sub_f32 v136, 0, v30
    v_sub_f32 v137, 0, v30
    v_sub_f32 v138, 0, v30
    v_sub_f32 v139, 0, v30
    v_mov_b32 v44, 0
    v_mov_b32 v45, 0
    v_mov_b32 v46, 0
    v_mov_b32 v47, 0
    v_mov_b32 v48, 0
    v_mov_b32 v49, 0
    v_mov_b32 v50, 0
    v_mov_b32 v51, 0
    v_mov_b32 v52, 0
    v_mov_b32 v53, 0
    v_mov_b32 v54, 0
    v_mov_b32 v55, 0
    v_mov_b32 v56, 0
    v_mov_b32 v57, 0
    v_mov_b32 v58, 0
    v_mov_b32 v59, 0
    v_mov_b32 v60, 0
    v_mov_b32 v61, 0
    v_mov_b32 v62, 0
    v_mov_b32 v63, 0
    v_mov_b32 v64, 0
    v_mov_b32 v65, 0
    v_mov_b32 v66, 0
    v_mov_b32 v67, 0
    v_mov_b32 v68, 0
    v_mov_b32 v69, 0
    v_mov_b32 v70, 0
    v_mov_b32 v71, 0
    v_mov_b32 v72, 0
    v_mov_b32 v73, 0
    v_mov_b32 v74, 0
    v_mov_b32 v75, 0
    v_mov_b32 v28, 0x3f803f80
    v_mov_b32 v36, 0x3f803f80
    v_mov_b32 v29, 0x3f803f80
    v_mov_b32 v37, 0x3f803f80
    v_mov_b32 v30, 0x3f803f80
    v_mov_b32 v38, 0x3f803f80
    v_mov_b32 v31, 0x3f803f80
    v_mov_b32 v39, 0x3f803f80
    v_and_b32 v12, 15, v1
    v_lshlrev_b32 v12, 4, v12
    v_lshrrev_b32 v13, 5, v1
    v_lshl_add_u32 v12, v13, 8, v12
    v_add_u32 v12, 2097152, v12
    s_sub_u32 s46, s46, 65536
    s_mov_b32 s62, 0xffff
    s_mov_b32 s63, 0xffff
L_attn_redo:
    buffer_load_dwordx4 v[20:23], v2, s[12:15], s46 offen sc1
L_again_10:
    s_mov_b64 exec, s[62:63]
    buffer_load_dwordx4 v[28:31], v12, s[12:15], s46 offen sc1
    buffer_load_dwordx4 v[36:39], v12, s[12:15], s46 offen offset:512 sc1
    s_mov_b64 exec, -1
    s_waitcnt vmcnt(0)
    v_max_u32 v24, v28, v36
    v_cmp_eq_u32 vcc, -1, v24
    s_nop 0
    s_cbranch_vccz L_valid_11
    s_sub_u32 s11, s11, 1
    s_cbranch_scc0 L_again_10
    s_mov_b32 s11, 0
L_valid_11:
    v_mfma_f32_32x32x16_bf16 v[76:91], v[20:23], v[4:7], v[108:123]
    v_mfma_f32_32x32x16_bf16 v[92:107], v[20:23], v[8:11], v[124:139]
    s_nop 10
    v_exp_f32 v76, v76
    v_exp_f32 v77, v77
    v_exp_f32 v78, v78
    v_exp_f32 v79, v79
    v_exp_f32 v80, v80
    v_exp_f32 v81, v81
    v_exp_f32 v82, v82
    v_exp_f32 v83, v83
    v_exp_f32 v84, v84
    v_exp_f32 v85, v85
    v_exp_f32 v86, v86
    v_exp_f32 v87, v87
    v_exp_f32 v88, v88
    v_exp_f32 v89, v89
    v_exp_f32 v90, v90
    v_exp_f32 v91, v91
    v_smfmac_f32_32x32x32_bf16 v[44:59], v[28:31], v[76:83], v3
    s_nop 0
    v_smfmac_f32_32x32x32_bf16 v[44:59], v[36:39], v[84:91], v3
    v_exp_f32 v92, v92
    v_exp_f32 v93, v93
    v_exp_f32 v94, v94
    v_exp_f32 v95, v95
    v_exp_f32 v96, v96
    v_exp_f32 v97, v97
    v_exp_f32 v98, v98
    v_exp_f32 v99, v99
    v_exp_f32 v100, v100
    v_exp_f32 v101, v101
    v_exp_f32 v102, v102
    v_exp_f32 v103, v103
    v_exp_f32 v104, v104
    v_exp_f32 v105, v105
    v_exp_f32 v106, v106
    v_exp_f32 v107, v107
    v_smfmac_f32_32x32x32_bf16 v[60:75], v[28:31], v[92:99], v3
    s_nop 0
    v_smfmac_f32_32x32x32_bf16 v[60:75], v[36:39], v[100:107], v3
    s_add_u32 s46, s46, 1024
    s_cmp_lt_u32 s46, s47
    s_cbranch_scc1 L_attn_redo
    s_branch L_attn_check
L_wo_redo:
    s_lshl_b32 s52, s54, 15
    s_add_u32 s52, s52, 6291456
    s_add_u32 s53, s52, 32768
    s_and_b32 s63, s41, 0
    s_lshl_b32 s63, s63, 14
    v_mov_b32 v48, v80
    v_mov_b32 v49, v81
    v_mov_b32 v50, v82
    v_mov_b32 v51, v83
    v_mov_b32 v52, v84
    v_mov_b32 v53, v85
    v_mov_b32 v54, v86
    v_mov_b32 v55, v87
    v_mov_b32 v56, v88
    v_mov_b32 v57, v89
    v_mov_b32 v58, v90
    v_mov_b32 v59, v91
    v_mov_b32 v60, v92
    v_mov_b32 v61, v93
    v_mov_b32 v62, v94
    v_mov_b32 v63, v95
L_wo_step:
    s_xor_b32 s62, s52, s63
L_again_15:
    buffer_load_dwordx4 v[16:19], v2, s[12:15], s62 offen sc1
    s_waitcnt vmcnt(0)
    v_max_u32 v20, v16, v16
    v_cmp_eq_u32 vcc, -1, v20
    s_nop 0
    s_cbranch_vccz L_valid_16
    s_sub_u32 s11, s11, 1
    s_cbranch_scc0 L_again_15
    s_mov_b32 s11, 0
L_valid_16:
    ds_read_b64_tr_b16 v[96:97], v4
    ds_read_b64_tr_b16 v[98:99], v4 offset:1024
    v_add_u32 v4, 2048, v4
    s_waitcnt lgkmcnt(0)
    v_mfma_f32_32x32x16_bf16 v[48:63], v[96:99], v[16:19], v[48:63]
    s_add_u32 s52, s52, 1024
    s_cmp_lt_u32 s52, s53
    s_cbranch_scc1 L_wo_step
    s_mov_b64 vcc, 0
    s_nop 11
    s_branch L_wo_done
L_redo4:
    s_sub_u32 s11, s11, 64
    s_cselect_b32 s11, 0, s11
    s_cbranch_scc1 L_done4
    s_waitcnt vmcnt(0) lgkmcnt(0)
    s_nop 7
    v_bfe_u32 v96, v1, 2, 3
    v_mul_u32_u24 v96, 3584, v96
    v_lshrrev_b32 v98, 5, v1
    v_lshrrev_b32 v97, 7, v0
    v_xor_b32 v97, v97, v98
    v_lshl_add_u32 v96, v97, 6, v96
    v_lshlrev_b32 v98, 10, v98
    v_and_b32 v97, 3, v1
    v_lshl_add_u32 v96, v97, 4, v96
    v_lshl_add_u32 v98, v97, 3, v98
    v_bfe_u32 v97, v1, 2, 2
    v_lshl_add_u32 v98, v97, 6, v98
    v_and_b32 v97, 16, v1
    v_mad_u32_u24 v98, v97, 18, v98
    v_lshlrev_b32 v97, 1, v97
    v_xor_b32 v96, v96, v97
    v_add_u32 v97, 27648, v96
    s_mul_i32 s93, s98, 229376
    s_add_u32 s93, s93, s94
    s_add_u32 m0, s92, 16384
    s_nop 0
    buffer_load_dwordx4 v96, s[20:23], s93 offen lds
    buffer_load_dwordx4 v97, s[20:23], s93 offen offset:1024 lds
    s_add_u32 s93, s93, 57344
    s_cmp_eq_u32 s93, s95
    s_cselect_b32 s93, s94, s93
    s_add_u32 m0, s92, 24576
    s_nop 0
    buffer_load_dwordx4 v96, s[20:23], s93 offen lds
    buffer_load_dwordx4 v97, s[20:23], s93 offen offset:1024 lds
    s_add_u32 s93, s93, 57344
    s_cmp_eq_u32 s93, s95
    s_cselect_b32 s93, s94, s93
    s_add_u32 m0, s92, 32768
    s_nop 0
    buffer_load_dwordx4 v96, s[20:23], s93 offen lds
    buffer_load_dwordx4 v97, s[20:23], s93 offen offset:1024 lds
    s_add_u32 s93, s93, 57344
    s_cmp_eq_u32 s93, s95
    s_cselect_b32 s93, s94, s93
    s_add_u32 m0, s92, 40960
    s_nop 0
    buffer_load_dwordx4 v96, s[20:23], s93 offen lds
    buffer_load_dwordx4 v97, s[20:23], s93 offen offset:1024 lds
    s_add_u32 s93, s93, 57344
    s_cmp_eq_u32 s93, s95
    s_cselect_b32 s93, s94, s93
    s_add_u32 m0, s92, 49152
    s_nop 0
    buffer_load_dwordx4 v96, s[20:23], s93 offen lds
    buffer_load_dwordx4 v97, s[20:23], s93 offen offset:1024 lds
    s_add_u32 s93, s93, 57344
    s_cmp_eq_u32 s93, s95
    s_cselect_b32 s93, s94, s93
    s_add_u32 m0, s92, 57344
    s_nop 0
    buffer_load_dwordx4 v96, s[20:23], s93 offen lds
    buffer_load_dwordx4 v97, s[20:23], s93 offen offset:1024 lds
    s_add_u32 s93, s93, 57344
    s_cmp_eq_u32 s93, s95
    s_cselect_b32 s93, s94, s93
    s_add_u32 m0, s92, 65536
    s_nop 0
    buffer_load_dwordx4 v96, s[20:23], s93 offen lds
    buffer_load_dwordx4 v97, s[20:23], s93 offen offset:1024 lds
    s_add_u32 s93, s93, 57344
    s_cmp_eq_u32 s93, s95
    s_cselect_b32 s93, s94, s93
    s_add_u32 m0, s92, 73728
    s_nop 0
    buffer_load_dwordx4 v96, s[20:23], s93 offen lds
    buffer_load_dwordx4 v97, s[20:23], s93 offen offset:1024 lds
    s_add_u32 s93, s93, 57344
    s_cmp_eq_u32 s93, s95
    s_cselect_b32 s93, s94, s93
    s_add_u32 m0, s92, 81920
    s_nop 0
    buffer_load_dwordx4 v96, s[20:23], s93 offen lds
    buffer_load_dwordx4 v97, s[20:23], s93 offen offset:1024 lds
    s_add_u32 s93, s93, 57344
    s_cmp_eq_u32 s93, s95
    s_cselect_b32 s93, s94, s93
    s_add_u32 m0, s92, 90112
    s_nop 0
    buffer_load_dwordx4 v96, s[20:23], s93 offen lds
    buffer_load_dwordx4 v97, s[20:23], s93 offen offset:1024 lds
    s_add_u32 s93, s93, 57344
    s_cmp_eq_u32 s93, s95
    s_cselect_b32 s93, s94, s93
    s_add_u32 m0, s92, 98304
    s_nop 0
    buffer_load_dwordx4 v96, s[20:23], s93 offen lds
    buffer_load_dwordx4 v97, s[20:23], s93 offen offset:1024 lds
    s_add_u32 s93, s93, 57344
    s_cmp_eq_u32 s93, s95
    s_cselect_b32 s93, s94, s93
    s_add_u32 m0, s92, 0
    s_nop 0
    buffer_load_dwordx4 v96, s[20:23], s93 offen lds
    buffer_load_dwordx4 v97, s[20:23], s93 offen offset:1024 lds
    s_add_u32 s93, s93, 57344
    s_cmp_eq_u32 s93, s95
    s_cselect_b32 s93, s94, s93
    s_add_u32 m0, s92, 8192
    s_nop 0
    buffer_load_dwordx4 v96, s[20:23], s93 offen lds
    buffer_load_dwordx4 v97, s[20:23], s93 offen offset:1024 lds
    s_add_u32 s93, s93, 57344
    s_cmp_eq_u32 s93, s95
    s_cselect_b32 s93, s94, s93
    s_add_u32 m0, s92, 106496
    s_nop 0
    buffer_load_dwordx4 v96, s[20:23], s93 offen lds
    buffer_load_dwordx4 v97, s[20:23], s93 offen offset:1024 lds
    s_waitcnt vmcnt(26)
    ds_read_b64_tr_b16 a[0:1], v252 offset:16384
    ds_read_b64_tr_b16 a[4:5], v244 offset:16384
    ds_read_b64_tr_b16 a[8:9], v252 offset:16896
    ds_read_b64_tr_b16 a[12:13], v244 offset:16896
    s_waitcnt vmcnt(24)
    ds_read_b64_tr_b16 a[2:3], v252 offset:24576
    ds_read_b64_tr_b16 a[6:7], v244 offset:24576
    ds_read_b64_tr_b16 a[10:11], v252 offset:25088
    ds_read_b64_tr_b16 a[14:15], v244 offset:25088
    s_waitcnt vmcnt(22)
    ds_read_b64_tr_b16 a[16:17], v252 offset:32768
    ds_read_b64_tr_b16 a[20:21], v244 offset:32768
    ds_read_b64_tr_b16 a[24:25], v252 offset:33280
    ds_read_b64_tr_b16 a[28:29], v244 offset:33280
    s_waitcnt vmcnt(20)
    ds_read_b64_tr_b16 a[18:19], v252 offset:40960
    ds_read_b64_tr_b16 a[22:23], v244 offset:40960
    ds_read_b64_tr_b16 a[26:27], v252 offset:41472
    ds_read_b64_tr_b16 a[30:31], v244 offset:41472
    s_waitcnt vmcnt(18)
    ds_read_b64_tr_b16 a[32:33], v252 offset:49152
    ds_read_b64_tr_b16 a[36:37], v244 offset:49152
    ds_read_b64_tr_b16 a[40:41], v252 offset:49664
    ds_read_b64_tr_b16 a[44:45], v244 offset:49664
    s_waitcnt vmcnt(16)
    ds_read_b64_tr_b16 a[34:35], v253 offset:0
    ds_read_b64_tr_b16 a[38:39], v245 offset:0
    ds_read_b64_tr_b16 a[42:43], v253 offset:512
    ds_read_b64_tr_b16 a[46:47], v245 offset:512
    s_waitcnt vmcnt(14)
    ds_read_b64_tr_b16 a[48:49], v253 offset:8192
    ds_read_b64_tr_b16 a[52:53], v245 offset:8192
    ds_read_b64_tr_b16 a[56:57], v253 offset:8704
    ds_read_b64_tr_b16 a[60:61], v245 offset:8704
    s_waitcnt vmcnt(12)
    ds_read_b64_tr_b16 a[50:51], v253 offset:16384
    ds_read_b64_tr_b16 a[54:55], v245 offset:16384
    ds_read_b64_tr_b16 a[58:59], v253 offset:16896
    ds_read_b64_tr_b16 a[62:63], v245 offset:16896
    s_waitcnt vmcnt(10)
    ds_read_b64_tr_b16 a[64:65], v253 offset:24576
    ds_read_b64_tr_b16 a[68:69], v245 offset:24576
    ds_read_b64_tr_b16 a[72:73], v253 offset:25088
    ds_read_b64_tr_b16 a[76:77], v245 offset:25088
    s_waitcnt vmcnt(8)
    ds_read_b64_tr_b16 a[66:67], v253 offset:32768
    ds_read_b64_tr_b16 a[70:71], v245 offset:32768
    ds_read_b64_tr_b16 a[74:75], v253 offset:33280
    ds_read_b64_tr_b16 a[78:79], v245 offset:33280
    s_waitcnt vmcnt(6)
    ds_read_b64_tr_b16 a[80:81], v253 offset:40960
    ds_read_b64_tr_b16 a[84:85], v245 offset:40960
    ds_read_b64_tr_b16 a[88:89], v253 offset:41472
    ds_read_b64_tr_b16 a[92:93], v245 offset:41472
    s_waitcnt vmcnt(4)
    ds_read_b64_tr_b16 a[82:83], v252 offset:0
    ds_read_b64_tr_b16 a[86:87], v244 offset:0
    ds_read_b64_tr_b16 a[90:91], v252 offset:512
    ds_read_b64_tr_b16 a[94:95], v244 offset:512
    s_waitcnt vmcnt(2)
    ds_read_b64_tr_b16 a[96:97], v252 offset:8192
    ds_read_b64_tr_b16 a[100:101], v244 offset:8192
    ds_read_b64_tr_b16 a[104:105], v252 offset:8704
    ds_read_b64_tr_b16 a[108:109], v244 offset:8704
    s_waitcnt vmcnt(0)
    ds_read_b64_tr_b16 a[98:99], v253 offset:49152
    ds_read_b64_tr_b16 a[102:103], v245 offset:49152
    ds_read_b64_tr_b16 a[106:107], v253 offset:49664
    ds_read_b64_tr_b16 a[110:111], v245 offset:49664
    s_mul_i32 s100, s99, 262144
    s_add_u32 s100, s100, s101
    s_waitcnt lgkmcnt(0)
    s_add_u32 m0, s92, 16384
    s_nop 0
    buffer_load_dwordx4 v250, s[24:27], s100 offen lds
    buffer_load_dwordx4 v251, s[24:27], s100 offen offset:1024 lds
    s_add_u32 m0, s92, 24576
    s_add_u32 s100, s100, 65536
    buffer_load_dwordx4 v250, s[24:27], s100 offen lds
    buffer_load_dwordx4 v251, s[24:27], s100 offen offset:1024 lds
    s_add_u32 m0, s92, 32768
    s_add_u32 s100, s100, 65536
    buffer_load_dwordx4 v250, s[24:27], s100 offen lds
    buffer_load_dwordx4 v251, s[24:27], s100 offen offset:1024 lds
    s_add_u32 m0, s92, 40960
    s_add_u32 s100, s100, 65536
    buffer_load_dwordx4 v250, s[24:27], s100 offen lds
    buffer_load_dwordx4 v251, s[24:27], s100 offen offset:1024 lds
    s_add_u32 m0, s92, 49152
    s_add_u32 s100, s100, 65536
    s_cmp_eq_u32 s100, s3
    s_cselect_b32 s100, s101, s100
    buffer_load_dwordx4 v250, s[24:27], s100 offen lds
    buffer_load_dwordx4 v251, s[24:27], s100 offen offset:1024 lds
    s_add_u32 m0, s92, 57344
    s_add_u32 s100, s100, 65536
    buffer_load_dwordx4 v250, s[24:27], s100 offen lds
    buffer_load_dwordx4 v251, s[24:27], s100 offen offset:1024 lds
    s_add_u32 m0, s92, 65536
    s_add_u32 s100, s100, 65536
    buffer_load_dwordx4 v250, s[24:27], s100 offen lds
    buffer_load_dwordx4 v251, s[24:27], s100 offen offset:1024 lds
    s_add_u32 m0, s92, 73728
    s_add_u32 s100, s100, 65536
    buffer_load_dwordx4 v250, s[24:27], s100 offen lds
    buffer_load_dwordx4 v251, s[24:27], s100 offen offset:1024 lds
    s_add_u32 m0, s92, 81920
    s_add_u32 s100, s100, 65536
    s_cmp_eq_u32 s100, s3
    s_cselect_b32 s100, s101, s100
    buffer_load_dwordx4 v250, s[24:27], s100 offen lds
    buffer_load_dwordx4 v251, s[24:27], s100 offen offset:1024 lds
    s_add_u32 m0, s92, 90112
    s_add_u32 s100, s100, 65536
    buffer_load_dwordx4 v250, s[24:27], s100 offen lds
    buffer_load_dwordx4 v251, s[24:27], s100 offen offset:1024 lds
    s_add_u32 m0, s92, 98304
    s_add_u32 s100, s100, 65536
    buffer_load_dwordx4 v250, s[24:27], s100 offen lds
    buffer_load_dwordx4 v251, s[24:27], s100 offen offset:1024 lds
    s_add_u32 m0, s92, 0
    s_add_u32 s100, s100, 65536
    buffer_load_dwordx4 v250, s[24:27], s100 offen lds
    buffer_load_dwordx4 v251, s[24:27], s100 offen offset:1024 lds
    s_add_u32 m0, s92, 8192
    s_add_u32 s100, s100, 65536
    s_cmp_eq_u32 s100, s3
    s_cselect_b32 s100, s101, s100
    buffer_load_dwordx4 v250, s[24:27], s100 offen lds
    buffer_load_dwordx4 v251, s[24:27], s100 offen offset:1024 lds
    s_add_u32 m0, s92, 106496
    s_add_u32 s100, s100, 65536
    buffer_load_dwordx4 v250, s[24:27], s100 offen lds
    buffer_load_dwordx4 v251, s[24:27], s100 offen offset:1024 lds
    s_waitcnt vmcnt(0)
    s_lshl_b32 s50, s98, 13
    s_add_u32 s50, s50, s51
    s_branch L_loop4
L_idle4:
    s_add_u32 m0, s92, 81920
    s_add_u32 s100, s100, 65536
    s_cmp_eq_u32 s100, s3
    s_cselect_b32 s100, s101, s100
    buffer_load_dwordx4 v250, s[24:27], s100 offen lds
    buffer_load_dwordx4 v251, s[24:27], s100 offen offset:1024 lds
    s_add_u32 m0, s92, 90112
    s_add_u32 s100, s100, 65536
    buffer_load_dwordx4 v250, s[24:27], s100 offen lds
    buffer_load_dwordx4 v251, s[24:27], s100 offen offset:1024 lds
    s_add_u32 m0, s92, 98304
    s_add_u32 s100, s100, 65536
    buffer_load_dwordx4 v250, s[24:27], s100 offen lds
    buffer_load_dwordx4 v251, s[24:27], s100 offen offset:1024 lds
    s_add_u32 m0, s92, 0
    s_add_u32 s100, s100, 65536
    buffer_load_dwordx4 v250, s[24:27], s100 offen lds
    buffer_load_dwordx4 v251, s[24:27], s100 offen offset:1024 lds
    s_add_u32 m0, s92, 8192
    s_add_u32 s100, s100, 65536
    s_cmp_eq_u32 s100, s3
    s_cselect_b32 s100, s101, s100
    buffer_load_dwordx4 v250, s[24:27], s100 offen lds
    buffer_load_dwordx4 v251, s[24:27], s100 offen offset:1024 lds
    s_add_u32 m0, s92, 106496
    s_add_u32 s100, s100, 65536
    buffer_load_dwordx4 v250, s[24:27], s100 offen lds
    buffer_load_dwordx4 v251, s[24:27], s100 offen offset:1024 lds
    s_lshl2_add_u32 s51, s43, s40
    s_mul_i32 s51, s51, 65536
    s_add_u32 s51, s51, 10485760
    s_add_u32 s52, s51, 65536
    s_lshl_b32 s50, s98, 13
    s_add_u32 s50, s50, s51
    s_and_b32 s46, s40, 1
    v_lshl_add_u32 v3, s46, 11, v2
    v_xor_b32 v4, 2048, v3
    s_and_b32 s46, s40, 1
    s_lshl1_add_u32 s54, s43, s46
    v_lshlrev_b32 v16, 16, v240
    v_and_b32 v17, 0xffff0000, v240
    v_lshlrev_b32 v18, 16, v241
    v_and_b32 v19, 0xffff0000, v241
    v_lshlrev_b32 v20, 16, v242
    v_and_b32 v21, 0xffff0000, v242
    v_lshlrev_b32 v22, 16, v243
    v_and_b32 v23, 0xffff0000, v243
    s_xor_b32 s46, s40, 1
    s_mul_i32 s46, s46, 12288
    v_add_u32 v12, s46, v2
    s_xor_b32 s46, s40, 2
    s_mul_i32 s46, s46, 12288
    v_add_u32 v13, s46, v2
    s_xor_b32 s46, s40, 3
    s_mul_i32 s46, s46, 12288
    v_add_u32 v14, s46, v2
    s_mul_i32 s46, s40, 12288
    v_add_u32 v15, s46, v2
    ds_read_b64_tr_b16 a[0:1], v252 offset:16384
    ds_read_b64_tr_b16 a[4:5], v244 offset:16384
    ds_read_b64_tr_b16 a[8:9], v252 offset:16896
    ds_read_b64_tr_b16 a[12:13], v244 offset:16896
    ds_read_b64_tr_b16 a[2:3], v252 offset:24576
    ds_read_b64_tr_b16 a[6:7], v244 offset:24576
    ds_read_b64_tr_b16 a[10:11], v252 offset:25088
    ds_read_b64_tr_b16 a[14:15], v244 offset:25088
    ds_read_b64_tr_b16 a[16:17], v252 offset:32768
    ds_read_b64_tr_b16 a[20:21], v244 offset:32768
    ds_read_b64_tr_b16 a[24:25], v252 offset:33280
    ds_read_b64_tr_b16 a[28:29], v244 offset:33280
    ds_read_b64_tr_b16 a[18:19], v252 offset:40960
    ds_read_b64_tr_b16 a[22:23], v244 offset:40960
    ds_read_b64_tr_b16 a[26:27], v252 offset:41472
    ds_read_b64_tr_b16 a[30:31], v244 offset:41472
    ds_read_b64_tr_b16 a[32:33], v252 offset:49152
    ds_read_b64_tr_b16 a[36:37], v244 offset:49152
    ds_read_b64_tr_b16 a[40:41], v252 offset:49664
    ds_read_b64_tr_b16 a[44:45], v244 offset:49664
    ds_read_b64_tr_b16 a[34:35], v253 offset:0
    ds_read_b64_tr_b16 a[38:39], v245 offset:0
    ds_read_b64_tr_b16 a[42:43], v253 offset:512
    ds_read_b64_tr_b16 a[46:47], v245 offset:512
    ds_read_b64_tr_b16 a[48:49], v253 offset:8192
    ds_read_b64_tr_b16 a[52:53], v245 offset:8192
    ds_read_b64_tr_b16 a[56:57], v253 offset:8704
    ds_read_b64_tr_b16 a[60:61], v245 offset:8704
    ds_read_b64_tr_b16 a[50:51], v253 offset:16384
    ds_read_b64_tr_b16 a[54:55], v245 offset:16384
    ds_read_b64_tr_b16 a[58:59], v253 offset:16896
    ds_read_b64_tr_b16 a[62:63], v245 offset:16896
    s_waitcnt vmcnt(10)
    ds_read_b64_tr_b16 a[64:65], v253 offset:24576
    ds_read_b64_tr_b16 a[68:69], v245 offset:24576
    ds_read_b64_tr_b16 a[72:73], v253 offset:25088
    ds_read_b64_tr_b16 a[76:77], v245 offset:25088
    s_waitcnt vmcnt(8)
    ds_read_b64_tr_b16 a[66:67], v253 offset:32768
    ds_read_b64_tr_b16 a[70:71], v245 offset:32768
    ds_read_b64_tr_b16 a[74:75], v253 offset:33280
    ds_read_b64_tr_b16 a[78:79], v245 offset:33280
    s_waitcnt vmcnt(6)
    ds_read_b64_tr_b16 a[80:81], v253 offset:40960
    ds_read_b64_tr_b16 a[84:85], v245 offset:40960
    ds_read_b64_tr_b16 a[88:89], v253 offset:41472
    ds_read_b64_tr_b16 a[92:93], v245 offset:41472
    s_waitcnt vmcnt(4)
    ds_read_b64_tr_b16 a[82:83], v252 offset:0
    ds_read_b64_tr_b16 a[86:87], v244 offset:0
    ds_read_b64_tr_b16 a[90:91], v252 offset:512
    ds_read_b64_tr_b16 a[94:95], v244 offset:512
    s_waitcnt vmcnt(2)
    ds_read_b64_tr_b16 a[96:97], v252 offset:8192
    ds_read_b64_tr_b16 a[100:101], v244 offset:8192
    ds_read_b64_tr_b16 a[104:105], v252 offset:8704
    ds_read_b64_tr_b16 a[108:109], v244 offset:8704
    s_waitcnt vmcnt(0)
    ds_read_b64_tr_b16 a[98:99], v253 offset:49152
    ds_read_b64_tr_b16 a[102:103], v245 offset:49152
    ds_read_b64_tr_b16 a[106:107], v253 offset:49664
    ds_read_b64_tr_b16 a[110:111], v245 offset:49664
    v_and_b32 v8, 7, v1
    v_and_b32 v6, 15, v1
    v_lshl_add_u32 v6, v6, 7, s92
    v_add_u32 v6, 90112, v6
    v_lshlrev_b32 v9, 1, v7
    v_xor_b32 v9, v9, v8
    v_lshl_add_u32 v9, v9, 4, v6
    v_and_b32 v5, 16, v1
    v_lshl_add_u32 v9, v5, 9, v9
    v_xor_b32 v5, 16, v9
    ds_write_b128 v9, v[220:223]
    ds_write_b128 v5, v[224:227]
    v_xor_b32 v9, 64, v9
    v_xor_b32 v5, 64, v5
    ds_write_b128 v9, v[228:231]
    ds_write_b128 v5, v[232:235]
    v_lshrrev_b32 v9, 4, v1
    v_xor_b32 v9, v9, v8
    v_lshl_add_u32 v9, v9, 4, v6
    v_xor_b32 v5, 64, v9
    ds_read_b128 v[200:203], v9
    ds_read_b128 v[204:207], v5
    ds_read_b128 v[208:211], v9 offset:8192
    ds_read_b128 v[212:215], v5 offset:8192
    s_waitcnt lgkmcnt(0)
    s_add_u32 m0, s92, 16384
    s_add_u32 s100, s100, 65536
    buffer_load_dwordx4 v250, s[24:27], s100 offen lds
    buffer_load_dwordx4 v251, s[24:27], s100 offen offset:1024 lds
    s_add_u32 m0, s92, 24576
    s_add_u32 s100, s100, 65536
    buffer_load_dwordx4 v250, s[24:27], s100 offen lds
    buffer_load_dwordx4 v251, s[24:27], s100 offen offset:1024 lds
    s_add_u32 m0, s92, 32768
    s_add_u32 s100, s100, 65536
    s_cmp_eq_u32 s100, s3
    s_cselect_b32 s100, s101, s100
    buffer_load_dwordx4 v250, s[24:27], s100 offen lds
    buffer_load_dwordx4 v251, s[24:27], s100 offen offset:1024 lds
    s_add_u32 m0, s92, 40960
    s_add_u32 s100, s100, 65536
    buffer_load_dwordx4 v250, s[24:27], s100 offen lds
    buffer_load_dwordx4 v251, s[24:27], s100 offen offset:1024 lds
    s_add_u32 m0, s92, 49152
    s_add_u32 s100, s100, 65536
    buffer_load_dwordx4 v250, s[24:27], s100 offen lds
    buffer_load_dwordx4 v251, s[24:27], s100 offen offset:1024 lds
    s_add_u32 m0, s92, 57344
    s_add_u32 s100, s100, 65536
    buffer_load_dwordx4 v250, s[24:27], s100 offen lds
    buffer_load_dwordx4 v251, s[24:27], s100 offen offset:1024 lds
    s_add_u32 m0, s92, 65536
    s_add_u32 s100, s100, 65536
    s_cmp_eq_u32 s100, s3
    s_cselect_b32 s100, s101, s100
    buffer_load_dwordx4 v250, s[24:27], s100 offen lds
    buffer_load_dwordx4 v251, s[24:27], s100 offen offset:1024 lds
    s_branch L_join5
L_redo5:
    s_sub_u32 s11, s11, 64
    s_cselect_b32 s11, 0, s11
    s_cbranch_scc1 L_done5
    s_waitcnt vmcnt(0) lgkmcnt(0)
    s_nop 7
    s_lshl_b32 s50, s99, 13
    s_add_u32 s50, s50, s51
    s_branch L_loop5
L_code_end:
.section .rodata,"a"
.p2align 6
.amdhsa_kernel sequential_preLN__softmax_full_mha__mixer_token_mlp__prompt_kernel
  .amdhsa_next_free_vgpr 512
  .amdhsa_next_free_sgpr 102
  .amdhsa_accum_offset 256
  .amdhsa_group_segment_fixed_size 0
  .amdhsa_kernarg_size 88
  .amdhsa_user_sgpr_count 2
  .amdhsa_user_sgpr_kernarg_segment_ptr 1
  .amdhsa_system_sgpr_workgroup_id_x 1
.end_amdhsa_kernel
```
